```python
import torch

def _softmax(x, axis=-1):
    return torch.softmax(x, dim=axis)
def _gelu(x):
    return torch.nn.functional.gelu(x, approximate="tanh")
def _silu(x):
    return torch.nn.functional.silu(x)
def _sigmoid(x):
    return torch.sigmoid(x)
def _layernorm(x, axis=-1, eps=1e-5):
    m = x.mean(dim=axis, keepdim=True)
    v = x.var(dim=axis, keepdim=True, unbiased=False)
    return (x - m) / torch.sqrt(v + eps)
def _scatter_add(tgt, idx, src, axis=0):
    return tgt.clone().index_add_(axis, idx, src)
def _segment_sum(src, seg, n):
    out = torch.zeros((n,) + src.shape[1:], dtype=src.dtype)
    return out.index_add_(0, seg, src)
def _pad(x, pw):
    flat = tuple(v for pair in reversed(pw) for v in pair)
    return torch.nn.functional.pad(x, flat)

kernel_name = 'standalone__mixer_channel_mlp__prompt'

def setup_inputs():

    _w = (lambda a: (lambda t: t.to(torch.bfloat16) if t.is_floating_point() else t)(torch.as_tensor(a)))
    B, S, D, F = 1, 2048, 1024, 3584
    return {
        "x": _w((lambda *s: torch.randn(*s, dtype=torch.bfloat16) * 0.05)(B, S, D)),
        "w1": _w((lambda *s: torch.randn(*s, dtype=torch.bfloat16) * 0.8)(D, F) * (D ** -0.5)),
        "b1": _w((lambda *s: torch.randn(*s, dtype=torch.bfloat16) * 0.4)(F)),
        "w2": _w((lambda *s: torch.randn(*s, dtype=torch.bfloat16) * 0.05)(F, D) * (F ** -0.5)),
        "b2": _w((lambda *s: torch.randn(*s, dtype=torch.bfloat16) * 0.05)(D)),
    }

def reference(x, w1, b1, w2, b2):
    y = _layernorm(x, axis=-1)
    h = _gelu(torch.einsum("bsd,df->bsf", y, w1) + b1)
    return torch.einsum("bsf,fd->bsd", h, w2) + b2
```

```asm
; @launch grid=(256,1,1) block=(256,1,1) lds=163840
.amdgcn_target "amdgcn-amd-amdhsa--gfx950"
.text
.globl standalone__mixer_channel_mlp__prompt_kernel
.p2align 12
.p2align 8
.type standalone__mixer_channel_mlp__prompt_kernel,@function
standalone__mixer_channel_mlp__prompt_kernel:
s_cmp_ge_u32 s2, 256
s_cbranch_scc1 L_end
s_load_dwordx16 s[4:19], s[0:1], 0
v_lshrrev_b32 v1, 6, v0
v_and_b32 v86, 63, v0
v_readfirstlane_b32 s3, v1
s_lshr_b32 s83, s2, 3
s_getpc_b64 s[76:77]
L_pc:
v_lshl_add_u32 v2, v86, 2, v1
v_min_u32 v2, 10, v2
v_lshlrev_b32 v2, 5, v2
v_lshl_add_u32 v4, s83, 2, v1
v_mul_u32_u24 v4, 3, v4
v_min_u32 v3, 5, v86
v_add3_u32 v4, v4, v3, -3
v_min_u32 v4, 328, v4
v_cmp_gt_u32 vcc, 3, v86
s_add_u32 s76, s76, L_main-L_pc
s_addc_u32 s77, s77, 0
v_cndmask_b32 v2, v4, v2, vcc
v_lshlrev_b32 v2, 7, v2
v_mov_b32 v3, s77
v_add_co_u32 v232, vcc, s76, v2
s_and_b32 s82, s2, 7
s_lshl_b32 s80, s3, 12
v_addc_co_u32 v233, vcc, 0, v3, vcc
global_load_dword v87, v[232:233], off
s_lshr_b32 s78, s82, 1
s_lshl_b32 s78, s78, 2
s_lshr_b32 s84, s83, 3
s_add_u32 s78, s78, s84
s_and_b32 s79, s82, 1
s_lshl_b32 s79, s79, 3
s_and_b32 s84, s83, 7
s_add_u32 s79, s79, s84
s_and_b32 s90, s78, 12
s_and_b32 s82, s79, 8
s_add_u32 s90, s90, s82
s_add_u32 s91, s78, s79
s_and_b32 s91, s91, 3
s_mov_b32 s76, 0x76534210
s_mov_b32 s77, 0xfedbca98
s_cmp_eq_u32 s91, 1
s_cmov_b32 s76, 0x76453201
s_cmov_b32 s77, 0xfecdba89
s_cmp_eq_u32 s91, 2
s_cmov_b32 s76, 0x75643120
s_cmov_b32 s77, 0xfdecb9a8
s_cmp_eq_u32 s91, 3
s_cmov_b32 s76, 0x67542310
s_cmov_b32 s77, 0xefdcab98
s_bfe_u32 s44, s76, 0x40000
s_add_u32 s44, s44, s90
s_and_b32 s44, s44, 15
s_lshl_b32 s60, s44, 7
s_mul_i32 s44, s44, 458752
s_add_u32 s44, s44, 4096
s_bfe_u32 s45, s76, 0x40004
s_add_u32 s45, s45, s90
s_and_b32 s45, s45, 15
s_lshl_b32 s61, s45, 7
s_mul_i32 s45, s45, 458752
s_add_u32 s45, s45, 2048
v_lshrrev_b32 v1, 3, v86
v_and_b32 v2, 7, v86
v_lshrrev_b32 v3, 4, v86
s_lshl_b32 s86, s78, 2
s_add_u32 s86, s86, s3
s_lshl_b32 s83, s86, 16
v_xor_b32 v4, v2, v3
v_lshlrev_b32 v5, 11, v1
v_add_u32 v5, s83, v5
v_lshl_add_u32 v64, v4, 4, v5
v_xor_b32 v6, 64, v64
v_add_u32 v65, 15360, v6
v_add_u32 v66, 30720, v64
v_add_u32 v67, 46080, v6
s_and_b32 s89, s79, 1
s_mul_i32 s87, s79, 448
s_lshl_b32 s82, s89, 6
s_add_u32 s84, s87, s82
s_mul_i32 s82, s3, 57344
s_add_u32 s84, s84, s82
s_and_b32 s82, s3, 1
s_lshl_b32 s82, s82, 2
v_and_b32 v11, 1, v3
v_lshlrev_b32 v4, 1, v11
v_or_b32 v4, s82, v4
v_xor_b32 v4, v4, v2
v_mul_u32_u24 v5, 7168, v1
v_add_u32 v5, s84, v5
v_lshl_add_u32 v234, v4, 4, v5
v_add_u32 v235, 228352, v234
s_mov_b32 s22, 4194304
s_mov_b32 s23, 0x20000
s_mov_b32 s26, 7344128
s_mov_b32 s27, 0x20000
s_waitcnt lgkmcnt(0)
s_mov_b32 s20, s4
s_mov_b32 s21, s5
s_add_u32 m0, s80, 98304
s_nop 0
buffer_load_dwordx4 v64, s[20:23], s60 offen lds
buffer_load_dwordx4 v65, s[20:23], s60 offen offset:1024 lds
buffer_load_dwordx4 v66, s[20:23], s60 offen offset:2048 lds
buffer_load_dwordx4 v67, s[20:23], s60 offen offset:3072 lds
s_sub_u32 s24, s6, 4096
s_subb_u32 s25, s7, 0
s_add_u32 m0, s80, 0
s_nop 0
buffer_load_dwordx4 v234, s[24:27], s44 offen lds
s_add_u32 s28, s24, 128
s_addc_u32 s29, s25, 0
s_mov_b32 s30, 7344000
s_mov_b32 s31, 0x20000
buffer_load_dwordx4 v235, s[24:27], s44 offen offset:1024 lds
s_mov_b32 s40, s18
s_mov_b32 s41, s19
s_mov_b32 s42, 69206016
s_mov_b32 s43, 0x20000
buffer_load_dwordx4 v234, s[24:27], s45 offen offset:2048 lds
s_mov_b32 s16, s86
s_mov_b32 s17, s90
s_mov_b32 s18, s91
s_mov_b32 s19, s87
buffer_load_dwordx4 v235, s[24:27], s45 offen offset:3072 lds
s_bfe_u32 s46, s76, 0x40008
s_add_u32 s46, s46, s17
s_and_b32 s46, s46, 15
s_lshl_b32 s62, s46, 7
s_add_u32 m0, s80, 114688
s_nop 0
buffer_load_dwordx4 v64, s[20:23], s61 offen lds
s_mul_i32 s46, s46, 458752
s_add_u32 s46, s46, 4096
s_bfe_u32 s47, s76, 0x4000c
s_add_u32 s47, s47, s17
s_and_b32 s47, s47, 15
s_lshl_b32 s63, s47, 7
s_mul_i32 s47, s47, 458752
s_add_u32 s47, s47, 2048
v_and_b32 v7, 15, v86
v_lshrrev_b32 v16, 1, v7
v_xor_b32 v16, v16, v3
v_lshlrev_b32 v16, 4, v16
v_lshl_add_u32 v16, v7, 7, v16
s_add_u32 s82, s80, 98304
v_add_u32 v68, s82, v16
v_xor_b32 v69, 64, v68
s_and_b32 s1, s79, 7
buffer_load_dwordx4 v65, s[20:23], s61 offen offset:1024 lds
s_lshl_b32 s83, s1, 9
s_add_u32 s82, s82, s83
v_lshlrev_b32 v83, 3, v86
v_add_u32 v82, s82, v83
v_lshrrev_b32 v8, 2, v7
v_and_b32 v9, 3, v86
v_lshlrev_b32 v9, 3, v9
v_lshrrev_b32 v10, 1, v8
v_lshl_add_u32 v12, v11, 1, v10
v_lshl_add_u32 v13, v12, 5, v9
v_lshl_add_u32 v14, v8, 7, v13
v_lshl_add_u32 v160, v3, 12, v14
v_xor_b32 v161, 32, v160
v_xor_b32 v162, 64, v160
v_xor_b32 v163, 96, v160
v_add_u32 v164, 0x10000, v160
v_add_u32 v165, 0x10000, v161
buffer_load_dwordx4 v66, s[20:23], s61 offen offset:2048 lds
v_add_u32 v166, 0x10000, v162
v_add_u32 v167, 0x10000, v163
s_add_u32 s83, s17, s18
s_and_b32 s83, s83, 15
s_mul_i32 s83, s83, 458752
s_add_u32 s90, s83, 4352
s_lshl_b32 s84, s89, 9
s_sub_u32 s83, s83, s84
s_add_u32 s91, s83, 2432
s_and_b32 s84, s3, 1
s_lshl_b32 s84, s84, 6
v_xor_b32 v16, s84, v160
s_lshl_b32 s82, s18, 2
s_lshr_b32 s82, 0x2100, s82
s_and_b32 s82, s82, 3
s_lshr_b32 s84, s3, 1
s_and_b32 s83, s82, 2
buffer_load_dwordx4 v67, s[20:23], s61 offen offset:3072 lds
s_add_u32 s83, s83, s84
s_lshl_b32 s83, s83, 14
s_and_b32 s82, s82, 1
s_lshl_b32 s82, s82, 11
s_add_u32 s82, s82, s83
v_add_u32 v70, s82, v16
v_xor_b32 v71, 32, v70
s_lshl_b32 s84, s84, 11
s_add_u32 s84, s84, 147456
v_add_u32 v72, s84, v16
v_xor_b32 v73, 32, v72
s_bfe_u32 s48, s76, 0x40010
s_add_u32 s48, s48, s17
s_and_b32 s48, s48, 15
s_lshl_b32 s64, s48, 7
s_mul_i32 s48, s48, 458752
s_add_u32 s48, s48, 4096
s_add_u32 m0, s80, 16384
s_nop 0
buffer_load_dwordx4 v234, s[28:31], s44 offen lds
s_bfe_u32 s49, s76, 0x40014
s_add_u32 s49, s49, s17
s_and_b32 s49, s49, 15
s_lshl_b32 s65, s49, 7
s_mul_i32 s49, s49, 458752
s_add_u32 s49, s49, 2048
s_bfe_u32 s50, s76, 0x40018
s_add_u32 s50, s50, s17
s_and_b32 s50, s50, 15
s_lshl_b32 s66, s50, 7
s_mul_i32 s50, s50, 458752
s_add_u32 s50, s50, 4096
s_bfe_u32 s51, s76, 0x4001c
s_add_u32 s51, s51, s17
s_and_b32 s51, s51, 15
s_lshl_b32 s67, s51, 7
s_mul_i32 s51, s51, 458752
buffer_load_dwordx4 v235, s[28:31], s44 offen offset:1024 lds
s_add_u32 s51, s51, 2048
s_bfe_u32 s52, s77, 0x40000
s_add_u32 s52, s52, s17
s_and_b32 s52, s52, 15
s_lshl_b32 s68, s52, 7
s_mul_i32 s52, s52, 458752
s_add_u32 s52, s52, 4096
s_bfe_u32 s53, s77, 0x40004
s_add_u32 s53, s53, s17
s_and_b32 s53, s53, 15
s_lshl_b32 s69, s53, 7
s_mul_i32 s53, s53, 458752
s_add_u32 s53, s53, 2048
s_bfe_u32 s54, s77, 0x40008
s_add_u32 s54, s54, s17
s_and_b32 s54, s54, 15
s_lshl_b32 s70, s54, 7
buffer_load_dwordx4 v234, s[28:31], s45 offen offset:2048 lds
s_mul_i32 s54, s54, 458752
s_add_u32 s54, s54, 4096
s_bfe_u32 s55, s77, 0x4000c
s_add_u32 s55, s55, s17
s_and_b32 s55, s55, 15
s_lshl_b32 s71, s55, 7
s_mul_i32 s55, s55, 458752
s_add_u32 s55, s55, 2048
s_bfe_u32 s56, s77, 0x40010
s_add_u32 s56, s56, s17
s_and_b32 s56, s56, 15
s_lshl_b32 s72, s56, 7
s_mul_i32 s56, s56, 458752
s_add_u32 s56, s56, 4096
s_bfe_u32 s57, s77, 0x40014
s_add_u32 s57, s57, s17
s_and_b32 s57, s57, 15
buffer_load_dwordx4 v235, s[28:31], s45 offen offset:3072 lds
s_lshl_b32 s73, s57, 7
s_mul_i32 s57, s57, 458752
s_add_u32 s57, s57, 2048
s_bfe_u32 s58, s77, 0x40018
s_add_u32 s58, s58, s17
s_and_b32 s58, s58, 15
s_lshl_b32 s74, s58, 7
s_mul_i32 s58, s58, 458752
s_add_u32 s58, s58, 4096
s_bfe_u32 s59, s77, 0x4001c
s_add_u32 s59, s59, s17
s_and_b32 s59, s59, 15
s_lshl_b32 s75, s59, 7
s_mul_i32 s59, s59, 458752
s_add_u32 s59, s59, 2048
s_mov_b32 s81, 0x3f803f80
s_mov_b32 s36, s8
s_add_u32 m0, s80, 131072
s_nop 0
buffer_load_dwordx4 v64, s[20:23], s62 offen lds
s_mov_b32 s37, s9
s_mov_b32 s38, 7168
s_mov_b32 s39, 0x20000
v_lshl_add_u32 v17, v7, 1, v11
v_lshlrev_b32 v18, 1, v17
s_lshl_b32 s82, s89, 6
s_add_u32 s82, s82, s19
s_lshl_b32 s83, s3, 6
s_add_u32 s82, s82, s83
buffer_load_ushort v80, v18, s[36:39], s82 offen
s_lshl_b32 s84, s89, 9
s_cmp_lt_u32 s3, 2
s_cselect_b32 s84, 0, s84
s_sub_u32 s82, s82, s84
s_add_u32 s82, s82, 256
buffer_load_ushort v250, v18, s[36:39], s82 offen
s_lshl_b32 s82, s3, 7
buffer_load_dwordx4 v65, s[20:23], s62 offen offset:1024 lds
s_add_u32 s82, s82, 131072
v_lshl_add_u32 v249, v17, 2, s82
v_lshlrev_b32 v245, 4, v3
v_add_u32 v245, 131072, v245
v_lshrrev_b32 v15, 1, v3
s_mul_i32 s84, s89, 384
s_sub_u32 s84, 384, s84
s_add_u32 s84, s84, s19
s_mul_i32 s82, s3, 114688
s_add_u32 s84, s84, s82
v_lshrrev_b32 v16, 2, v86
v_mul_u32_u24 v16, 7168, v16
v_add_u32 v16, s84, v16
v_and_b32 v17, 3, v86
v_lshlrev_b32 v18, 1, v15
v_xor_b32 v17, v17, v18
v_lshl_add_u32 v236, v17, 4, v16
buffer_load_dwordx4 v66, s[20:23], s62 offen offset:2048 lds
s_and_b32 s82, s79, 3
s_lshl_b32 s82, s82, 9
s_lshr_b32 s83, s79, 2
s_lshl_b32 s19, s83, 7
s_add_u32 s19, s19, s82
s_mov_b32 s36, s12
s_mov_b32 s37, s13
s_mov_b32 s38, 2048
v_lshlrev_b32 v16, 3, v3
buffer_load_dwordx2 v[220:221], v16, s[36:39], s19 offen offset:0
buffer_load_dwordx2 v[222:223], v16, s[36:39], s19 offen offset:32
buffer_load_dwordx2 v[224:225], v16, s[36:39], s19 offen offset:64
buffer_load_dwordx2 v[226:227], v16, s[36:39], s19 offen offset:96
s_lshl_b32 s82, s79, 6
v_lshl_add_u32 v85, v3, 4, s82
s_mul_i32 s83, s83, 1835008
s_and_b32 s82, s19, 0x600
buffer_load_dwordx4 v67, s[20:23], s62 offen offset:3072 lds
s_add_u32 s83, s83, s82
s_sub_u32 s32, s10, 4096
s_subb_u32 s33, s11, 0
s_add_u32 s32, s32, s83
s_addc_u32 s33, s33, 0
s_sub_u32 s34, 7344128, s83
s_mov_b32 s35, 0x20000
s_mov_b32 s36, s10
s_mov_b32 s37, s11
s_mov_b32 s38, 7340032
v_lshlrev_b32 v239, 4, v86
v_lshlrev_b32 v240, 4, v2
v_lshl_add_u32 v240, v1, 9, v240
v_mov_b32 v251, v240
v_lshlrev_b32 v88, 7, v86
v_lshl_add_u32 v16, v11, 9, v14
v_lshl_add_u32 v16, v15, 12, v16
v_sub_u32 v247, v16, v160
v_lshl_add_u32 v16, v8, 6, v9
v_mul_u32_u24 v17, 544, v11
v_add_u32 v16, v16, v17
v_lshl_add_u32 v168, v15, 12, v16
v_xor_b32 v169, 32, v168
v_add_u32 v170, 0x10000, v168
v_add_u32 v171, 0x10000, v169
v_lshlrev_b32 v16, 1, v3
v_xor_b32 v16, v16, v2
v_lshlrev_b32 v16, 4, v16
v_lshl_add_u32 v16, v1, 11, v16
s_lshl_b32 s84, s3, 14
v_add_u32 v16, s84, v16
s_lshr_b32 s4, s79, 2
s_xor_b32 s84, s4, 2
s_lshl_b32 s84, s84, 7
v_add_u32 v237, s84, v16
s_xor_b32 s84, s4, 3
s_lshl_b32 s84, s84, 7
v_add_u32 v238, s84, v16
s_xor_b32 s84, s4, 1
s_lshl_b32 s84, s84, 7
v_add_u32 v232, s84, v16
s_xor_b32 s84, s4, 0
s_lshl_b32 s84, s84, 7
v_add_u32 v233, s84, v16
v_lshlrev_b32 v16, 11, v7
v_lshl_add_u32 v16, v11, 5, v16
v_lshl_add_u32 v16, v15, 4, v16
s_lshl_b32 s82, s16, 16
s_add_u32 s82, s82, s19
v_add_u32 v246, s82, v16
s_mov_b32 s76, 0x409d30fc
s_mov_b32 s77, 0xbeeff558
s_lshl_b32 s86, s16, 12
s_add_u32 s86, s86, 1048576
s_lshl_b32 s87, s79, 2
s_add_u32 s87, s87, s3
s_lshl_b32 s87, s87, 13
s_add_u32 s87, s87, 262144
s_add_u32 s17, s87, 4096
s_lshl_b32 s88, s16, 4
s_add_u32 s88, s88, s79
s_lshl_b32 s88, s88, 15
s_add_u32 s88, s88, 2097152
s_lshl_b32 s82, s78, 8
v_and_b32 v16, 31, v86
v_lshl_add_u32 v84, v16, 3, s82
s_lshl_b32 s83, s4, 7
v_and_b32 v16, 3, v86
v_lshl_add_u32 v241, v16, 2, s83
s_lshl_b32 s82, s79, 2
v_mov_b32 v248, s82
s_lshl_b32 s82, s78, 2
v_writelane_b32 v248, s82, 1
s_and_b32 s82, s79, 3
s_lshl_b32 s82, s82, 2
s_add_u32 s82, s82, s83
v_mov_b32 v248, 0x7ff00000
v_writelane_b32 v248, s82, 0
v_mov_b32 v16, 0x7ff00000
v_cmp_eq_u32 vcc, 0, v7
s_nop 1
v_cndmask_b32 v85, v16, v85, vcc
s_lshl_b32 s82, s78, 4
s_add_u32 s82, s82, s79
s_lshl_b32 s82, s82, 2
s_add_u32 s82, s82, s3
s_lshl_b32 s82, s82, 15
s_add_u32 s12, s82, 35651584
s_mov_b32 s82, 0x883838a8
s_cmp_ge_u32 s79, 8
s_cmov_b32 s82, 0xb6b0b0b6
s_and_b32 s83, s79, 7
s_mul_i32 s83, s83, 4
s_lshr_b32 s82, s82, s83
s_and_b32 s82, s82, 15
s_lshl_b32 s82, s82, 3
v_mov_b32 v16, 0x7ff00000
v_add_u32 v17, 64, v86
v_cmp_gt_u32 vcc, s82, v86
v_lshlrev_b32 v18, 7, v17
s_nop 0
v_cndmask_b32 v88, v16, v88, vcc
v_cmp_gt_u32 vcc, s82, v17
s_nop 1
v_cndmask_b32 v89, v16, v18, vcc
s_mov_b32 s82, 0x1a120800
s_cmp_ge_u32 s79, 4
s_cmov_b32 s82, 0x3028251d
s_cmp_ge_u32 s79, 8
s_cmov_b32 s82, 0x49493e38
s_cmp_ge_u32 s79, 12
s_cmov_b32 s82, 0x655f5454
s_and_b32 s83, s79, 3
s_mul_i32 s83, s83, 8
s_lshr_b32 s82, s82, s83
s_and_b32 s82, s82, 255
s_mul_i32 s83, s16, 112
s_add_u32 s82, s82, s83
s_lshl_b32 s92, s82, 10
s_mov_b32 s82, 0x76543210
s_cmp_ge_u32 s79, 8
s_cmov_b32 s82, 0x76543210
s_and_b32 s83, s79, 7
s_mul_i32 s83, s83, 4
s_lshr_b32 s82, s82, s83
s_and_b32 s82, s82, 15
s_mov_b32 s1, s82
s_lshl_b32 s89, s89, 7
v_mov_b32 v19, 0
buffer_load_dword v242, v19, s[40:43], 0 offen sc1
s_waitcnt vmcnt(23)
ds_read_b64 v[204:205], v82 offset:0
ds_read_b128 a[0:3], v68 offset:0
ds_read_b128 a[4:7], v68 offset:2048
ds_read_b128 a[8:11], v69 offset:0
ds_read_b128 a[12:15], v69 offset:2048
s_waitcnt vmcnt(15)
ds_read_b64 v[206:207], v82 offset:16384
ds_read_b128 a[16:19], v68 offset:16384
ds_read_b128 a[20:23], v68 offset:18432
ds_read_b128 a[24:27], v69 offset:16384
ds_read_b128 a[28:31], v69 offset:18432
s_barrier
ds_read_b64_tr_b16 v[112:113], v160 offset:0
ds_read_b64_tr_b16 v[114:115], v160 offset:512
ds_read_b64_tr_b16 v[116:117], v160 offset:1024
ds_read_b64_tr_b16 v[118:119], v160 offset:1536
ds_read_b64_tr_b16 v[120:121], v160 offset:2048
ds_read_b64_tr_b16 v[122:123], v160 offset:2560
ds_read_b64_tr_b16 v[124:125], v160 offset:3072
ds_read_b64_tr_b16 v[126:127], v160 offset:3584
ds_read_b64_tr_b16 v[128:129], v161 offset:0
ds_read_b64_tr_b16 v[130:131], v161 offset:512
ds_read_b64_tr_b16 v[132:133], v161 offset:1024
ds_read_b64_tr_b16 v[134:135], v161 offset:1536
ds_read_b64_tr_b16 v[136:137], v161 offset:2048
ds_read_b64_tr_b16 v[138:139], v161 offset:2560
ds_read_b64_tr_b16 v[140:141], v161 offset:3072
ds_read_b64_tr_b16 v[142:143], v161 offset:3584
s_waitcnt lgkmcnt(8)
v_mfma_f32_16x16x32_bf16 v[0:3], v[112:115], a[0:3], 0
ds_read_b64_tr_b16 v[144:145], v162 offset:0
v_mfma_f32_16x16x32_bf16 v[0:3], v[116:119], a[8:11], v[0:3]
ds_read_b64_tr_b16 v[146:147], v162 offset:512
ds_read_b64_tr_b16 v[148:149], v162 offset:1024
s_add_u32 m0, s80, 32768
v_mfma_f32_16x16x32_bf16 v[0:3], v[120:123], a[16:19], v[0:3]
buffer_load_dwordx4 v234, s[24:27], s46 offen lds
v_mfma_f32_16x16x32_bf16 v[0:3], v[124:127], a[24:27], v[0:3]
ds_read_b64_tr_b16 v[150:151], v162 offset:1536
ds_read_b64_tr_b16 v[152:153], v162 offset:2048
v_mfma_f32_16x16x32_bf16 v[4:7], v[124:127], a[28:31], 0
buffer_load_dwordx4 v235, s[24:27], s46 offen offset:1024 lds
v_mfma_f32_16x16x32_bf16 v[4:7], v[120:123], a[20:23], v[4:7]
ds_read_b64_tr_b16 v[154:155], v162 offset:2560
ds_read_b64_tr_b16 v[156:157], v162 offset:3072
v_mfma_f32_16x16x32_bf16 v[4:7], v[116:119], a[12:15], v[4:7]
buffer_load_dwordx4 v234, s[24:27], s47 offen offset:2048 lds
v_mfma_f32_16x16x32_bf16 v[4:7], v[112:115], a[4:7], v[4:7]
ds_read_b64_tr_b16 v[158:159], v162 offset:3584
s_waitcnt lgkmcnt(8)
v_mfma_f32_16x16x32_bf16 v[8:11], v[128:131], a[0:3], 0
ds_read_b64_tr_b16 v[112:113], v163 offset:0
ds_read_b64_tr_b16 v[114:115], v163 offset:512
v_mfma_f32_16x16x32_bf16 v[8:11], v[132:135], a[8:11], v[8:11]
buffer_load_dwordx4 v235, s[24:27], s47 offen offset:3072 lds
v_mfma_f32_16x16x32_bf16 v[8:11], v[136:139], a[16:19], v[8:11]
ds_read_b64_tr_b16 v[116:117], v163 offset:1024
ds_read_b64_tr_b16 v[118:119], v163 offset:1536
s_add_u32 m0, s80, 98304
v_mfma_f32_16x16x32_bf16 v[8:11], v[140:143], a[24:27], v[8:11]
buffer_load_dwordx4 v64, s[20:23], s63 offen lds
v_mfma_f32_16x16x32_bf16 v[12:15], v[140:143], a[28:31], 0
ds_read_b64_tr_b16 v[120:121], v163 offset:2048
ds_read_b64_tr_b16 v[122:123], v163 offset:2560
v_mfma_f32_16x16x32_bf16 v[12:15], v[136:139], a[20:23], v[12:15]
buffer_load_dwordx4 v65, s[20:23], s63 offen offset:1024 lds
s_mov_b64 exec, 0
s_cmp_eq_u32 s3, 0
s_cbranch_scc1 L_pad0
s_cmp_eq_u32 s3, 1
s_cbranch_scc1 L_pad1
s_cmp_eq_u32 s3, 2
s_cbranch_scc1 L_pad2
s_cmp_eq_u32 s3, 3
s_cbranch_scc1 L_pad3
L_warm0:
s_mov_b64 exec, -1
v_mfma_f32_16x16x32_bf16 v[12:15], v[132:135], a[12:15], v[12:15]
ds_read_b64_tr_b16 v[124:125], v163 offset:3072
ds_read_b64_tr_b16 v[126:127], v163 offset:3584
v_mfma_f32_16x16x32_bf16 v[12:15], v[128:131], a[4:7], v[12:15]
s_branch L_main
L_warmsub:
s_mov_b64 exec, 0
s_cmp_eq_u32 s3, 0
s_cbranch_scc1 L_pad4
s_cmp_eq_u32 s3, 1
s_cbranch_scc1 L_pad5
s_cmp_eq_u32 s3, 2
s_cbranch_scc1 L_pad6
s_cmp_eq_u32 s3, 3
s_cbranch_scc1 L_pad7
L_warm1:
s_mov_b64 exec, -1
s_mov_b64 exec, 0
s_cmp_eq_u32 s3, 0
s_cbranch_scc1 L_pad8
s_cmp_eq_u32 s3, 1
s_cbranch_scc1 L_pad9
s_cmp_eq_u32 s3, 2
s_cbranch_scc1 L_pad10
L_warm2:
s_mov_b64 exec, -1
s_setpc_b64 s[6:7]
.p2align 12
L_main:
L_pad0:
s_cbranch_execz L_warm0
s_waitcnt vmcnt(17) lgkmcnt(8)
s_barrier
v_mfma_f32_16x16x32_bf16 v[16:19], v[144:147], a[0:3], 0
ds_read_b64_tr_b16 v[128:129], v160 offset:16384
ds_read_b64_tr_b16 v[130:131], v160 offset:16896
v_mfma_f32_16x16x32_bf16 v[16:19], v[148:151], a[8:11], v[16:19]
buffer_load_dwordx4 v66, s[20:23], s63 offen offset:2048 lds
v_mfma_f32_16x16x32_bf16 v[16:19], v[152:155], a[16:19], v[16:19]
ds_read_b64_tr_b16 v[132:133], v160 offset:17408
ds_read_b64_tr_b16 v[134:135], v160 offset:17920
v_mfma_f32_16x16x32_bf16 v[16:19], v[156:159], a[24:27], v[16:19]
buffer_load_dwordx4 v67, s[20:23], s63 offen offset:3072 lds
v_mfma_f32_16x16x32_bf16 v[20:23], v[156:159], a[28:31], 0
ds_read_b64_tr_b16 v[136:137], v160 offset:18432
v_mfma_f32_16x16x32_bf16 v[20:23], v[152:155], a[20:23], v[20:23]
ds_read_b64_tr_b16 v[138:139], v160 offset:18944
v_mfma_f32_16x16x32_bf16 v[20:23], v[148:151], a[12:15], v[20:23]
ds_read_b64_tr_b16 v[140:141], v160 offset:19456
v_mfma_f32_16x16x32_bf16 v[20:23], v[144:147], a[4:7], v[20:23]
ds_read_b64_tr_b16 v[142:143], v160 offset:19968
s_waitcnt lgkmcnt(8)
v_mfma_f32_16x16x32_bf16 v[24:27], v[112:115], a[0:3], 0
ds_read_b64_tr_b16 v[144:145], v161 offset:16384
ds_read_b64_tr_b16 v[146:147], v161 offset:16896
s_add_u32 m0, s80, 49152
v_mfma_f32_16x16x32_bf16 v[24:27], v[116:119], a[8:11], v[24:27]
buffer_load_dwordx4 v234, s[28:31], s46 offen lds
v_mfma_f32_16x16x32_bf16 v[24:27], v[120:123], a[16:19], v[24:27]
ds_read_b64_tr_b16 v[148:149], v161 offset:17408
v_mfma_f32_16x16x32_bf16 v[24:27], v[124:127], a[24:27], v[24:27]
ds_read_b64_tr_b16 v[150:151], v161 offset:17920
v_mfma_f32_16x16x32_bf16 v[28:31], v[124:127], a[28:31], 0
ds_read_b64_tr_b16 v[152:153], v161 offset:18432
ds_read_b64_tr_b16 v[154:155], v161 offset:18944
v_mfma_f32_16x16x32_bf16 v[28:31], v[120:123], a[20:23], v[28:31]
buffer_load_dwordx4 v235, s[28:31], s46 offen offset:1024 lds
v_mfma_f32_16x16x32_bf16 v[28:31], v[116:119], a[12:15], v[28:31]
ds_read_b64_tr_b16 v[156:157], v161 offset:19456
v_mfma_f32_16x16x32_bf16 v[28:31], v[112:115], a[4:7], v[28:31]
ds_read_b64_tr_b16 v[158:159], v161 offset:19968
s_waitcnt lgkmcnt(8)
v_mfma_f32_16x16x32_bf16 v[32:35], v[128:131], a[0:3], 0
ds_read_b64_tr_b16 v[112:113], v162 offset:16384
ds_read_b64_tr_b16 v[114:115], v162 offset:16896
v_mfma_f32_16x16x32_bf16 v[32:35], v[132:135], a[8:11], v[32:35]
buffer_load_dwordx4 v234, s[28:31], s47 offen offset:2048 lds
v_mfma_f32_16x16x32_bf16 v[32:35], v[136:139], a[16:19], v[32:35]
ds_read_b64_tr_b16 v[116:117], v162 offset:17408
v_mfma_f32_16x16x32_bf16 v[32:35], v[140:143], a[24:27], v[32:35]
ds_read_b64_tr_b16 v[118:119], v162 offset:17920
v_mfma_f32_16x16x32_bf16 v[36:39], v[140:143], a[28:31], 0
ds_read_b64_tr_b16 v[120:121], v162 offset:18432
ds_read_b64_tr_b16 v[122:123], v162 offset:18944
v_mfma_f32_16x16x32_bf16 v[36:39], v[136:139], a[20:23], v[36:39]
buffer_load_dwordx4 v235, s[28:31], s47 offen offset:3072 lds
v_mfma_f32_16x16x32_bf16 v[36:39], v[132:135], a[12:15], v[36:39]
ds_read_b64_tr_b16 v[124:125], v162 offset:19456
v_mfma_f32_16x16x32_bf16 v[36:39], v[128:131], a[4:7], v[36:39]
ds_read_b64_tr_b16 v[126:127], v162 offset:19968
s_waitcnt lgkmcnt(8)
v_mfma_f32_16x16x32_bf16 v[40:43], v[144:147], a[0:3], 0
ds_read_b64_tr_b16 v[128:129], v163 offset:16384
ds_read_b64_tr_b16 v[130:131], v163 offset:16896
s_add_u32 m0, s80, 114688
v_mfma_f32_16x16x32_bf16 v[40:43], v[148:151], a[8:11], v[40:43]
buffer_load_dwordx4 v64, s[20:23], s64 offen lds
v_mfma_f32_16x16x32_bf16 v[40:43], v[152:155], a[16:19], v[40:43]
ds_read_b64_tr_b16 v[132:133], v163 offset:17408
s_waitcnt vmcnt(13)
v_add_u32 v242, 16, v242
v_mfma_f32_16x16x32_bf16 v[40:43], v[156:159], a[24:27], v[40:43]
ds_read_b64_tr_b16 v[134:135], v163 offset:17920
ds_read_b64 v[208:209], v82 offset:32768
v_mfma_f32_16x16x32_bf16 v[44:47], v[156:159], a[28:31], 0
ds_read_b64_tr_b16 v[136:137], v163 offset:18432
ds_read_b64_tr_b16 v[138:139], v163 offset:18944
v_mfma_f32_16x16x32_bf16 v[44:47], v[152:155], a[20:23], v[44:47]
buffer_load_dwordx4 v65, s[20:23], s64 offen offset:1024 lds
v_mfma_f32_16x16x32_bf16 v[44:47], v[148:151], a[12:15], v[44:47]
ds_read_b64_tr_b16 v[140:141], v163 offset:19456
ds_read_b64_tr_b16 v[142:143], v163 offset:19968
v_mfma_f32_16x16x32_bf16 v[44:47], v[144:147], a[4:7], v[44:47]
ds_read_b128 a[32:35], v68 offset:32768
s_waitcnt vmcnt(10) lgkmcnt(10)
s_barrier
v_mfma_f32_16x16x32_bf16 v[48:51], v[112:115], a[0:3], 0
ds_read_b64_tr_b16 v[144:145], v160 offset:32768
ds_read_b64_tr_b16 v[146:147], v160 offset:33280
ds_read_b128 a[36:39], v68 offset:34816
v_mfma_f32_16x16x32_bf16 v[48:51], v[116:119], a[8:11], v[48:51]
buffer_load_dwordx4 v66, s[20:23], s64 offen offset:2048 lds
ds_read_b128 a[40:43], v69 offset:32768
v_mfma_f32_16x16x32_bf16 v[48:51], v[120:123], a[16:19], v[48:51]
ds_read_b64_tr_b16 v[148:149], v160 offset:33792
ds_read_b128 a[44:47], v69 offset:34816
v_mfma_f32_16x16x32_bf16 v[48:51], v[124:127], a[24:27], v[48:51]
ds_read_b64_tr_b16 v[150:151], v160 offset:34304
s_waitcnt vmcnt(7)
ds_read_b64 v[210:211], v82 offset:0
v_mfma_f32_16x16x32_bf16 v[52:55], v[124:127], a[28:31], 0
ds_read_b64_tr_b16 v[152:153], v160 offset:34816
ds_read_b64_tr_b16 v[154:155], v160 offset:35328
v_mfma_f32_16x16x32_bf16 v[52:55], v[120:123], a[20:23], v[52:55]
buffer_load_dwordx4 v67, s[20:23], s64 offen offset:3072 lds
v_mfma_f32_16x16x32_bf16 v[52:55], v[116:119], a[12:15], v[52:55]
ds_read_b64_tr_b16 v[156:157], v160 offset:35840
ds_read_b128 a[48:51], v68 offset:0
v_mfma_f32_16x16x32_bf16 v[52:55], v[112:115], a[4:7], v[52:55]
ds_read_b64_tr_b16 v[158:159], v160 offset:36352
ds_read_b128 a[52:55], v68 offset:2048
s_waitcnt lgkmcnt(15)
v_mfma_f32_16x16x32_bf16 v[56:59], v[128:131], a[0:3], 0
ds_read_b64_tr_b16 v[112:113], v161 offset:32768
ds_read_b64_tr_b16 v[114:115], v161 offset:33280
s_add_u32 m0, s80, 65536
ds_read_b128 a[56:59], v69 offset:0
v_mfma_f32_16x16x32_bf16 v[56:59], v[132:135], a[8:11], v[56:59]
buffer_load_dwordx4 v234, s[24:27], s48 offen lds
v_mfma_f32_16x16x32_bf16 v[56:59], v[136:139], a[16:19], v[56:59]
ds_read_b64_tr_b16 v[116:117], v161 offset:33792
ds_read_b128 a[60:63], v69 offset:2048
v_mfma_f32_16x16x32_bf16 v[56:59], v[140:143], a[24:27], v[56:59]
ds_read_b64_tr_b16 v[118:119], v161 offset:34304
v_mfma_f32_16x16x32_bf16 v[60:63], v[140:143], a[28:31], 0
ds_read_b64_tr_b16 v[120:121], v161 offset:34816
ds_read_b64_tr_b16 v[122:123], v161 offset:35328
v_mfma_f32_16x16x32_bf16 v[60:63], v[136:139], a[20:23], v[60:63]
buffer_load_dwordx4 v235, s[24:27], s48 offen offset:1024 lds
v_mfma_f32_16x16x32_bf16 v[60:63], v[132:135], a[12:15], v[60:63]
ds_read_b64_tr_b16 v[124:125], v161 offset:35840
v_mfma_f32_16x16x32_bf16 v[60:63], v[128:131], a[4:7], v[60:63]
ds_read_b64_tr_b16 v[126:127], v161 offset:36352
s_waitcnt lgkmcnt(5)
v_mfma_f32_16x16x32_bf16 v[0:3], v[144:147], a[32:35], v[0:3]
ds_read_b64_tr_b16 v[128:129], v162 offset:32768
ds_read_b64_tr_b16 v[130:131], v162 offset:33280
v_mfma_f32_16x16x32_bf16 v[0:3], v[148:151], a[40:43], v[0:3]
buffer_load_dwordx4 v234, s[24:27], s49 offen offset:2048 lds
v_mfma_f32_16x16x32_bf16 v[0:3], v[152:155], a[48:51], v[0:3]
ds_read_b64_tr_b16 v[132:133], v162 offset:33792
v_mfma_f32_16x16x32_bf16 v[0:3], v[156:159], a[56:59], v[0:3]
ds_read_b64_tr_b16 v[134:135], v162 offset:34304
v_mfma_f32_16x16x32_bf16 v[4:7], v[156:159], a[60:63], v[4:7]
ds_read_b64_tr_b16 v[136:137], v162 offset:34816
ds_read_b64_tr_b16 v[138:139], v162 offset:35328
v_mfma_f32_16x16x32_bf16 v[4:7], v[152:155], a[52:55], v[4:7]
buffer_load_dwordx4 v235, s[24:27], s49 offen offset:3072 lds
v_mfma_f32_16x16x32_bf16 v[4:7], v[148:151], a[44:47], v[4:7]
ds_read_b64_tr_b16 v[140:141], v162 offset:35840
v_mfma_f32_16x16x32_bf16 v[4:7], v[144:147], a[36:39], v[4:7]
ds_read_b64_tr_b16 v[142:143], v162 offset:36352
s_waitcnt lgkmcnt(8)
v_mfma_f32_16x16x32_bf16 v[8:11], v[112:115], a[32:35], v[8:11]
ds_read_b64_tr_b16 v[144:145], v163 offset:32768
ds_read_b64_tr_b16 v[146:147], v163 offset:33280
s_add_u32 m0, s80, 131072
v_mfma_f32_16x16x32_bf16 v[8:11], v[116:119], a[40:43], v[8:11]
buffer_load_dwordx4 v64, s[20:23], s65 offen lds
v_mfma_f32_16x16x32_bf16 v[8:11], v[120:123], a[48:51], v[8:11]
ds_read_b64_tr_b16 v[148:149], v163 offset:33792
ds_read_b64_tr_b16 v[150:151], v163 offset:34304
v_mfma_f32_16x16x32_bf16 v[8:11], v[124:127], a[56:59], v[8:11]
buffer_load_dwordx4 v65, s[20:23], s65 offen offset:1024 lds
v_mfma_f32_16x16x32_bf16 v[12:15], v[124:127], a[60:63], v[12:15]
ds_read_b64_tr_b16 v[152:153], v163 offset:34816
ds_read_b64_tr_b16 v[154:155], v163 offset:35328
v_mfma_f32_16x16x32_bf16 v[12:15], v[120:123], a[52:55], v[12:15]
buffer_load_dwordx4 v66, s[20:23], s65 offen offset:2048 lds
v_mfma_f32_16x16x32_bf16 v[12:15], v[116:119], a[44:47], v[12:15]
ds_read_b64_tr_b16 v[156:157], v163 offset:35840
ds_read_b64_tr_b16 v[158:159], v163 offset:36352
v_mfma_f32_16x16x32_bf16 v[12:15], v[112:115], a[36:39], v[12:15]
s_waitcnt vmcnt(11) lgkmcnt(8)
s_barrier
v_mfma_f32_16x16x32_bf16 v[16:19], v[128:131], a[32:35], v[16:19]
ds_read_b64_tr_b16 v[112:113], v160 offset:49152
ds_read_b64_tr_b16 v[114:115], v160 offset:49664
v_mfma_f32_16x16x32_bf16 v[16:19], v[132:135], a[40:43], v[16:19]
buffer_load_dwordx4 v67, s[20:23], s65 offen offset:3072 lds
v_mfma_f32_16x16x32_bf16 v[16:19], v[136:139], a[48:51], v[16:19]
ds_read_b64_tr_b16 v[116:117], v160 offset:50176
ds_read_b64_tr_b16 v[172:173], v70 offset:0
v_mfma_f32_16x16x32_bf16 v[16:19], v[140:143], a[56:59], v[16:19]
ds_read_b64_tr_b16 v[118:119], v160 offset:50688
ds_read_b64_tr_b16 v[174:175], v70 offset:512
v_mfma_f32_16x16x32_bf16 v[20:23], v[140:143], a[60:63], v[20:23]
ds_read_b64_tr_b16 v[120:121], v160 offset:51200
ds_read_b64_tr_b16 v[122:123], v160 offset:51712
s_add_u32 m0, s80, 81920
v_mfma_f32_16x16x32_bf16 v[20:23], v[136:139], a[52:55], v[20:23]
buffer_load_dwordx4 v234, s[28:31], s48 offen lds
v_mfma_f32_16x16x32_bf16 v[20:23], v[132:135], a[44:47], v[20:23]
ds_read_b64_tr_b16 v[124:125], v160 offset:52224
ds_read_b64_tr_b16 v[176:177], v70 offset:1024
v_mfma_f32_16x16x32_bf16 v[20:23], v[128:131], a[36:39], v[20:23]
ds_read_b64_tr_b16 v[126:127], v160 offset:52736
s_waitcnt lgkmcnt(11)
v_mfma_f32_16x16x32_bf16 v[24:27], v[144:147], a[32:35], v[24:27]
ds_read_b64_tr_b16 v[128:129], v161 offset:49152
ds_read_b64_tr_b16 v[130:131], v161 offset:49664
v_mfma_f32_16x16x32_bf16 v[24:27], v[148:151], a[40:43], v[24:27]
buffer_load_dwordx4 v235, s[28:31], s48 offen offset:1024 lds
v_mfma_f32_16x16x32_bf16 v[24:27], v[152:155], a[48:51], v[24:27]
ds_read_b64_tr_b16 v[132:133], v161 offset:50176
ds_read_b64_tr_b16 v[178:179], v70 offset:1536
ds_read_b64_tr_b16 v[180:181], v71 offset:0
v_mfma_f32_16x16x32_bf16 v[24:27], v[156:159], a[56:59], v[24:27]
ds_read_b64_tr_b16 v[134:135], v161 offset:50688
ds_read_b64_tr_b16 v[182:183], v71 offset:512
v_mfma_f32_16x16x32_bf16 v[28:31], v[156:159], a[60:63], v[28:31]
ds_read_b64_tr_b16 v[136:137], v161 offset:51200
ds_read_b64_tr_b16 v[138:139], v161 offset:51712
v_mfma_f32_16x16x32_bf16 v[28:31], v[152:155], a[52:55], v[28:31]
buffer_load_dwordx4 v234, s[28:31], s49 offen offset:2048 lds
ds_read_b64_tr_b16 v[184:185], v71 offset:1024
v_mfma_f32_16x16x32_bf16 v[28:31], v[148:151], a[44:47], v[28:31]
ds_read_b64_tr_b16 v[140:141], v161 offset:52224
ds_read_b64_tr_b16 v[186:187], v71 offset:1536
v_mfma_f32_16x16x32_bf16 v[28:31], v[144:147], a[36:39], v[28:31]
ds_read_b64_tr_b16 v[142:143], v161 offset:52736
s_waitcnt lgkmcnt(13)
v_mfma_f32_16x16x32_bf16 v[32:35], v[112:115], a[32:35], v[32:35]
ds_read_b64_tr_b16 v[144:145], v162 offset:49152
ds_read_b64_tr_b16 v[146:147], v162 offset:49664
v_mfma_f32_16x16x32_bf16 v[32:35], v[116:119], a[40:43], v[32:35]
buffer_load_dwordx4 v235, s[28:31], s49 offen offset:3072 lds
v_mfma_f32_16x16x32_bf16 v[32:35], v[120:123], a[48:51], v[32:35]
ds_read_b64_tr_b16 v[148:149], v162 offset:50176
v_mfma_f32_16x16x32_bf16 v[32:35], v[124:127], a[56:59], v[32:35]
ds_read_b64_tr_b16 v[150:151], v162 offset:50688
v_mfma_f32_16x16x32_bf16 v[36:39], v[124:127], a[60:63], v[36:39]
ds_read_b64_tr_b16 v[152:153], v162 offset:51200
ds_read_b64_tr_b16 v[154:155], v162 offset:51712
s_add_u32 m0, s80, 98304
v_mfma_f32_16x16x32_bf16 v[36:39], v[120:123], a[52:55], v[36:39]
buffer_load_dwordx4 v64, s[20:23], s66 offen lds
v_mfma_f32_16x16x32_bf16 v[36:39], v[116:119], a[44:47], v[36:39]
ds_read_b64_tr_b16 v[156:157], v162 offset:52224
s_waitcnt vmcnt(13)
ds_read_b64 v[212:213], v82 offset:16384
v_mfma_f32_16x16x32_bf16 v[36:39], v[112:115], a[36:39], v[36:39]
ds_read_b64_tr_b16 v[158:159], v162 offset:52736
s_waitcnt lgkmcnt(9)
v_mfma_f32_16x16x32_bf16 v[40:43], v[128:131], a[32:35], v[40:43]
ds_read_b64_tr_b16 v[112:113], v163 offset:49152
ds_read_b64_tr_b16 v[114:115], v163 offset:49664
v_mfma_f32_16x16x32_bf16 v[40:43], v[132:135], a[40:43], v[40:43]
buffer_load_dwordx4 v65, s[20:23], s66 offen offset:1024 lds
ds_read_b128 a[64:67], v68 offset:16384
v_mfma_f32_16x16x32_bf16 v[40:43], v[136:139], a[48:51], v[40:43]
ds_read_b64_tr_b16 v[116:117], v163 offset:50176
ds_read_b128 a[68:71], v68 offset:18432
v_dot2_f32_bf16 v76, v172, s81, 0
v_dot2_f32_bf16 v76, v173, s81, v76
v_dot2_f32_bf16 v76, v174, s81, v76
v_dot2_f32_bf16 v76, v175, s81, v76
v_dot2_f32_bf16 v76, v176, s81, v76
v_dot2_f32_bf16 v76, v177, s81, v76
v_dot2_f32_bf16 v76, v178, s81, v76
v_dot2_f32_bf16 v76, v179, s81, v76
v_dot2_f32_bf16 v77, v180, s81, 0
v_dot2_f32_bf16 v77, v181, s81, v77
v_dot2_f32_bf16 v77, v182, s81, v77
v_dot2_f32_bf16 v77, v183, s81, v77
v_dot2_f32_bf16 v77, v184, s81, v77
v_dot2_f32_bf16 v77, v185, s81, v77
v_dot2_f32_bf16 v77, v186, s81, v77
v_dot2_f32_bf16 v77, v187, s81, v77
v_mfma_f32_16x16x32_bf16 v[40:43], v[140:143], a[56:59], v[40:43]
ds_read_b64_tr_b16 v[118:119], v163 offset:50688
ds_read_b128 a[72:75], v69 offset:16384
v_mfma_f32_16x16x32_bf16 v[44:47], v[140:143], a[60:63], v[44:47]
ds_read_b64_tr_b16 v[120:121], v163 offset:51200
ds_read_b64_tr_b16 v[122:123], v163 offset:51712
v_mfma_f32_16x16x32_bf16 v[44:47], v[136:139], a[52:55], v[44:47]
buffer_load_dwordx4 v66, s[20:23], s66 offen offset:2048 lds
ds_read_b128 a[76:79], v69 offset:18432
v_mfma_f32_16x16x32_bf16 v[44:47], v[132:135], a[44:47], v[44:47]
ds_read_b64_tr_b16 v[124:125], v163 offset:52224
ds_read_b64_tr_b16 v[126:127], v163 offset:52736
v_mfma_f32_16x16x32_bf16 v[44:47], v[128:131], a[36:39], v[44:47]
v_permlane16_swap_b32 v76, v77
s_waitcnt vmcnt(11) lgkmcnt(12)
s_barrier
v_mfma_f32_16x16x32_bf16 v[48:51], v[144:147], a[32:35], v[48:51]
ds_read_b64_tr_b16 v[128:129], v164 offset:0
ds_read_b64_tr_b16 v[130:131], v164 offset:512
v_mfma_f32_16x16x32_bf16 v[48:51], v[148:151], a[40:43], v[48:51]
buffer_load_dwordx4 v67, s[20:23], s66 offen offset:3072 lds
v_mfma_f32_16x16x32_bf16 v[48:51], v[152:155], a[48:51], v[48:51]
ds_read_b64_tr_b16 v[132:133], v164 offset:1024
s_waitcnt vmcnt(8)
ds_read_b64 v[214:215], v82 offset:32768
v_mfma_f32_16x16x32_bf16 v[48:51], v[156:159], a[56:59], v[48:51]
ds_read_b64_tr_b16 v[134:135], v164 offset:1536
ds_read_b128 a[80:83], v68 offset:32768
v_mfma_f32_16x16x32_bf16 v[52:55], v[156:159], a[60:63], v[52:55]
ds_read_b64_tr_b16 v[136:137], v164 offset:2048
ds_read_b64_tr_b16 v[138:139], v164 offset:2560
s_add_u32 m0, s80, 0
v_mfma_f32_16x16x32_bf16 v[52:55], v[152:155], a[52:55], v[52:55]
buffer_load_dwordx4 v234, s[24:27], s50 offen lds
v_mfma_f32_16x16x32_bf16 v[52:55], v[148:151], a[44:47], v[52:55]
ds_read_b64_tr_b16 v[140:141], v164 offset:3072
ds_read_b128 a[84:87], v68 offset:34816
v_mfma_f32_16x16x32_bf16 v[52:55], v[144:147], a[36:39], v[52:55]
ds_read_b64_tr_b16 v[142:143], v164 offset:3584
s_waitcnt lgkmcnt(11)
v_mfma_f32_16x16x32_bf16 v[56:59], v[112:115], a[32:35], v[56:59]
ds_read_b64_tr_b16 v[144:145], v165 offset:0
ds_read_b64_tr_b16 v[146:147], v165 offset:512
ds_read_b128 a[88:91], v69 offset:32768
v_mfma_f32_16x16x32_bf16 v[56:59], v[116:119], a[40:43], v[56:59]
buffer_load_dwordx4 v235, s[24:27], s50 offen offset:1024 lds
v_mfma_f32_16x16x32_bf16 v[56:59], v[120:123], a[48:51], v[56:59]
ds_read_b64_tr_b16 v[148:149], v165 offset:1024
ds_read_b128 a[92:95], v69 offset:34816
v_add_f32 v76, v76, v77
v_mfma_f32_16x16x32_bf16 v[56:59], v[124:127], a[56:59], v[56:59]
ds_read_b64_tr_b16 v[150:151], v165 offset:1536
v_mov_b32 v77, v76
s_nop 1
v_permlane32_swap_b32 v76, v77
v_mfma_f32_16x16x32_bf16 v[60:63], v[124:127], a[60:63], v[60:63]
ds_read_b64_tr_b16 v[152:153], v165 offset:2048
ds_read_b64_tr_b16 v[154:155], v165 offset:2560
v_add_f32 v76, v76, v77
v_mfma_f32_16x16x32_bf16 v[60:63], v[120:123], a[52:55], v[60:63]
buffer_load_dwordx4 v234, s[24:27], s51 offen offset:2048 lds
v_mov_b32 v77, v242
v_mfma_f32_16x16x32_bf16 v[60:63], v[116:119], a[44:47], v[60:63]
ds_read_b64_tr_b16 v[156:157], v165 offset:3072
buffer_store_dwordx2 v[76:77], v84, s[40:43], s87 offen sc1
v_mfma_f32_16x16x32_bf16 v[60:63], v[112:115], a[36:39], v[60:63]
ds_read_b64_tr_b16 v[158:159], v165 offset:3584
s_waitcnt lgkmcnt(5)
v_mfma_f32_16x16x32_bf16 v[0:3], v[128:131], a[64:67], v[0:3]
ds_read_b64_tr_b16 v[112:113], v166 offset:0
ds_read_b64_tr_b16 v[114:115], v166 offset:512
v_mfma_f32_16x16x32_bf16 v[0:3], v[132:135], a[72:75], v[0:3]
buffer_load_dwordx4 v235, s[24:27], s51 offen offset:3072 lds
v_mfma_f32_16x16x32_bf16 v[0:3], v[136:139], a[80:83], v[0:3]
ds_read_b64_tr_b16 v[116:117], v166 offset:1024
ds_read_b64_tr_b16 v[118:119], v166 offset:1536
s_add_u32 m0, s80, 114688
v_mfma_f32_16x16x32_bf16 v[0:3], v[140:143], a[88:91], v[0:3]
buffer_load_dwordx4 v64, s[20:23], s67 offen lds
v_mfma_f32_16x16x32_bf16 v[4:7], v[140:143], a[92:95], v[4:7]
ds_read_b64_tr_b16 v[120:121], v166 offset:2048
ds_read_b64_tr_b16 v[122:123], v166 offset:2560
v_mfma_f32_16x16x32_bf16 v[4:7], v[136:139], a[84:87], v[4:7]
buffer_load_dwordx4 v65, s[20:23], s67 offen offset:1024 lds
v_mfma_f32_16x16x32_bf16 v[4:7], v[132:135], a[76:79], v[4:7]
ds_read_b64_tr_b16 v[124:125], v166 offset:3072
v_mfma_f32_16x16x32_bf16 v[4:7], v[128:131], a[68:71], v[4:7]
ds_read_b64_tr_b16 v[126:127], v166 offset:3584
s_waitcnt lgkmcnt(8)
v_mfma_f32_16x16x32_bf16 v[8:11], v[144:147], a[64:67], v[8:11]
ds_read_b64_tr_b16 v[128:129], v167 offset:0
ds_read_b64_tr_b16 v[130:131], v167 offset:512
v_mfma_f32_16x16x32_bf16 v[8:11], v[148:151], a[72:75], v[8:11]
buffer_load_dwordx4 v66, s[20:23], s67 offen offset:2048 lds
v_mfma_f32_16x16x32_bf16 v[8:11], v[152:155], a[80:83], v[8:11]
ds_read_b64_tr_b16 v[132:133], v167 offset:1024
ds_read_b64_tr_b16 v[134:135], v167 offset:1536
v_mfma_f32_16x16x32_bf16 v[8:11], v[156:159], a[88:91], v[8:11]
buffer_load_dwordx4 v67, s[20:23], s67 offen offset:3072 lds
v_mfma_f32_16x16x32_bf16 v[12:15], v[156:159], a[92:95], v[12:15]
ds_read_b64_tr_b16 v[136:137], v167 offset:2048
v_mfma_f32_16x16x32_bf16 v[12:15], v[152:155], a[84:87], v[12:15]
ds_read_b64_tr_b16 v[138:139], v167 offset:2560
v_mfma_f32_16x16x32_bf16 v[12:15], v[148:151], a[76:79], v[12:15]
ds_read_b64_tr_b16 v[140:141], v167 offset:3072
ds_read_b64_tr_b16 v[142:143], v167 offset:3584
v_mfma_f32_16x16x32_bf16 v[12:15], v[144:147], a[68:71], v[12:15]
s_waitcnt vmcnt(13) lgkmcnt(8)
s_barrier
v_mfma_f32_16x16x32_bf16 v[16:19], v[112:115], a[64:67], v[16:19]
ds_read_b64_tr_b16 v[144:145], v164 offset:16384
ds_read_b64_tr_b16 v[146:147], v164 offset:16896
s_add_u32 m0, s80, 16384
v_mfma_f32_16x16x32_bf16 v[16:19], v[116:119], a[72:75], v[16:19]
buffer_load_dwordx4 v234, s[28:31], s50 offen lds
v_mfma_f32_16x16x32_bf16 v[16:19], v[120:123], a[80:83], v[16:19]
ds_read_b64_tr_b16 v[148:149], v164 offset:17408
v_mfma_f32_16x16x32_bf16 v[16:19], v[124:127], a[88:91], v[16:19]
ds_read_b64_tr_b16 v[150:151], v164 offset:17920
s_add_u32 m0, s80, 147456
s_cmp_lg_u32 s1, 0
s_cbranch_scc1 L_cond0
buffer_load_dwordx4 v234, s[24:27], s90 offen offset:0 lds
buffer_load_dwordx4 v235, s[24:27], s90 offen offset:1024 lds
buffer_load_dwordx4 v234, s[24:27], s91 offen offset:2048 lds
buffer_load_dwordx4 v235, s[24:27], s91 offen offset:3072 lds
buffer_load_dword v87, v88, s[36:39], s92 offen
buffer_load_dword v87, v89, s[36:39], s92 offen
s_call_b64 s[6:7], L_warmsub
L_cond0:
v_mfma_f32_16x16x32_bf16 v[20:23], v[124:127], a[92:95], v[20:23]
ds_read_b64_tr_b16 v[152:153], v164 offset:18432
ds_read_b64_tr_b16 v[154:155], v164 offset:18944
s_add_u32 m0, s80, 16384
v_mfma_f32_16x16x32_bf16 v[20:23], v[120:123], a[84:87], v[20:23]
buffer_load_dwordx4 v235, s[28:31], s50 offen offset:1024 lds
v_mfma_f32_16x16x32_bf16 v[20:23], v[116:119], a[76:79], v[20:23]
ds_read_b64_tr_b16 v[156:157], v164 offset:19456
v_mfma_f32_16x16x32_bf16 v[20:23], v[112:115], a[68:71], v[20:23]
ds_read_b64_tr_b16 v[158:159], v164 offset:19968
s_waitcnt lgkmcnt(8)
v_mfma_f32_16x16x32_bf16 v[24:27], v[128:131], a[64:67], v[24:27]
ds_read_b64_tr_b16 v[112:113], v165 offset:16384
ds_read_b64_tr_b16 v[114:115], v165 offset:16896
v_mfma_f32_16x16x32_bf16 v[24:27], v[132:135], a[72:75], v[24:27]
buffer_load_dwordx4 v234, s[28:31], s51 offen offset:2048 lds
v_mfma_f32_16x16x32_bf16 v[24:27], v[136:139], a[80:83], v[24:27]
ds_read_b64_tr_b16 v[116:117], v165 offset:17408
v_mfma_f32_16x16x32_bf16 v[24:27], v[140:143], a[88:91], v[24:27]
ds_read_b64_tr_b16 v[118:119], v165 offset:17920
v_mfma_f32_16x16x32_bf16 v[28:31], v[140:143], a[92:95], v[28:31]
ds_read_b64_tr_b16 v[120:121], v165 offset:18432
ds_read_b64_tr_b16 v[122:123], v165 offset:18944
v_mfma_f32_16x16x32_bf16 v[28:31], v[136:139], a[84:87], v[28:31]
buffer_load_dwordx4 v235, s[28:31], s51 offen offset:3072 lds
v_mfma_f32_16x16x32_bf16 v[28:31], v[132:135], a[76:79], v[28:31]
ds_read_b64_tr_b16 v[124:125], v165 offset:19456
v_mfma_f32_16x16x32_bf16 v[28:31], v[128:131], a[68:71], v[28:31]
ds_read_b64_tr_b16 v[126:127], v165 offset:19968
s_waitcnt lgkmcnt(8)
v_mfma_f32_16x16x32_bf16 v[32:35], v[144:147], a[64:67], v[32:35]
ds_read_b64_tr_b16 v[128:129], v166 offset:16384
ds_read_b64_tr_b16 v[130:131], v166 offset:16896
s_add_u32 m0, s80, 131072
v_mfma_f32_16x16x32_bf16 v[32:35], v[148:151], a[72:75], v[32:35]
buffer_load_dwordx4 v64, s[20:23], s68 offen lds
v_mfma_f32_16x16x32_bf16 v[32:35], v[152:155], a[80:83], v[32:35]
ds_read_b64_tr_b16 v[132:133], v166 offset:17408
s_waitcnt vmcnt(14)
ds_read_b64 v[216:217], v82 offset:0
v_mfma_f32_16x16x32_bf16 v[32:35], v[156:159], a[88:91], v[32:35]
ds_read_b64_tr_b16 v[134:135], v166 offset:17920
ds_read_b128 a[96:99], v68 offset:0
v_mfma_f32_16x16x32_bf16 v[36:39], v[156:159], a[92:95], v[36:39]
ds_read_b64_tr_b16 v[136:137], v166 offset:18432
ds_read_b64_tr_b16 v[138:139], v166 offset:18944
v_mfma_f32_16x16x32_bf16 v[36:39], v[152:155], a[84:87], v[36:39]
buffer_load_dwordx4 v65, s[20:23], s68 offen offset:1024 lds
v_mfma_f32_16x16x32_bf16 v[36:39], v[148:151], a[76:79], v[36:39]
ds_read_b64_tr_b16 v[140:141], v166 offset:19456
ds_read_b128 a[100:103], v68 offset:2048
v_mfma_f32_16x16x32_bf16 v[36:39], v[144:147], a[68:71], v[36:39]
ds_read_b64_tr_b16 v[142:143], v166 offset:19968
ds_read_b128 a[104:107], v69 offset:0
s_waitcnt lgkmcnt(12)
v_mfma_f32_16x16x32_bf16 v[40:43], v[112:115], a[64:67], v[40:43]
ds_read_b64_tr_b16 v[144:145], v167 offset:16384
ds_read_b64_tr_b16 v[146:147], v167 offset:16896
v_mfma_f32_16x16x32_bf16 v[40:43], v[116:119], a[72:75], v[40:43]
buffer_load_dwordx4 v66, s[20:23], s68 offen offset:2048 lds
ds_read_b128 a[108:111], v69 offset:2048
v_mfma_f32_16x16x32_bf16 v[40:43], v[120:123], a[80:83], v[40:43]
ds_read_b64_tr_b16 v[148:149], v167 offset:17408
v_mfma_f32_16x16x32_bf16 v[40:43], v[124:127], a[88:91], v[40:43]
ds_read_b64_tr_b16 v[150:151], v167 offset:17920
v_mfma_f32_16x16x32_bf16 v[44:47], v[124:127], a[92:95], v[44:47]
ds_read_b64_tr_b16 v[152:153], v167 offset:18432
ds_read_b64_tr_b16 v[154:155], v167 offset:18944
v_mfma_f32_16x16x32_bf16 v[44:47], v[120:123], a[84:87], v[44:47]
buffer_load_dwordx4 v67, s[20:23], s68 offen offset:3072 lds
v_mfma_f32_16x16x32_bf16 v[44:47], v[116:119], a[76:79], v[44:47]
ds_read_b64_tr_b16 v[156:157], v167 offset:19456
ds_read_b64_tr_b16 v[158:159], v167 offset:19968
v_mfma_f32_16x16x32_bf16 v[44:47], v[112:115], a[68:71], v[44:47]
s_waitcnt vmcnt(12) lgkmcnt(10)
s_barrier
v_mfma_f32_16x16x32_bf16 v[48:51], v[128:131], a[64:67], v[48:51]
ds_read_b64_tr_b16 v[112:113], v160 offset:0
ds_read_b64_tr_b16 v[114:115], v160 offset:512
s_add_u32 m0, s80, 32768
v_mfma_f32_16x16x32_bf16 v[48:51], v[132:135], a[72:75], v[48:51]
buffer_load_dwordx4 v234, s[24:27], s52 offen lds
v_mfma_f32_16x16x32_bf16 v[48:51], v[136:139], a[80:83], v[48:51]
ds_read_b64_tr_b16 v[116:117], v160 offset:1024
s_waitcnt vmcnt(9)
ds_read_b64 v[218:219], v82 offset:16384
v_mfma_f32_16x16x32_bf16 v[48:51], v[140:143], a[88:91], v[48:51]
ds_read_b64_tr_b16 v[118:119], v160 offset:1536
ds_read_b128 a[112:115], v68 offset:16384
s_add_u32 m0, s80, 147456
s_cmp_lg_u32 s1, 1
s_cbranch_scc1 L_cond1
buffer_load_dwordx4 v234, s[24:27], s90 offen offset:0 lds
buffer_load_dwordx4 v235, s[24:27], s90 offen offset:1024 lds
buffer_load_dwordx4 v234, s[24:27], s91 offen offset:2048 lds
buffer_load_dwordx4 v235, s[24:27], s91 offen offset:3072 lds
buffer_load_dword v87, v88, s[36:39], s92 offen
buffer_load_dword v87, v89, s[36:39], s92 offen
s_call_b64 s[6:7], L_warmsub
L_cond1:
v_mfma_f32_16x16x32_bf16 v[52:55], v[140:143], a[92:95], v[52:55]
ds_read_b64_tr_b16 v[120:121], v160 offset:2048
ds_read_b64_tr_b16 v[122:123], v160 offset:2560
s_add_u32 m0, s80, 32768
v_mfma_f32_16x16x32_bf16 v[52:55], v[136:139], a[84:87], v[52:55]
buffer_load_dwordx4 v235, s[24:27], s52 offen offset:1024 lds
v_mfma_f32_16x16x32_bf16 v[52:55], v[132:135], a[76:79], v[52:55]
ds_read_b64_tr_b16 v[124:125], v160 offset:3072
ds_read_b128 a[116:119], v68 offset:18432
v_mfma_f32_16x16x32_bf16 v[52:55], v[128:131], a[68:71], v[52:55]
ds_read_b64_tr_b16 v[126:127], v160 offset:3584
s_waitcnt lgkmcnt(11)
v_mfma_f32_16x16x32_bf16 v[56:59], v[144:147], a[64:67], v[56:59]
ds_read_b64_tr_b16 v[128:129], v161 offset:0
ds_read_b64_tr_b16 v[130:131], v161 offset:512
ds_read_b128 a[120:123], v69 offset:16384
v_mfma_f32_16x16x32_bf16 v[56:59], v[148:151], a[72:75], v[56:59]
buffer_load_dwordx4 v234, s[24:27], s53 offen offset:2048 lds
v_mfma_f32_16x16x32_bf16 v[56:59], v[152:155], a[80:83], v[56:59]
ds_read_b64_tr_b16 v[132:133], v161 offset:1024
ds_read_b128 a[124:127], v69 offset:18432
v_mfma_f32_16x16x32_bf16 v[56:59], v[156:159], a[88:91], v[56:59]
ds_read_b64_tr_b16 v[134:135], v161 offset:1536
v_mfma_f32_16x16x32_bf16 v[60:63], v[156:159], a[92:95], v[60:63]
ds_read_b64_tr_b16 v[136:137], v161 offset:2048
ds_read_b64_tr_b16 v[138:139], v161 offset:2560
v_mfma_f32_16x16x32_bf16 v[60:63], v[152:155], a[84:87], v[60:63]
buffer_load_dwordx4 v235, s[24:27], s53 offen offset:3072 lds
v_mfma_f32_16x16x32_bf16 v[60:63], v[148:151], a[76:79], v[60:63]
ds_read_b64_tr_b16 v[140:141], v161 offset:3072
v_mfma_f32_16x16x32_bf16 v[60:63], v[144:147], a[68:71], v[60:63]
ds_read_b64_tr_b16 v[142:143], v161 offset:3584
s_waitcnt lgkmcnt(5)
v_mfma_f32_16x16x32_bf16 v[0:3], v[112:115], a[96:99], v[0:3]
ds_read_b64_tr_b16 v[144:145], v162 offset:0
ds_read_b64_tr_b16 v[146:147], v162 offset:512
s_add_u32 m0, s80, 98304
v_mfma_f32_16x16x32_bf16 v[0:3], v[116:119], a[104:107], v[0:3]
buffer_load_dwordx4 v64, s[20:23], s69 offen lds
v_mfma_f32_16x16x32_bf16 v[0:3], v[120:123], a[112:115], v[0:3]
ds_read_b64_tr_b16 v[148:149], v162 offset:1024
L_pad1:
s_cbranch_execz L_warm0
ds_read_b64_tr_b16 v[150:151], v162 offset:1536
v_mfma_f32_16x16x32_bf16 v[0:3], v[124:127], a[120:123], v[0:3]
buffer_load_dwordx4 v65, s[20:23], s69 offen offset:1024 lds
v_dot2_f32_bf16 v188, v204, s81, 0
v_dot2_f32_bf16 v190, v204, v204, 0
v_dot2_f32_bf16 v188, v205, s81, v188
v_dot2_f32_bf16 v190, v205, v205, v190
v_dot2_f32_bf16 v188, v206, s81, v188
v_dot2_f32_bf16 v190, v206, v206, v190
v_dot2_f32_bf16 v188, v207, s81, v188
v_dot2_f32_bf16 v190, v207, v207, v190
v_dot2_f32_bf16 v188, v208, s81, v188
v_dot2_f32_bf16 v190, v208, v208, v190
v_dot2_f32_bf16 v188, v209, s81, v188
v_dot2_f32_bf16 v190, v209, v209, v190
v_dot2_f32_bf16 v188, v210, s81, v188
v_dot2_f32_bf16 v190, v210, v210, v190
v_dot2_f32_bf16 v188, v211, s81, v188
v_dot2_f32_bf16 v190, v211, v211, v190
v_dot2_f32_bf16 v188, v212, s81, v188
v_dot2_f32_bf16 v190, v212, v212, v190
v_dot2_f32_bf16 v188, v213, s81, v188
v_dot2_f32_bf16 v190, v213, v213, v190
v_dot2_f32_bf16 v188, v214, s81, v188
v_dot2_f32_bf16 v190, v214, v214, v190
v_dot2_f32_bf16 v188, v215, s81, v188
v_dot2_f32_bf16 v190, v215, v215, v190
v_dot2_f32_bf16 v188, v216, s81, v188
v_dot2_f32_bf16 v190, v216, v216, v190
v_dot2_f32_bf16 v188, v217, s81, v188
v_dot2_f32_bf16 v190, v217, v217, v190
v_dot2_f32_bf16 v188, v218, s81, v188
v_dot2_f32_bf16 v190, v218, v218, v190
v_dot2_f32_bf16 v188, v219, s81, v188
v_dot2_f32_bf16 v190, v219, v219, v190
v_mfma_f32_16x16x32_bf16 v[4:7], v[124:127], a[124:127], v[4:7]
ds_read_b64_tr_b16 v[152:153], v162 offset:2048
ds_read_b64_tr_b16 v[154:155], v162 offset:2560
v_mfma_f32_16x16x32_bf16 v[4:7], v[120:123], a[116:119], v[4:7]
buffer_load_dwordx4 v66, s[20:23], s69 offen offset:2048 lds
v_mfma_f32_16x16x32_bf16 v[4:7], v[116:119], a[108:111], v[4:7]
ds_read_b64_tr_b16 v[156:157], v162 offset:3072
v_add_f32_dpp v188, v188, v188 row_ror:8 row_mask:0xf bank_mask:0xf
v_mfma_f32_16x16x32_bf16 v[4:7], v[112:115], a[100:103], v[4:7]
ds_read_b64_tr_b16 v[158:159], v162 offset:3584
s_waitcnt lgkmcnt(8)
v_mfma_f32_16x16x32_bf16 v[8:11], v[128:131], a[96:99], v[8:11]
ds_read_b64_tr_b16 v[112:113], v163 offset:0
ds_read_b64_tr_b16 v[114:115], v163 offset:512
v_mfma_f32_16x16x32_bf16 v[8:11], v[132:135], a[104:107], v[8:11]
buffer_load_dwordx4 v67, s[20:23], s69 offen offset:3072 lds
v_mfma_f32_16x16x32_bf16 v[8:11], v[136:139], a[112:115], v[8:11]
ds_read_b64_tr_b16 v[116:117], v163 offset:1024
v_add_f32_dpp v190, v190, v190 row_ror:8 row_mask:0xf bank_mask:0xf
v_mfma_f32_16x16x32_bf16 v[8:11], v[140:143], a[120:123], v[8:11]
ds_read_b64_tr_b16 v[118:119], v163 offset:1536
v_add_f32_dpp v188, v188, v188 row_ror:4 row_mask:0xf bank_mask:0xf
v_mfma_f32_16x16x32_bf16 v[12:15], v[140:143], a[124:127], v[12:15]
ds_read_b64_tr_b16 v[120:121], v163 offset:2048
ds_read_b64_tr_b16 v[122:123], v163 offset:2560
s_add_u32 m0, s80, 49152
v_mfma_f32_16x16x32_bf16 v[12:15], v[136:139], a[116:119], v[12:15]
buffer_load_dwordx4 v234, s[28:31], s52 offen lds
v_mfma_f32_16x16x32_bf16 v[12:15], v[132:135], a[108:111], v[12:15]
ds_read_b64_tr_b16 v[124:125], v163 offset:3072
ds_read_b64_tr_b16 v[126:127], v163 offset:3584
v_mfma_f32_16x16x32_bf16 v[12:15], v[128:131], a[100:103], v[12:15]
v_add_f32_dpp v190, v190, v190 row_ror:4 row_mask:0xf bank_mask:0xf
s_waitcnt vmcnt(13) lgkmcnt(8)
s_barrier
v_mfma_f32_16x16x32_bf16 v[16:19], v[144:147], a[96:99], v[16:19]
ds_read_b64_tr_b16 v[128:129], v160 offset:16384
ds_read_b64_tr_b16 v[130:131], v160 offset:16896
v_mfma_f32_16x16x32_bf16 v[16:19], v[148:151], a[104:107], v[16:19]
buffer_load_dwordx4 v235, s[28:31], s52 offen offset:1024 lds
v_mfma_f32_16x16x32_bf16 v[16:19], v[152:155], a[112:115], v[16:19]
ds_read_b64_tr_b16 v[132:133], v160 offset:17408
v_add_f32_dpp v188, v188, v188 row_ror:2 row_mask:0xf bank_mask:0xf
v_mfma_f32_16x16x32_bf16 v[16:19], v[156:159], a[120:123], v[16:19]
ds_read_b64_tr_b16 v[134:135], v160 offset:17920
v_add_f32_dpp v190, v190, v190 row_ror:2 row_mask:0xf bank_mask:0xf
s_add_u32 m0, s80, 147456
s_cmp_lg_u32 s1, 2
s_cbranch_scc1 L_cond2
buffer_load_dwordx4 v234, s[24:27], s90 offen offset:0 lds
buffer_load_dwordx4 v235, s[24:27], s90 offen offset:1024 lds
buffer_load_dwordx4 v234, s[24:27], s91 offen offset:2048 lds
buffer_load_dwordx4 v235, s[24:27], s91 offen offset:3072 lds
buffer_load_dword v87, v88, s[36:39], s92 offen
buffer_load_dword v87, v89, s[36:39], s92 offen
s_call_b64 s[6:7], L_warmsub
L_cond2:
v_mfma_f32_16x16x32_bf16 v[20:23], v[156:159], a[124:127], v[20:23]
ds_read_b64_tr_b16 v[136:137], v160 offset:18432
ds_read_b64_tr_b16 v[138:139], v160 offset:18944
s_add_u32 m0, s80, 49152
v_add_f32_dpp v188, v188, v188 row_ror:1 row_mask:0xf bank_mask:0xf
v_mfma_f32_16x16x32_bf16 v[20:23], v[152:155], a[116:119], v[20:23]
buffer_load_dwordx4 v234, s[28:31], s53 offen offset:2048 lds
v_add_f32_dpp v190, v190, v190 row_ror:1 row_mask:0xf bank_mask:0xf
v_mfma_f32_16x16x32_bf16 v[20:23], v[148:151], a[108:111], v[20:23]
ds_read_b64_tr_b16 v[140:141], v160 offset:19456
v_mov_b32 v189, v242
v_mfma_f32_16x16x32_bf16 v[20:23], v[144:147], a[100:103], v[20:23]
ds_read_b64_tr_b16 v[142:143], v160 offset:19968
s_waitcnt lgkmcnt(8)
v_mfma_f32_16x16x32_bf16 v[24:27], v[112:115], a[96:99], v[24:27]
ds_read_b64_tr_b16 v[144:145], v161 offset:16384
ds_read_b64_tr_b16 v[146:147], v161 offset:16896
v_mov_b32 v191, v242
v_mfma_f32_16x16x32_bf16 v[24:27], v[116:119], a[104:107], v[24:27]
buffer_load_dwordx4 v235, s[28:31], s53 offen offset:3072 lds
v_mfma_f32_16x16x32_bf16 v[24:27], v[120:123], a[112:115], v[24:27]
ds_read_b64_tr_b16 v[148:149], v161 offset:17408
buffer_store_dwordx4 v[188:191], v85, s[40:43], s86 offen sc1
v_mfma_f32_16x16x32_bf16 v[24:27], v[124:127], a[120:123], v[24:27]
ds_read_b64_tr_b16 v[150:151], v161 offset:17920
v_mfma_f32_16x16x32_bf16 v[28:31], v[124:127], a[124:127], v[28:31]
ds_read_b64_tr_b16 v[152:153], v161 offset:18432
ds_read_b64_tr_b16 v[154:155], v161 offset:18944
s_add_u32 m0, s80, 114688
v_mfma_f32_16x16x32_bf16 v[28:31], v[120:123], a[116:119], v[28:31]
buffer_load_dwordx4 v64, s[20:23], s70 offen lds
v_mfma_f32_16x16x32_bf16 v[28:31], v[116:119], a[108:111], v[28:31]
ds_read_b64_tr_b16 v[156:157], v161 offset:19456
s_waitcnt vmcnt(14)
ds_read_b128 a[128:131], v68 offset:32768
v_mfma_f32_16x16x32_bf16 v[28:31], v[112:115], a[100:103], v[28:31]
ds_read_b64_tr_b16 v[158:159], v161 offset:19968
s_waitcnt lgkmcnt(9)
v_mfma_f32_16x16x32_bf16 v[32:35], v[128:131], a[96:99], v[32:35]
ds_read_b64_tr_b16 v[112:113], v162 offset:16384
ds_read_b64_tr_b16 v[114:115], v162 offset:16896
v_mfma_f32_16x16x32_bf16 v[32:35], v[132:135], a[104:107], v[32:35]
buffer_load_dwordx4 v65, s[20:23], s70 offen offset:1024 lds
v_mfma_f32_16x16x32_bf16 v[32:35], v[136:139], a[112:115], v[32:35]
ds_read_b64_tr_b16 v[116:117], v162 offset:17408
ds_read_b128 a[132:135], v68 offset:34816
v_mfma_f32_16x16x32_bf16 v[32:35], v[140:143], a[120:123], v[32:35]
ds_read_b64_tr_b16 v[118:119], v162 offset:17920
ds_read_b128 a[136:139], v69 offset:32768
v_mfma_f32_16x16x32_bf16 v[36:39], v[140:143], a[124:127], v[36:39]
ds_read_b64_tr_b16 v[120:121], v162 offset:18432
ds_read_b64_tr_b16 v[122:123], v162 offset:18944
v_mfma_f32_16x16x32_bf16 v[36:39], v[136:139], a[116:119], v[36:39]
buffer_load_dwordx4 v66, s[20:23], s70 offen offset:2048 lds
ds_read_b128 a[140:143], v69 offset:34816
v_mfma_f32_16x16x32_bf16 v[36:39], v[132:135], a[108:111], v[36:39]
ds_read_b64_tr_b16 v[124:125], v162 offset:19456
v_mfma_f32_16x16x32_bf16 v[36:39], v[128:131], a[100:103], v[36:39]
ds_read_b64_tr_b16 v[126:127], v162 offset:19968
s_waitcnt lgkmcnt(11)
v_mfma_f32_16x16x32_bf16 v[40:43], v[144:147], a[96:99], v[40:43]
ds_read_b64_tr_b16 v[128:129], v163 offset:16384
ds_read_b64_tr_b16 v[130:131], v163 offset:16896
v_mfma_f32_16x16x32_bf16 v[40:43], v[148:151], a[104:107], v[40:43]
buffer_load_dwordx4 v67, s[20:23], s70 offen offset:3072 lds
v_mfma_f32_16x16x32_bf16 v[40:43], v[152:155], a[112:115], v[40:43]
ds_read_b64_tr_b16 v[132:133], v163 offset:17408
v_mfma_f32_16x16x32_bf16 v[40:43], v[156:159], a[120:123], v[40:43]
ds_read_b64_tr_b16 v[134:135], v163 offset:17920
v_mfma_f32_16x16x32_bf16 v[44:47], v[156:159], a[124:127], v[44:47]
ds_read_b64_tr_b16 v[136:137], v163 offset:18432
ds_read_b64_tr_b16 v[138:139], v163 offset:18944
s_add_u32 m0, s80, 65536
v_mfma_f32_16x16x32_bf16 v[44:47], v[152:155], a[116:119], v[44:47]
buffer_load_dwordx4 v234, s[24:27], s54 offen lds
v_mfma_f32_16x16x32_bf16 v[44:47], v[148:151], a[108:111], v[44:47]
ds_read_b64_tr_b16 v[140:141], v163 offset:19456
ds_read_b64_tr_b16 v[142:143], v163 offset:19968
v_mfma_f32_16x16x32_bf16 v[44:47], v[144:147], a[100:103], v[44:47]
s_waitcnt vmcnt(14) lgkmcnt(8)
s_barrier
v_mfma_f32_16x16x32_bf16 v[48:51], v[112:115], a[96:99], v[48:51]
ds_read_b64_tr_b16 v[144:145], v160 offset:32768
ds_read_b64_tr_b16 v[146:147], v160 offset:33280
v_mfma_f32_16x16x32_bf16 v[48:51], v[116:119], a[104:107], v[48:51]
buffer_load_dwordx4 v235, s[24:27], s54 offen offset:1024 lds
v_mfma_f32_16x16x32_bf16 v[48:51], v[120:123], a[112:115], v[48:51]
ds_read_b64_tr_b16 v[148:149], v160 offset:33792
s_waitcnt vmcnt(11)
ds_read_b128 a[144:147], v68 offset:0
v_mfma_f32_16x16x32_bf16 v[48:51], v[124:127], a[120:123], v[48:51]
ds_read_b64_tr_b16 v[150:151], v160 offset:34304
ds_read_b128 a[148:151], v68 offset:2048
s_add_u32 m0, s80, 147456
s_cmp_lg_u32 s1, 3
s_cbranch_scc1 L_cond3
buffer_load_dwordx4 v234, s[24:27], s90 offen offset:0 lds
buffer_load_dwordx4 v235, s[24:27], s90 offen offset:1024 lds
buffer_load_dwordx4 v234, s[24:27], s91 offen offset:2048 lds
buffer_load_dwordx4 v235, s[24:27], s91 offen offset:3072 lds
buffer_load_dword v87, v88, s[36:39], s92 offen
buffer_load_dword v87, v89, s[36:39], s92 offen
s_call_b64 s[6:7], L_warmsub
L_cond3:
v_mfma_f32_16x16x32_bf16 v[52:55], v[124:127], a[124:127], v[52:55]
ds_read_b64_tr_b16 v[152:153], v160 offset:34816
ds_read_b64_tr_b16 v[154:155], v160 offset:35328
s_add_u32 m0, s80, 65536
v_mfma_f32_16x16x32_bf16 v[52:55], v[120:123], a[116:119], v[52:55]
buffer_load_dwordx4 v234, s[24:27], s55 offen offset:2048 lds
v_mfma_f32_16x16x32_bf16 v[52:55], v[116:119], a[108:111], v[52:55]
ds_read_b64_tr_b16 v[156:157], v160 offset:35840
ds_read_b128 a[152:155], v69 offset:0
v_mfma_f32_16x16x32_bf16 v[52:55], v[112:115], a[100:103], v[52:55]
ds_read_b64_tr_b16 v[158:159], v160 offset:36352
s_waitcnt lgkmcnt(11)
v_mfma_f32_16x16x32_bf16 v[56:59], v[128:131], a[96:99], v[56:59]
ds_read_b64_tr_b16 v[112:113], v161 offset:32768
ds_read_b64_tr_b16 v[114:115], v161 offset:33280
v_mfma_f32_16x16x32_bf16 v[56:59], v[132:135], a[104:107], v[56:59]
buffer_load_dwordx4 v235, s[24:27], s55 offen offset:3072 lds
v_mfma_f32_16x16x32_bf16 v[56:59], v[136:139], a[112:115], v[56:59]
ds_read_b64_tr_b16 v[116:117], v161 offset:33792
ds_read_b64_tr_b16 v[118:119], v161 offset:34304
s_add_u32 m0, s80, 131072
ds_read_b128 a[156:159], v69 offset:2048
v_mfma_f32_16x16x32_bf16 v[56:59], v[140:143], a[120:123], v[56:59]
buffer_load_dwordx4 v64, s[20:23], s71 offen lds
v_mfma_f32_16x16x32_bf16 v[60:63], v[140:143], a[124:127], v[60:63]
ds_read_b64_tr_b16 v[120:121], v161 offset:34816
v_mfma_f32_16x16x32_bf16 v[60:63], v[136:139], a[116:119], v[60:63]
ds_read_b64_tr_b16 v[122:123], v161 offset:35328
ds_read_b64_tr_b16 v[124:125], v161 offset:35840
v_mfma_f32_16x16x32_bf16 v[60:63], v[132:135], a[108:111], v[60:63]
buffer_load_dwordx4 v65, s[20:23], s71 offen offset:1024 lds
v_mfma_f32_16x16x32_bf16 v[60:63], v[128:131], a[100:103], v[60:63]
ds_read_b64_tr_b16 v[126:127], v161 offset:36352
s_waitcnt lgkmcnt(4)
v_mfma_f32_16x16x32_bf16 v[0:3], v[144:147], a[128:131], v[0:3]
ds_read_b64_tr_b16 v[128:129], v162 offset:32768
v_mfma_f32_16x16x32_bf16 v[0:3], v[148:151], a[136:139], v[0:3]
ds_read_b64_tr_b16 v[130:131], v162 offset:33280
ds_read_b64_tr_b16 v[132:133], v162 offset:33792
v_mfma_f32_16x16x32_bf16 v[0:3], v[152:155], a[144:147], v[0:3]
buffer_load_dwordx4 v66, s[20:23], s71 offen offset:2048 lds
v_mfma_f32_16x16x32_bf16 v[0:3], v[156:159], a[152:155], v[0:3]
ds_read_b64_tr_b16 v[134:135], v162 offset:34304
v_mfma_f32_16x16x32_bf16 v[4:7], v[156:159], a[156:159], v[4:7]
ds_read_b64_tr_b16 v[136:137], v162 offset:34816
v_mfma_f32_16x16x32_bf16 v[4:7], v[152:155], a[148:151], v[4:7]
ds_read_b64_tr_b16 v[138:139], v162 offset:35328
ds_read_b64_tr_b16 v[140:141], v162 offset:35840
v_mfma_f32_16x16x32_bf16 v[4:7], v[148:151], a[140:143], v[4:7]
buffer_load_dwordx4 v67, s[20:23], s71 offen offset:3072 lds
v_mfma_f32_16x16x32_bf16 v[4:7], v[144:147], a[132:135], v[4:7]
ds_read_b64_tr_b16 v[142:143], v162 offset:36352
s_waitcnt lgkmcnt(8)
v_mfma_f32_16x16x32_bf16 v[8:11], v[112:115], a[128:131], v[8:11]
ds_read_b64_tr_b16 v[144:145], v163 offset:32768
v_mfma_f32_16x16x32_bf16 v[8:11], v[116:119], a[136:139], v[8:11]
ds_read_b64_tr_b16 v[146:147], v163 offset:33280
ds_read_b64_tr_b16 v[148:149], v163 offset:33792
s_add_u32 m0, s80, 81920
v_mfma_f32_16x16x32_bf16 v[8:11], v[120:123], a[144:147], v[8:11]
buffer_load_dwordx4 v234, s[28:31], s54 offen lds
v_mfma_f32_16x16x32_bf16 v[8:11], v[124:127], a[152:155], v[8:11]
ds_read_b64_tr_b16 v[150:151], v163 offset:34304
v_mfma_f32_16x16x32_bf16 v[12:15], v[124:127], a[156:159], v[12:15]
ds_read_b64_tr_b16 v[152:153], v163 offset:34816
v_mfma_f32_16x16x32_bf16 v[12:15], v[120:123], a[148:151], v[12:15]
ds_read_b64_tr_b16 v[154:155], v163 offset:35328
ds_read_b64_tr_b16 v[156:157], v163 offset:35840
v_mfma_f32_16x16x32_bf16 v[12:15], v[116:119], a[140:143], v[12:15]
buffer_load_dwordx4 v235, s[28:31], s54 offen offset:1024 lds
v_mfma_f32_16x16x32_bf16 v[12:15], v[112:115], a[132:135], v[12:15]
ds_read_b64_tr_b16 v[158:159], v163 offset:36352
s_waitcnt vmcnt(15) lgkmcnt(8)
s_barrier
v_mfma_f32_16x16x32_bf16 v[16:19], v[128:131], a[128:131], v[16:19]
ds_read_b64_tr_b16 v[112:113], v160 offset:49152
v_mfma_f32_16x16x32_bf16 v[16:19], v[132:135], a[136:139], v[16:19]
ds_read_b64_tr_b16 v[114:115], v160 offset:49664
ds_read_b64_tr_b16 v[116:117], v160 offset:50176
v_mfma_f32_16x16x32_bf16 v[16:19], v[136:139], a[144:147], v[16:19]
buffer_load_dwordx4 v234, s[28:31], s55 offen offset:2048 lds
v_mfma_f32_16x16x32_bf16 v[16:19], v[140:143], a[152:155], v[16:19]
ds_read_b64_tr_b16 v[118:119], v160 offset:50688
s_add_u32 m0, s80, 147456
s_cmp_lg_u32 s1, 4
s_cbranch_scc1 L_cond4
buffer_load_dwordx4 v234, s[24:27], s90 offen offset:0 lds
buffer_load_dwordx4 v235, s[24:27], s90 offen offset:1024 lds
buffer_load_dwordx4 v234, s[24:27], s91 offen offset:2048 lds
buffer_load_dwordx4 v235, s[24:27], s91 offen offset:3072 lds
buffer_load_dword v87, v88, s[36:39], s92 offen
buffer_load_dword v87, v89, s[36:39], s92 offen
s_call_b64 s[6:7], L_warmsub
L_cond4:
v_mfma_f32_16x16x32_bf16 v[20:23], v[140:143], a[156:159], v[20:23]
ds_read_b64_tr_b16 v[120:121], v160 offset:51200
v_mfma_f32_16x16x32_bf16 v[20:23], v[136:139], a[148:151], v[20:23]
ds_read_b64_tr_b16 v[122:123], v160 offset:51712
ds_read_b64_tr_b16 v[124:125], v160 offset:52224
s_add_u32 m0, s80, 81920
v_mfma_f32_16x16x32_bf16 v[20:23], v[132:135], a[140:143], v[20:23]
buffer_load_dwordx4 v235, s[28:31], s55 offen offset:3072 lds
v_mfma_f32_16x16x32_bf16 v[20:23], v[128:131], a[132:135], v[20:23]
ds_read_b64_tr_b16 v[126:127], v160 offset:52736
s_waitcnt lgkmcnt(8)
v_mfma_f32_16x16x32_bf16 v[24:27], v[144:147], a[128:131], v[24:27]
ds_read_b64_tr_b16 v[128:129], v161 offset:49152
v_mfma_f32_16x16x32_bf16 v[24:27], v[148:151], a[136:139], v[24:27]
ds_read_b64_tr_b16 v[130:131], v161 offset:49664
ds_read_b64_tr_b16 v[132:133], v161 offset:50176
s_add_u32 m0, s80, 98304
v_mfma_f32_16x16x32_bf16 v[24:27], v[152:155], a[144:147], v[24:27]
buffer_load_dwordx4 v64, s[20:23], s72 offen lds
v_mfma_f32_16x16x32_bf16 v[24:27], v[156:159], a[152:155], v[24:27]
ds_read_b64_tr_b16 v[134:135], v161 offset:50688
s_waitcnt vmcnt(13)
ds_read_b128 a[160:163], v68 offset:16384
v_mfma_f32_16x16x32_bf16 v[28:31], v[156:159], a[156:159], v[28:31]
ds_read_b64_tr_b16 v[136:137], v161 offset:51200
ds_read_b128 a[164:167], v68 offset:18432
v_mfma_f32_16x16x32_bf16 v[28:31], v[152:155], a[148:151], v[28:31]
ds_read_b64_tr_b16 v[138:139], v161 offset:51712
ds_read_b64_tr_b16 v[140:141], v161 offset:52224
v_mfma_f32_16x16x32_bf16 v[28:31], v[148:151], a[140:143], v[28:31]
buffer_load_dwordx4 v65, s[20:23], s72 offen offset:1024 lds
v_mfma_f32_16x16x32_bf16 v[28:31], v[144:147], a[132:135], v[28:31]
ds_read_b64_tr_b16 v[142:143], v161 offset:52736
ds_read_b128 a[168:171], v69 offset:16384
s_waitcnt lgkmcnt(11)
v_mfma_f32_16x16x32_bf16 v[32:35], v[112:115], a[128:131], v[32:35]
ds_read_b64_tr_b16 v[144:145], v162 offset:49152
ds_read_b128 a[172:175], v69 offset:18432
v_mfma_f32_16x16x32_bf16 v[32:35], v[116:119], a[136:139], v[32:35]
ds_read_b64_tr_b16 v[146:147], v162 offset:49664
ds_read_b64_tr_b16 v[148:149], v162 offset:50176
v_mfma_f32_16x16x32_bf16 v[32:35], v[120:123], a[144:147], v[32:35]
buffer_load_dwordx4 v66, s[20:23], s72 offen offset:2048 lds
v_mfma_f32_16x16x32_bf16 v[32:35], v[124:127], a[152:155], v[32:35]
ds_read_b64_tr_b16 v[150:151], v162 offset:50688
v_mfma_f32_16x16x32_bf16 v[36:39], v[124:127], a[156:159], v[36:39]
ds_read_b64_tr_b16 v[152:153], v162 offset:51200
v_mfma_f32_16x16x32_bf16 v[36:39], v[120:123], a[148:151], v[36:39]
ds_read_b64_tr_b16 v[154:155], v162 offset:51712
ds_read_b64_tr_b16 v[156:157], v162 offset:52224
v_mfma_f32_16x16x32_bf16 v[36:39], v[116:119], a[140:143], v[36:39]
buffer_load_dwordx4 v67, s[20:23], s72 offen offset:3072 lds
v_mfma_f32_16x16x32_bf16 v[36:39], v[112:115], a[132:135], v[36:39]
ds_read_b64_tr_b16 v[158:159], v162 offset:52736
s_waitcnt lgkmcnt(10)
v_mfma_f32_16x16x32_bf16 v[40:43], v[128:131], a[128:131], v[40:43]
ds_read_b64_tr_b16 v[112:113], v163 offset:49152
v_mfma_f32_16x16x32_bf16 v[40:43], v[132:135], a[136:139], v[40:43]
ds_read_b64_tr_b16 v[114:115], v163 offset:49664
ds_read_b64_tr_b16 v[116:117], v163 offset:50176
s_add_u32 m0, s80, 0
v_mfma_f32_16x16x32_bf16 v[40:43], v[136:139], a[144:147], v[40:43]
buffer_load_dwordx4 v234, s[24:27], s56 offen lds
v_mfma_f32_16x16x32_bf16 v[40:43], v[140:143], a[152:155], v[40:43]
ds_read_b64_tr_b16 v[118:119], v163 offset:50688
v_mfma_f32_16x16x32_bf16 v[44:47], v[140:143], a[156:159], v[44:47]
ds_read_b64_tr_b16 v[120:121], v163 offset:51200
v_mfma_f32_16x16x32_bf16 v[44:47], v[136:139], a[148:151], v[44:47]
ds_read_b64_tr_b16 v[122:123], v163 offset:51712
ds_read_b64_tr_b16 v[124:125], v163 offset:52224
v_mfma_f32_16x16x32_bf16 v[44:47], v[132:135], a[140:143], v[44:47]
buffer_load_dwordx4 v235, s[24:27], s56 offen offset:1024 lds
v_mfma_f32_16x16x32_bf16 v[44:47], v[128:131], a[132:135], v[44:47]
ds_read_b64_tr_b16 v[126:127], v163 offset:52736
s_waitcnt vmcnt(14) lgkmcnt(8)
s_barrier
v_mfma_f32_16x16x32_bf16 v[48:51], v[144:147], a[128:131], v[48:51]
ds_read_b64_tr_b16 v[128:129], v164 offset:0
v_mfma_f32_16x16x32_bf16 v[48:51], v[148:151], a[136:139], v[48:51]
ds_read_b64_tr_b16 v[130:131], v164 offset:512
ds_read_b64_tr_b16 v[132:133], v164 offset:1024
v_mfma_f32_16x16x32_bf16 v[48:51], v[152:155], a[144:147], v[48:51]
buffer_load_dwordx4 v234, s[24:27], s57 offen offset:2048 lds
v_mfma_f32_16x16x32_bf16 v[48:51], v[156:159], a[152:155], v[48:51]
ds_read_b64_tr_b16 v[134:135], v164 offset:1536
s_waitcnt vmcnt(11)
ds_read_b128 a[176:179], v68 offset:32768
s_add_u32 m0, s80, 147456
s_cmp_lg_u32 s1, 5
s_cbranch_scc1 L_cond5
buffer_load_dwordx4 v234, s[24:27], s90 offen offset:0 lds
buffer_load_dwordx4 v235, s[24:27], s90 offen offset:1024 lds
buffer_load_dwordx4 v234, s[24:27], s91 offen offset:2048 lds
buffer_load_dwordx4 v235, s[24:27], s91 offen offset:3072 lds
buffer_load_dword v87, v88, s[36:39], s92 offen
buffer_load_dword v87, v89, s[36:39], s92 offen
s_call_b64 s[6:7], L_warmsub
L_cond5:
v_mfma_f32_16x16x32_bf16 v[52:55], v[156:159], a[156:159], v[52:55]
ds_read_b64_tr_b16 v[136:137], v164 offset:2048
ds_read_b128 a[180:183], v68 offset:34816
v_mfma_f32_16x16x32_bf16 v[52:55], v[152:155], a[148:151], v[52:55]
ds_read_b64_tr_b16 v[138:139], v164 offset:2560
ds_read_b64_tr_b16 v[140:141], v164 offset:3072
s_add_u32 m0, s80, 0
v_mfma_f32_16x16x32_bf16 v[52:55], v[148:151], a[140:143], v[52:55]
buffer_load_dwordx4 v235, s[24:27], s57 offen offset:3072 lds
v_mfma_f32_16x16x32_bf16 v[52:55], v[144:147], a[132:135], v[52:55]
ds_read_b64_tr_b16 v[142:143], v164 offset:3584
s_waitcnt lgkmcnt(10)
v_mfma_f32_16x16x32_bf16 v[56:59], v[112:115], a[128:131], v[56:59]
ds_read_b64_tr_b16 v[144:145], v165 offset:0
ds_read_b128 a[184:187], v69 offset:32768
v_mfma_f32_16x16x32_bf16 v[56:59], v[116:119], a[136:139], v[56:59]
ds_read_b64_tr_b16 v[146:147], v165 offset:512
ds_read_b64_tr_b16 v[148:149], v165 offset:1024
s_add_u32 m0, s80, 114688
v_mfma_f32_16x16x32_bf16 v[56:59], v[120:123], a[144:147], v[56:59]
buffer_load_dwordx4 v64, s[20:23], s73 offen lds
ds_read_b128 a[188:191], v69 offset:34816
v_mfma_f32_16x16x32_bf16 v[56:59], v[124:127], a[152:155], v[56:59]
ds_read_b64_tr_b16 v[150:151], v165 offset:1536
v_mfma_f32_16x16x32_bf16 v[60:63], v[124:127], a[156:159], v[60:63]
ds_read_b64_tr_b16 v[152:153], v165 offset:2048
v_mfma_f32_16x16x32_bf16 v[60:63], v[120:123], a[148:151], v[60:63]
ds_read_b64_tr_b16 v[154:155], v165 offset:2560
ds_read_b64_tr_b16 v[156:157], v165 offset:3072
v_mfma_f32_16x16x32_bf16 v[60:63], v[116:119], a[140:143], v[60:63]
buffer_load_dwordx4 v65, s[20:23], s73 offen offset:1024 lds
v_mfma_f32_16x16x32_bf16 v[60:63], v[112:115], a[132:135], v[60:63]
ds_read_b64_tr_b16 v[158:159], v165 offset:3584
s_waitcnt lgkmcnt(5)
v_mfma_f32_16x16x32_bf16 v[0:3], v[128:131], a[160:163], v[0:3]
ds_read_b64_tr_b16 v[112:113], v166 offset:0
v_mfma_f32_16x16x32_bf16 v[0:3], v[132:135], a[168:171], v[0:3]
ds_read_b64_tr_b16 v[114:115], v166 offset:512
ds_read_b64_tr_b16 v[116:117], v166 offset:1024
v_mfma_f32_16x16x32_bf16 v[0:3], v[136:139], a[176:179], v[0:3]
buffer_load_dwordx4 v66, s[20:23], s73 offen offset:2048 lds
v_mfma_f32_16x16x32_bf16 v[0:3], v[140:143], a[184:187], v[0:3]
ds_read_b64_tr_b16 v[118:119], v166 offset:1536
v_mfma_f32_16x16x32_bf16 v[4:7], v[140:143], a[188:191], v[4:7]
ds_read_b64_tr_b16 v[120:121], v166 offset:2048
v_mfma_f32_16x16x32_bf16 v[4:7], v[136:139], a[180:183], v[4:7]
ds_read_b64_tr_b16 v[122:123], v166 offset:2560
ds_read_b64_tr_b16 v[124:125], v166 offset:3072
v_mfma_f32_16x16x32_bf16 v[4:7], v[132:135], a[172:175], v[4:7]
buffer_load_dwordx4 v67, s[20:23], s73 offen offset:3072 lds
v_mfma_f32_16x16x32_bf16 v[4:7], v[128:131], a[164:167], v[4:7]
ds_read_b64_tr_b16 v[126:127], v166 offset:3584
s_waitcnt lgkmcnt(8)
v_mfma_f32_16x16x32_bf16 v[8:11], v[144:147], a[160:163], v[8:11]
ds_read_b64_tr_b16 v[128:129], v167 offset:0
v_mfma_f32_16x16x32_bf16 v[8:11], v[148:151], a[168:171], v[8:11]
ds_read_b64_tr_b16 v[130:131], v167 offset:512
ds_read_b64_tr_b16 v[132:133], v167 offset:1024
s_add_u32 m0, s80, 16384
v_mfma_f32_16x16x32_bf16 v[8:11], v[152:155], a[176:179], v[8:11]
buffer_load_dwordx4 v234, s[28:31], s56 offen lds
v_mfma_f32_16x16x32_bf16 v[8:11], v[156:159], a[184:187], v[8:11]
ds_read_b64_tr_b16 v[134:135], v167 offset:1536
v_mfma_f32_16x16x32_bf16 v[12:15], v[156:159], a[188:191], v[12:15]
ds_read_b64_tr_b16 v[136:137], v167 offset:2048
v_mfma_f32_16x16x32_bf16 v[12:15], v[152:155], a[180:183], v[12:15]
ds_read_b64_tr_b16 v[138:139], v167 offset:2560
ds_read_b64_tr_b16 v[140:141], v167 offset:3072
v_mfma_f32_16x16x32_bf16 v[12:15], v[148:151], a[172:175], v[12:15]
buffer_load_dwordx4 v235, s[28:31], s56 offen offset:1024 lds
v_mfma_f32_16x16x32_bf16 v[12:15], v[144:147], a[164:167], v[12:15]
ds_read_b64_tr_b16 v[142:143], v167 offset:3584
s_waitcnt vmcnt(14) lgkmcnt(8)
s_barrier
v_mfma_f32_16x16x32_bf16 v[16:19], v[112:115], a[160:163], v[16:19]
ds_read_b64_tr_b16 v[144:145], v164 offset:16384
v_mfma_f32_16x16x32_bf16 v[16:19], v[116:119], a[168:171], v[16:19]
ds_read_b64_tr_b16 v[146:147], v164 offset:16896
ds_read_b64_tr_b16 v[148:149], v164 offset:17408
v_mfma_f32_16x16x32_bf16 v[16:19], v[120:123], a[176:179], v[16:19]
buffer_load_dwordx4 v234, s[28:31], s57 offen offset:2048 lds
v_mfma_f32_16x16x32_bf16 v[16:19], v[124:127], a[184:187], v[16:19]
ds_read_b64_tr_b16 v[150:151], v164 offset:17920
s_add_u32 m0, s80, 147456
s_cmp_lg_u32 s1, 6
s_cbranch_scc1 L_cond6
buffer_load_dwordx4 v234, s[24:27], s90 offen offset:0 lds
buffer_load_dwordx4 v235, s[24:27], s90 offen offset:1024 lds
buffer_load_dwordx4 v234, s[24:27], s91 offen offset:2048 lds
buffer_load_dwordx4 v235, s[24:27], s91 offen offset:3072 lds
buffer_load_dword v87, v88, s[36:39], s92 offen
buffer_load_dword v87, v89, s[36:39], s92 offen
s_call_b64 s[6:7], L_warmsub
L_cond6:
v_mfma_f32_16x16x32_bf16 v[20:23], v[124:127], a[188:191], v[20:23]
ds_read_b64_tr_b16 v[152:153], v164 offset:18432
v_mfma_f32_16x16x32_bf16 v[20:23], v[120:123], a[180:183], v[20:23]
ds_read_b64_tr_b16 v[154:155], v164 offset:18944
ds_read_b64_tr_b16 v[156:157], v164 offset:19456
s_add_u32 m0, s80, 16384
v_mfma_f32_16x16x32_bf16 v[20:23], v[116:119], a[172:175], v[20:23]
buffer_load_dwordx4 v235, s[28:31], s57 offen offset:3072 lds
v_mfma_f32_16x16x32_bf16 v[20:23], v[112:115], a[164:167], v[20:23]
ds_read_b64_tr_b16 v[158:159], v164 offset:19968
s_waitcnt lgkmcnt(8)
v_mfma_f32_16x16x32_bf16 v[24:27], v[128:131], a[160:163], v[24:27]
ds_read_b64_tr_b16 v[112:113], v165 offset:16384
s_waitcnt vmcnt(12)
ds_read_b128 a[192:195], v68 offset:0
v_mfma_f32_16x16x32_bf16 v[24:27], v[132:135], a[168:171], v[24:27]
ds_read_b64_tr_b16 v[114:115], v165 offset:16896
ds_read_b64_tr_b16 v[116:117], v165 offset:17408
s_add_u32 m0, s80, 131072
v_mfma_f32_16x16x32_bf16 v[24:27], v[136:139], a[176:179], v[24:27]
buffer_load_dwordx4 v64, s[20:23], s74 offen lds
v_mfma_f32_16x16x32_bf16 v[24:27], v[140:143], a[184:187], v[24:27]
ds_read_b64_tr_b16 v[118:119], v165 offset:17920
ds_read_b128 a[196:199], v68 offset:2048
v_mfma_f32_16x16x32_bf16 v[28:31], v[140:143], a[188:191], v[28:31]
ds_read_b64_tr_b16 v[120:121], v165 offset:18432
ds_read_b128 a[200:203], v69 offset:0
v_mfma_f32_16x16x32_bf16 v[28:31], v[136:139], a[180:183], v[28:31]
ds_read_b64_tr_b16 v[122:123], v165 offset:18944
ds_read_b64_tr_b16 v[124:125], v165 offset:19456
v_mfma_f32_16x16x32_bf16 v[28:31], v[132:135], a[172:175], v[28:31]
buffer_load_dwordx4 v65, s[20:23], s74 offen offset:1024 lds
ds_read_b128 a[204:207], v69 offset:2048
v_mfma_f32_16x16x32_bf16 v[28:31], v[128:131], a[164:167], v[28:31]
ds_read_b64_tr_b16 v[126:127], v165 offset:19968
s_waitcnt lgkmcnt(12)
v_mfma_f32_16x16x32_bf16 v[32:35], v[144:147], a[160:163], v[32:35]
ds_read_b64_tr_b16 v[128:129], v166 offset:16384
v_mfma_f32_16x16x32_bf16 v[32:35], v[148:151], a[168:171], v[32:35]
ds_read_b64_tr_b16 v[130:131], v166 offset:16896
ds_read_b64_tr_b16 v[132:133], v166 offset:17408
v_mfma_f32_16x16x32_bf16 v[32:35], v[152:155], a[176:179], v[32:35]
buffer_load_dwordx4 v66, s[20:23], s74 offen offset:2048 lds
v_mfma_f32_16x16x32_bf16 v[32:35], v[156:159], a[184:187], v[32:35]
ds_read_b64_tr_b16 v[134:135], v166 offset:17920
v_mfma_f32_16x16x32_bf16 v[36:39], v[156:159], a[188:191], v[36:39]
ds_read_b64_tr_b16 v[136:137], v166 offset:18432
v_mfma_f32_16x16x32_bf16 v[36:39], v[152:155], a[180:183], v[36:39]
ds_read_b64_tr_b16 v[138:139], v166 offset:18944
ds_read_b64_tr_b16 v[140:141], v166 offset:19456
v_mfma_f32_16x16x32_bf16 v[36:39], v[148:151], a[172:175], v[36:39]
buffer_load_dwordx4 v67, s[20:23], s74 offen offset:3072 lds
v_mfma_f32_16x16x32_bf16 v[36:39], v[144:147], a[164:167], v[36:39]
ds_read_b64_tr_b16 v[142:143], v166 offset:19968
s_waitcnt lgkmcnt(8)
v_mfma_f32_16x16x32_bf16 v[40:43], v[112:115], a[160:163], v[40:43]
ds_read_b64_tr_b16 v[144:145], v167 offset:16384
v_mfma_f32_16x16x32_bf16 v[40:43], v[116:119], a[168:171], v[40:43]
ds_read_b64_tr_b16 v[146:147], v167 offset:16896
L_pad2:
s_cbranch_execz L_warm0
ds_read_b64_tr_b16 v[148:149], v167 offset:17408
s_add_u32 m0, s80, 32768
v_mfma_f32_16x16x32_bf16 v[40:43], v[120:123], a[176:179], v[40:43]
buffer_load_dwordx4 v234, s[24:27], s58 offen lds
v_mfma_f32_16x16x32_bf16 v[40:43], v[124:127], a[184:187], v[40:43]
ds_read_b64_tr_b16 v[150:151], v167 offset:17920
v_mfma_f32_16x16x32_bf16 v[44:47], v[124:127], a[188:191], v[44:47]
ds_read_b64_tr_b16 v[152:153], v167 offset:18432
v_mfma_f32_16x16x32_bf16 v[44:47], v[120:123], a[180:183], v[44:47]
ds_read_b64_tr_b16 v[154:155], v167 offset:18944
ds_read_b64_tr_b16 v[156:157], v167 offset:19456
v_mfma_f32_16x16x32_bf16 v[44:47], v[116:119], a[172:175], v[44:47]
buffer_load_dwordx4 v235, s[24:27], s58 offen offset:1024 lds
v_mfma_f32_16x16x32_bf16 v[44:47], v[112:115], a[164:167], v[44:47]
ds_read_b64_tr_b16 v[158:159], v167 offset:19968
s_waitcnt vmcnt(14) lgkmcnt(8)
s_barrier
v_mfma_f32_16x16x32_bf16 v[48:51], v[128:131], a[160:163], v[48:51]
ds_read_b64_tr_b16 v[112:113], v160 offset:0
v_mfma_f32_16x16x32_bf16 v[48:51], v[132:135], a[168:171], v[48:51]
ds_read_b64_tr_b16 v[114:115], v160 offset:512
ds_read_b64_tr_b16 v[116:117], v160 offset:1024
v_mfma_f32_16x16x32_bf16 v[48:51], v[136:139], a[176:179], v[48:51]
buffer_load_dwordx4 v234, s[24:27], s59 offen offset:2048 lds
v_mfma_f32_16x16x32_bf16 v[48:51], v[140:143], a[184:187], v[48:51]
ds_read_b64_tr_b16 v[118:119], v160 offset:1536
s_waitcnt vmcnt(11)
ds_read_b128 a[208:211], v68 offset:16384
s_add_u32 m0, s80, 147456
s_cmp_lg_u32 s1, 7
s_cbranch_scc1 L_cond7
buffer_load_dwordx4 v234, s[24:27], s90 offen offset:0 lds
buffer_load_dwordx4 v235, s[24:27], s90 offen offset:1024 lds
buffer_load_dwordx4 v234, s[24:27], s91 offen offset:2048 lds
buffer_load_dwordx4 v235, s[24:27], s91 offen offset:3072 lds
buffer_load_dword v87, v88, s[36:39], s92 offen
buffer_load_dword v87, v89, s[36:39], s92 offen
s_call_b64 s[6:7], L_warmsub
L_cond7:
v_mfma_f32_16x16x32_bf16 v[52:55], v[140:143], a[188:191], v[52:55]
ds_read_b64_tr_b16 v[120:121], v160 offset:2048
ds_read_b128 a[212:215], v68 offset:18432
v_mfma_f32_16x16x32_bf16 v[52:55], v[136:139], a[180:183], v[52:55]
ds_read_b64_tr_b16 v[122:123], v160 offset:2560
ds_read_b64_tr_b16 v[124:125], v160 offset:3072
s_add_u32 m0, s80, 32768
v_mfma_f32_16x16x32_bf16 v[52:55], v[132:135], a[172:175], v[52:55]
buffer_load_dwordx4 v235, s[24:27], s59 offen offset:3072 lds
v_mfma_f32_16x16x32_bf16 v[52:55], v[128:131], a[164:167], v[52:55]
ds_read_b64_tr_b16 v[126:127], v160 offset:3584
s_waitcnt lgkmcnt(10)
v_mfma_f32_16x16x32_bf16 v[56:59], v[144:147], a[160:163], v[56:59]
ds_read_b64_tr_b16 v[128:129], v161 offset:0
ds_read_b128 a[216:219], v69 offset:16384
v_mfma_f32_16x16x32_bf16 v[56:59], v[148:151], a[168:171], v[56:59]
ds_read_b64_tr_b16 v[130:131], v161 offset:512
ds_read_b64_tr_b16 v[132:133], v161 offset:1024
s_add_u32 m0, s80, 98304
v_mfma_f32_16x16x32_bf16 v[56:59], v[152:155], a[176:179], v[56:59]
buffer_load_dwordx4 v64, s[20:23], s75 offen lds
ds_read_b128 a[220:223], v69 offset:18432
v_mfma_f32_16x16x32_bf16 v[56:59], v[156:159], a[184:187], v[56:59]
ds_read_b64_tr_b16 v[134:135], v161 offset:1536
v_mfma_f32_16x16x32_bf16 v[60:63], v[156:159], a[188:191], v[60:63]
ds_read_b64_tr_b16 v[136:137], v161 offset:2048
v_mfma_f32_16x16x32_bf16 v[60:63], v[152:155], a[180:183], v[60:63]
ds_read_b64_tr_b16 v[138:139], v161 offset:2560
ds_read_b64_tr_b16 v[140:141], v161 offset:3072
v_mfma_f32_16x16x32_bf16 v[60:63], v[148:151], a[172:175], v[60:63]
buffer_load_dwordx4 v65, s[20:23], s75 offen offset:1024 lds
v_mfma_f32_16x16x32_bf16 v[60:63], v[144:147], a[164:167], v[60:63]
ds_read_b64_tr_b16 v[142:143], v161 offset:3584
s_waitcnt lgkmcnt(5)
v_mfma_f32_16x16x32_bf16 v[0:3], v[112:115], a[192:195], v[0:3]
ds_read_b64_tr_b16 v[144:145], v162 offset:0
ds_read_b64_tr_b16 v[146:147], v162 offset:512
v_mfma_f32_16x16x32_bf16 v[0:3], v[116:119], a[200:203], v[0:3]
buffer_load_dwordx4 v[188:191], v239, s[40:43], s86 offen sc1
v_mfma_f32_16x16x32_bf16 v[0:3], v[120:123], a[208:211], v[0:3]
ds_read_b64_tr_b16 v[148:149], v162 offset:1024
ds_read_b64_tr_b16 v[150:151], v162 offset:1536
v_mfma_f32_16x16x32_bf16 v[0:3], v[124:127], a[216:219], v[0:3]
buffer_load_dwordx4 v[172:175], v239, s[40:43], s87 offen offset:0 sc1
v_mfma_f32_16x16x32_bf16 v[4:7], v[124:127], a[220:223], v[4:7]
ds_read_b64_tr_b16 v[152:153], v162 offset:2048
ds_read_b64_tr_b16 v[154:155], v162 offset:2560
v_mfma_f32_16x16x32_bf16 v[4:7], v[120:123], a[212:215], v[4:7]
buffer_load_dwordx4 v[176:179], v239, s[40:43], s87 offen offset:1024 sc1
v_mfma_f32_16x16x32_bf16 v[4:7], v[116:119], a[204:207], v[4:7]
ds_read_b64_tr_b16 v[156:157], v162 offset:3072
v_mfma_f32_16x16x32_bf16 v[4:7], v[112:115], a[196:199], v[4:7]
ds_read_b64_tr_b16 v[158:159], v162 offset:3584
s_waitcnt lgkmcnt(8)
v_mfma_f32_16x16x32_bf16 v[8:11], v[128:131], a[192:195], v[8:11]
ds_read_b64_tr_b16 v[112:113], v163 offset:0
ds_read_b64_tr_b16 v[114:115], v163 offset:512
v_mfma_f32_16x16x32_bf16 v[8:11], v[132:135], a[200:203], v[8:11]
buffer_load_dwordx4 v[180:183], v239, s[40:43], s87 offen offset:2048 sc1
v_mfma_f32_16x16x32_bf16 v[8:11], v[136:139], a[208:211], v[8:11]
ds_read_b64_tr_b16 v[116:117], v163 offset:1024
ds_read_b64_tr_b16 v[118:119], v163 offset:1536
v_mfma_f32_16x16x32_bf16 v[8:11], v[140:143], a[216:219], v[8:11]
buffer_load_dwordx4 v[184:187], v239, s[40:43], s87 offen offset:3072 sc1
v_mfma_f32_16x16x32_bf16 v[12:15], v[140:143], a[220:223], v[12:15]
ds_read_b64_tr_b16 v[120:121], v163 offset:2048
ds_read_b64_tr_b16 v[122:123], v163 offset:2560
v_mfma_f32_16x16x32_bf16 v[12:15], v[136:139], a[212:215], v[12:15]
buffer_load_dwordx4 v66, s[20:23], s75 offen offset:2048 lds
v_mfma_f32_16x16x32_bf16 v[12:15], v[132:135], a[204:207], v[12:15]
ds_read_b64_tr_b16 v[124:125], v163 offset:3072
ds_read_b64_tr_b16 v[126:127], v163 offset:3584
v_mfma_f32_16x16x32_bf16 v[12:15], v[128:131], a[196:199], v[12:15]
s_waitcnt vmcnt(16) lgkmcnt(8)
s_barrier
v_mfma_f32_16x16x32_bf16 v[16:19], v[144:147], a[192:195], v[16:19]
ds_read_b64_tr_b16 v[128:129], v160 offset:16384
ds_read_b64_tr_b16 v[130:131], v160 offset:16896
v_mfma_f32_16x16x32_bf16 v[16:19], v[148:151], a[200:203], v[16:19]
buffer_load_dwordx4 v67, s[20:23], s75 offen offset:3072 lds
v_mfma_f32_16x16x32_bf16 v[16:19], v[152:155], a[208:211], v[16:19]
ds_read_b64_tr_b16 v[132:133], v160 offset:17408
v_mfma_f32_16x16x32_bf16 v[16:19], v[156:159], a[216:219], v[16:19]
ds_read_b64_tr_b16 v[134:135], v160 offset:17920
v_mfma_f32_16x16x32_bf16 v[20:23], v[156:159], a[220:223], v[20:23]
ds_read_b64_tr_b16 v[136:137], v160 offset:18432
ds_read_b64_tr_b16 v[138:139], v160 offset:18944
s_add_u32 m0, s80, 49152
v_mfma_f32_16x16x32_bf16 v[20:23], v[152:155], a[212:215], v[20:23]
buffer_load_dwordx4 v234, s[28:31], s58 offen lds
v_mfma_f32_16x16x32_bf16 v[20:23], v[148:151], a[204:207], v[20:23]
ds_read_b64_tr_b16 v[140:141], v160 offset:19456
s_waitcnt vmcnt(14)
ds_read_b128 a[224:227], v68 offset:32768
v_mfma_f32_16x16x32_bf16 v[20:23], v[144:147], a[196:199], v[20:23]
ds_read_b64_tr_b16 v[142:143], v160 offset:19968
s_waitcnt lgkmcnt(9)
v_mfma_f32_16x16x32_bf16 v[24:27], v[112:115], a[192:195], v[24:27]
ds_read_b64_tr_b16 v[144:145], v161 offset:16384
ds_read_b64_tr_b16 v[146:147], v161 offset:16896
v_mfma_f32_16x16x32_bf16 v[24:27], v[116:119], a[200:203], v[24:27]
buffer_load_dwordx4 v235, s[28:31], s58 offen offset:1024 lds
v_mfma_f32_16x16x32_bf16 v[24:27], v[120:123], a[208:211], v[24:27]
ds_read_b64_tr_b16 v[148:149], v161 offset:17408
ds_read_b128 a[228:231], v68 offset:34816
v_mfma_f32_16x16x32_bf16 v[24:27], v[124:127], a[216:219], v[24:27]
ds_read_b64_tr_b16 v[150:151], v161 offset:17920
ds_read_b128 a[232:235], v69 offset:32768
v_mfma_f32_16x16x32_bf16 v[28:31], v[124:127], a[220:223], v[28:31]
ds_read_b64_tr_b16 v[152:153], v161 offset:18432
ds_read_b64_tr_b16 v[154:155], v161 offset:18944
v_mfma_f32_16x16x32_bf16 v[28:31], v[120:123], a[212:215], v[28:31]
buffer_load_dwordx4 v234, s[28:31], s59 offen offset:2048 lds
v_mfma_f32_16x16x32_bf16 v[28:31], v[116:119], a[204:207], v[28:31]
ds_read_b64_tr_b16 v[156:157], v161 offset:19456
ds_read_b128 a[236:239], v69 offset:34816
v_mfma_f32_16x16x32_bf16 v[28:31], v[112:115], a[196:199], v[28:31]
ds_read_b64_tr_b16 v[158:159], v161 offset:19968
s_waitcnt lgkmcnt(11)
v_mfma_f32_16x16x32_bf16 v[32:35], v[128:131], a[192:195], v[32:35]
ds_read_b64_tr_b16 v[112:113], v162 offset:16384
ds_read_b64_tr_b16 v[114:115], v162 offset:16896
v_mfma_f32_16x16x32_bf16 v[32:35], v[132:135], a[200:203], v[32:35]
buffer_load_dwordx4 v235, s[28:31], s59 offen offset:3072 lds
v_mfma_f32_16x16x32_bf16 v[32:35], v[136:139], a[208:211], v[32:35]
ds_read_b64_tr_b16 v[116:117], v162 offset:17408
v_mfma_f32_16x16x32_bf16 v[32:35], v[140:143], a[216:219], v[32:35]
ds_read_b64_tr_b16 v[118:119], v162 offset:17920
s_lshl_b32 s82, s16, 4
v_mfma_f32_16x16x32_bf16 v[36:39], v[140:143], a[220:223], v[36:39]
ds_read_b64_tr_b16 v[120:121], v162 offset:18432
ds_read_b64_tr_b16 v[122:123], v162 offset:18944
s_add_u32 s24, s24, 256
s_addc_u32 s25, s25, 0
s_sub_u32 s26, s26, 256
s_add_u32 m0, s80, 65536
v_mfma_f32_16x16x32_bf16 v[36:39], v[136:139], a[212:215], v[36:39]
buffer_load_dwordx4 v234, s[24:27], s44 offen lds
v_mfma_f32_16x16x32_bf16 v[36:39], v[132:135], a[204:207], v[36:39]
ds_read_b64_tr_b16 v[124:125], v162 offset:19456
s_and_b32 s83, s79, 12
v_mfma_f32_16x16x32_bf16 v[36:39], v[128:131], a[196:199], v[36:39]
ds_read_b64_tr_b16 v[126:127], v162 offset:19968
s_waitcnt lgkmcnt(8)
v_mfma_f32_16x16x32_bf16 v[40:43], v[144:147], a[192:195], v[40:43]
ds_read_b64_tr_b16 v[128:129], v163 offset:16384
ds_read_b64_tr_b16 v[130:131], v163 offset:16896
v_mfma_f32_16x16x32_bf16 v[40:43], v[148:151], a[200:203], v[40:43]
buffer_load_dwordx4 v235, s[24:27], s44 offen offset:1024 lds
v_mfma_f32_16x16x32_bf16 v[40:43], v[152:155], a[208:211], v[40:43]
ds_read_b64_tr_b16 v[132:133], v163 offset:17408
s_add_u32 s82, s82, s83
v_mfma_f32_16x16x32_bf16 v[40:43], v[156:159], a[216:219], v[40:43]
ds_read_b64_tr_b16 v[134:135], v163 offset:17920
v_mfma_f32_16x16x32_bf16 v[44:47], v[156:159], a[220:223], v[44:47]
ds_read_b64_tr_b16 v[136:137], v163 offset:18432
ds_read_b64_tr_b16 v[138:139], v163 offset:18944
v_mfma_f32_16x16x32_bf16 v[44:47], v[152:155], a[212:215], v[44:47]
buffer_load_dwordx4 v234, s[24:27], s45 offen offset:2048 lds
v_mfma_f32_16x16x32_bf16 v[44:47], v[148:151], a[204:207], v[44:47]
ds_read_b64_tr_b16 v[140:141], v163 offset:19456
ds_read_b64_tr_b16 v[142:143], v163 offset:19968
v_mfma_f32_16x16x32_bf16 v[44:47], v[144:147], a[196:199], v[44:47]
s_lshl_b32 s82, s82, 15
s_waitcnt vmcnt(16)
s_waitcnt lgkmcnt(8)
s_barrier
v_mfma_f32_16x16x32_bf16 v[48:51], v[112:115], a[192:195], v[48:51]
ds_read_b64_tr_b16 v[144:145], v160 offset:32768
ds_read_b64_tr_b16 v[146:147], v160 offset:33280
v_mfma_f32_16x16x32_bf16 v[48:51], v[116:119], a[200:203], v[48:51]
buffer_load_dwordx4 v235, s[24:27], s45 offen offset:3072 lds
v_mfma_f32_16x16x32_bf16 v[48:51], v[120:123], a[208:211], v[48:51]
ds_read_b64_tr_b16 v[148:149], v160 offset:33792
s_waitcnt vmcnt(8)
ds_read_b128 a[240:243], v68 offset:0
v_mfma_f32_16x16x32_bf16 v[48:51], v[124:127], a[216:219], v[48:51]
ds_read_b64_tr_b16 v[150:151], v160 offset:34304
ds_read_b128 a[244:247], v68 offset:2048
v_mfma_f32_16x16x32_bf16 v[52:55], v[124:127], a[220:223], v[52:55]
ds_read_b64_tr_b16 v[152:153], v160 offset:34816
ds_read_b128 a[248:251], v69 offset:0
v_mfma_f32_16x16x32_bf16 v[52:55], v[120:123], a[212:215], v[52:55]
ds_read_b64_tr_b16 v[154:155], v160 offset:35328
ds_read_b128 a[252:255], v69 offset:2048
v_mfma_f32_16x16x32_bf16 v[52:55], v[116:119], a[204:207], v[52:55]
ds_read_b64_tr_b16 v[156:157], v160 offset:35840
ds_read_b64_tr_b16 v[204:205], v72 offset:0
v_mfma_f32_16x16x32_bf16 v[52:55], v[112:115], a[196:199], v[52:55]
ds_read_b64_tr_b16 v[158:159], v160 offset:36352
s_waitcnt lgkmcnt(13)
v_mfma_f32_16x16x32_bf16 v[56:59], v[128:131], a[192:195], v[56:59]
ds_read_b64_tr_b16 v[112:113], v161 offset:32768
ds_read_b64_tr_b16 v[206:207], v72 offset:512
v_mfma_f32_16x16x32_bf16 v[56:59], v[132:135], a[200:203], v[56:59]
ds_read_b64_tr_b16 v[114:115], v161 offset:33280
ds_read_b64_tr_b16 v[208:209], v72 offset:1024
v_mfma_f32_16x16x32_bf16 v[56:59], v[136:139], a[208:211], v[56:59]
ds_read_b64_tr_b16 v[116:117], v161 offset:33792
ds_read_b64_tr_b16 v[210:211], v72 offset:1536
v_mfma_f32_16x16x32_bf16 v[56:59], v[140:143], a[216:219], v[56:59]
ds_read_b64_tr_b16 v[118:119], v161 offset:34304
ds_read_b64_tr_b16 v[212:213], v73 offset:0
v_mfma_f32_16x16x32_bf16 v[60:63], v[140:143], a[220:223], v[60:63]
ds_read_b64_tr_b16 v[120:121], v161 offset:34816
ds_read_b64_tr_b16 v[214:215], v73 offset:512
v_mfma_f32_16x16x32_bf16 v[60:63], v[136:139], a[212:215], v[60:63]
ds_read_b64_tr_b16 v[122:123], v161 offset:35328
ds_read_b64_tr_b16 v[216:217], v73 offset:1024
v_mfma_f32_16x16x32_bf16 v[60:63], v[132:135], a[204:207], v[60:63]
ds_read_b64_tr_b16 v[124:125], v161 offset:35840
ds_read_b64_tr_b16 v[218:219], v73 offset:1536
v_mfma_f32_16x16x32_bf16 v[60:63], v[128:131], a[196:199], v[60:63]
ds_read_b64_tr_b16 v[126:127], v161 offset:36352
s_waitcnt lgkmcnt(15)
v_mfma_f32_16x16x32_bf16 v[0:3], v[144:147], a[224:227], v[0:3]
ds_read_b64_tr_b16 v[128:129], v162 offset:32768
ds_read_b64_tr_b16 v[130:131], v162 offset:33280
s_add_u32 m0, s80, 81920
v_mfma_f32_16x16x32_bf16 v[0:3], v[148:151], a[232:235], v[0:3]
buffer_load_dwordx4 v234, s[24:27], s46 offen lds
v_mfma_f32_16x16x32_bf16 v[0:3], v[152:155], a[240:243], v[0:3]
ds_read_b64_tr_b16 v[132:133], v162 offset:33792
ds_read_b64_tr_b16 v[134:135], v162 offset:34304
v_mfma_f32_16x16x32_bf16 v[0:3], v[156:159], a[248:251], v[0:3]
buffer_load_dwordx4 v235, s[24:27], s46 offen offset:1024 lds
v_mfma_f32_16x16x32_bf16 v[4:7], v[156:159], a[252:255], v[4:7]
ds_read_b64_tr_b16 v[136:137], v162 offset:34816
ds_read_b64_tr_b16 v[138:139], v162 offset:35328
v_mfma_f32_16x16x32_bf16 v[4:7], v[152:155], a[244:247], v[4:7]
buffer_load_dwordx4 v234, s[24:27], s47 offen offset:2048 lds
v_mfma_f32_16x16x32_bf16 v[4:7], v[148:151], a[236:239], v[4:7]
ds_read_b64_tr_b16 v[140:141], v162 offset:35840
s_add_u32 s8, s82, 2097152
v_mfma_f32_16x16x32_bf16 v[4:7], v[144:147], a[228:231], v[4:7]
ds_read_b64_tr_b16 v[142:143], v162 offset:36352
s_waitcnt lgkmcnt(8)
v_mfma_f32_16x16x32_bf16 v[8:11], v[112:115], a[224:227], v[8:11]
ds_read_b64_tr_b16 v[144:145], v163 offset:32768
ds_read_b64_tr_b16 v[146:147], v163 offset:33280
v_mfma_f32_16x16x32_bf16 v[8:11], v[116:119], a[232:235], v[8:11]
buffer_load_dwordx4 v235, s[24:27], s47 offen offset:3072 lds
v_mfma_f32_16x16x32_bf16 v[8:11], v[120:123], a[240:243], v[8:11]
ds_read_b64_tr_b16 v[148:149], v163 offset:33792
s_add_u32 s9, s82, 2129920
v_mfma_f32_16x16x32_bf16 v[8:11], v[124:127], a[248:251], v[8:11]
ds_read_b64_tr_b16 v[150:151], v163 offset:34304
s_add_u32 s10, s82, 2162688
v_dot2_f32_bf16 v76, v204, s81, 0
v_dot2_f32_bf16 v76, v205, s81, v76
v_dot2_f32_bf16 v76, v206, s81, v76
v_dot2_f32_bf16 v76, v207, s81, v76
v_dot2_f32_bf16 v76, v208, s81, v76
v_dot2_f32_bf16 v76, v209, s81, v76
v_dot2_f32_bf16 v76, v210, s81, v76
v_dot2_f32_bf16 v76, v211, s81, v76
v_dot2_f32_bf16 v77, v212, s81, 0
v_dot2_f32_bf16 v77, v213, s81, v77
v_dot2_f32_bf16 v77, v214, s81, v77
v_dot2_f32_bf16 v77, v215, s81, v77
v_dot2_f32_bf16 v77, v216, s81, v77
v_dot2_f32_bf16 v77, v217, s81, v77
v_dot2_f32_bf16 v77, v218, s81, v77
v_dot2_f32_bf16 v77, v219, s81, v77
v_mfma_f32_16x16x32_bf16 v[12:15], v[124:127], a[252:255], v[12:15]
ds_read_b64_tr_b16 v[152:153], v163 offset:34816
ds_read_b64_tr_b16 v[154:155], v163 offset:35328
s_sub_u32 s28, s28, 128
s_subb_u32 s29, s29, 0
s_add_u32 s30, s30, 128
s_add_u32 m0, s80, 0
v_mfma_f32_16x16x32_bf16 v[12:15], v[120:123], a[244:247], v[12:15]
buffer_load_dwordx4 v236, s[28:31], s44 offen lds
v_mfma_f32_16x16x32_bf16 v[12:15], v[116:119], a[236:239], v[12:15]
ds_read_b64_tr_b16 v[156:157], v163 offset:35840
ds_read_b64_tr_b16 v[158:159], v163 offset:36352
v_mfma_f32_16x16x32_bf16 v[12:15], v[112:115], a[228:231], v[12:15]
v_permlane16_swap_b32 v76, v77
s_waitcnt vmcnt(9) lgkmcnt(8)
s_barrier
v_mfma_f32_16x16x32_bf16 v[16:19], v[128:131], a[224:227], v[16:19]
ds_read_b64_tr_b16 v[112:113], v160 offset:49152
v_add_f32 v76, v76, v77
v_mfma_f32_16x16x32_bf16 v[16:19], v[132:135], a[232:235], v[16:19]
ds_read_b64_tr_b16 v[114:115], v160 offset:49664
v_xor_b32 v189, v189, v242
v_mfma_f32_16x16x32_bf16 v[16:19], v[136:139], a[240:243], v[16:19]
ds_read_b64_tr_b16 v[116:117], v160 offset:50176
v_mov_b32 v77, v76
v_mfma_f32_16x16x32_bf16 v[16:19], v[140:143], a[248:251], v[16:19]
ds_read_b64_tr_b16 v[118:119], v160 offset:50688
v_bitop3_b32 v189, v189, v191, v242 bitop3:0xf6
v_mfma_f32_16x16x32_bf16 v[20:23], v[140:143], a[252:255], v[20:23]
ds_read_b64_tr_b16 v[120:121], v160 offset:51200
ds_read_b64_tr_b16 v[122:123], v160 offset:51712
s_add_u32 s45, s45, 1024
v_mfma_f32_16x16x32_bf16 v[20:23], v[136:139], a[244:247], v[20:23]
buffer_load_dwordx4 v236, s[28:31], s45 offen offset:1024 lds
v_mfma_f32_16x16x32_bf16 v[20:23], v[132:135], a[236:239], v[20:23]
ds_read_b64_tr_b16 v[124:125], v160 offset:52224
v_permlane32_swap_b32 v76, v77
v_mfma_f32_16x16x32_bf16 v[20:23], v[128:131], a[228:231], v[20:23]
ds_read_b64_tr_b16 v[126:127], v160 offset:52736
s_waitcnt lgkmcnt(8)
v_mfma_f32_16x16x32_bf16 v[24:27], v[144:147], a[224:227], v[24:27]
ds_read_b64_tr_b16 v[128:129], v161 offset:49152
v_add_f32 v76, v76, v77
v_mfma_f32_16x16x32_bf16 v[24:27], v[148:151], a[232:235], v[24:27]
ds_read_b64_tr_b16 v[130:131], v161 offset:49664
v_xor_b32 v173, v173, v242
v_mfma_f32_16x16x32_bf16 v[24:27], v[152:155], a[240:243], v[24:27]
ds_read_b64_tr_b16 v[132:133], v161 offset:50176
v_mov_b32 v77, v242
v_mfma_f32_16x16x32_bf16 v[24:27], v[156:159], a[248:251], v[24:27]
ds_read_b64_tr_b16 v[134:135], v161 offset:50688
v_bitop3_b32 v173, v173, v175, v242 bitop3:0xf6
v_mfma_f32_16x16x32_bf16 v[28:31], v[156:159], a[252:255], v[28:31]
ds_read_b64_tr_b16 v[136:137], v161 offset:51200
buffer_store_dwordx2 v[76:77], v84, s[40:43], s17 offen sc1
v_mfma_f32_16x16x32_bf16 v[28:31], v[152:155], a[244:247], v[28:31]
ds_read_b64_tr_b16 v[138:139], v161 offset:51712
v_bitop3_b32 v173, v173, v177, v242 bitop3:0xf6
v_mfma_f32_16x16x32_bf16 v[28:31], v[148:151], a[236:239], v[28:31]
ds_read_b64_tr_b16 v[140:141], v161 offset:52224
v_bitop3_b32 v173, v173, v179, v242 bitop3:0xf6
v_mfma_f32_16x16x32_bf16 v[28:31], v[144:147], a[228:231], v[28:31]
ds_read_b64_tr_b16 v[142:143], v161 offset:52736
s_waitcnt lgkmcnt(8)
v_mfma_f32_16x16x32_bf16 v[32:35], v[112:115], a[224:227], v[32:35]
ds_read_b64_tr_b16 v[144:145], v162 offset:49152
ds_read_b64_tr_b16 v[146:147], v162 offset:49664
s_add_u32 s46, s46, 4294965248
v_bitop3_b32 v173, v173, v181, v242 bitop3:0xf6
v_mfma_f32_16x16x32_bf16 v[32:35], v[116:119], a[232:235], v[32:35]
buffer_load_dwordx4 v236, s[28:31], s46 offen offset:2048 lds
v_bitop3_b32 v173, v173, v183, v242 bitop3:0xf6
v_mfma_f32_16x16x32_bf16 v[32:35], v[120:123], a[240:243], v[32:35]
ds_read_b64_tr_b16 v[148:149], v162 offset:50176
v_bitop3_b32 v173, v173, v185, v242 bitop3:0xf6
v_bitop3_b32 v173, v173, v187, v242 bitop3:0xf6
v_mfma_f32_16x16x32_bf16 v[32:35], v[124:127], a[248:251], v[32:35]
ds_read_b64_tr_b16 v[150:151], v162 offset:50688
v_cmp_ne_u32 vcc, 0, v173
s_cbranch_vccnz L_slow0
L_back0:
v_mfma_f32_16x16x32_bf16 v[36:39], v[124:127], a[252:255], v[36:39]
ds_read_b64_tr_b16 v[152:153], v162 offset:51200
v_add_f32 v172, v172, v176
v_add_f32 v174, v174, v178
v_mfma_f32_16x16x32_bf16 v[36:39], v[120:123], a[244:247], v[36:39]
ds_read_b64_tr_b16 v[154:155], v162 offset:51712
v_add_f32 v180, v180, v184
v_add_f32 v182, v182, v186
v_mfma_f32_16x16x32_bf16 v[36:39], v[116:119], a[236:239], v[36:39]
ds_read_b64_tr_b16 v[156:157], v162 offset:52224
v_add_f32 v172, v172, v180
v_add_f32 v174, v174, v182
v_mfma_f32_16x16x32_bf16 v[36:39], v[112:115], a[228:231], v[36:39]
ds_read_b64_tr_b16 v[158:159], v162 offset:52736
v_lshlrev_b32 v80, 16, v80
s_waitcnt lgkmcnt(8)
v_mfma_f32_16x16x32_bf16 v[40:43], v[128:131], a[224:227], v[40:43]
ds_read_b64_tr_b16 v[112:113], v163 offset:49152
ds_read_b64_tr_b16 v[114:115], v163 offset:49664
s_add_u32 s47, s47, 4294966272
v_mul_f32 v80, s77, v80
v_mfma_f32_16x16x32_bf16 v[40:43], v[132:135], a[232:235], v[40:43]
buffer_load_dwordx4 v236, s[28:31], s47 offen offset:3072 lds
v_permlane16_swap_b32 v172, v174
v_mfma_f32_16x16x32_bf16 v[40:43], v[136:139], a[240:243], v[40:43]
ds_read_b64_tr_b16 v[116:117], v163 offset:50176
v_add_f32 v172, v172, v174
v_mov_b32 v174, v172
v_mfma_f32_16x16x32_bf16 v[40:43], v[140:143], a[248:251], v[40:43]
ds_read_b64_tr_b16 v[118:119], v163 offset:50688
ds_write_b32 v249, v80 offset:1024
v_permlane32_swap_b32 v172, v174
v_mfma_f32_16x16x32_bf16 v[44:47], v[140:143], a[252:255], v[44:47]
ds_read_b64_tr_b16 v[120:121], v163 offset:51200
v_add_f32 v172, v172, v174
v_mfma_f32_16x16x32_bf16 v[44:47], v[136:139], a[244:247], v[44:47]
ds_read_b64_tr_b16 v[122:123], v163 offset:51712
ds_write_b32 v249, v172 offset:0
v_cmp_ne_u32 vcc, 0, v189
s_cbranch_vccnz L_slow1
L_back1:
v_mfma_f32_16x16x32_bf16 v[44:47], v[132:135], a[236:239], v[44:47]
ds_read_b64_tr_b16 v[124:125], v163 offset:52224
ds_read_b64_tr_b16 v[126:127], v163 offset:52736
v_permlane32_swap_b32 v188, v190
v_mfma_f32_16x16x32_bf16 v[44:47], v[128:131], a[228:231], v[44:47]
v_add_f32 v188, v188, v190
v_mul_f32 v188, 0x3a800000, v188
s_waitcnt lgkmcnt(2)
s_waitcnt vmcnt(5)
s_barrier
v_mfma_f32_16x16x32_bf16 v[48:51], v[144:147], a[224:227], v[48:51]
ds_read_b64_tr_b16 v[128:129], v164 offset:0
ds_read_b64_tr_b16 v[130:131], v164 offset:512
s_add_u32 m0, s80, 98304
v_mov_b32 v189, v188
v_mfma_f32_16x16x32_bf16 v[48:51], v[148:151], a[232:235], v[48:51]
buffer_load_dwordx4 v234, s[24:27], s48 offen lds
v_permlane32_swap_b32 v188, v189
v_mfma_f32_16x16x32_bf16 v[48:51], v[152:155], a[240:243], v[48:51]
ds_read_b64_tr_b16 v[132:133], v164 offset:1024
v_fma_f32 v189, -v188, v188, v189
v_max_f32 v189, 0, v189
v_mfma_f32_16x16x32_bf16 v[48:51], v[156:159], a[248:251], v[48:51]
ds_read_b64_tr_b16 v[134:135], v164 offset:1536
v_add_f32 v189, 0x3727c5ac, v189
v_rsq_f32 v228, v189
v_mfma_f32_16x16x32_bf16 v[52:55], v[156:159], a[252:255], v[52:55]
ds_read_b64_tr_b16 v[136:137], v164 offset:2048
ds_read_b64_tr_b16 v[138:139], v164 offset:2560
v_mfma_f32_16x16x32_bf16 v[52:55], v[152:155], a[244:247], v[52:55]
buffer_load_dwordx4 v235, s[24:27], s48 offen offset:1024 lds
v_mul_f32 v228, s77, v228
v_mfma_f32_16x16x32_bf16 v[52:55], v[148:151], a[236:239], v[52:55]
ds_read_b64_tr_b16 v[140:141], v164 offset:3072
v_mul_f32 v230, -v188, v228
v_mfma_f32_16x16x32_bf16 v[52:55], v[144:147], a[228:231], v[52:55]
ds_read_b64_tr_b16 v[142:143], v164 offset:3584
s_waitcnt lgkmcnt(8)
v_mfma_f32_16x16x32_bf16 v[56:59], v[112:115], a[224:227], v[56:59]
ds_read_b64_tr_b16 v[144:145], v165 offset:0
ds_read_b64_tr_b16 v[146:147], v165 offset:512
v_mov_b32 v229, v228
v_mfma_f32_16x16x32_bf16 v[56:59], v[116:119], a[232:235], v[56:59]
buffer_load_dwordx4 v234, s[24:27], s49 offen offset:2048 lds
v_mfma_f32_16x16x32_bf16 v[56:59], v[120:123], a[240:243], v[56:59]
ds_read_b64_tr_b16 v[148:149], v165 offset:1024
v_mov_b32 v231, v230
v_mfma_f32_16x16x32_bf16 v[56:59], v[124:127], a[248:251], v[56:59]
ds_read_b64_tr_b16 v[150:151], v165 offset:1536
v_permlane16_swap_b32 v228, v229
v_mfma_f32_16x16x32_bf16 v[60:63], v[124:127], a[252:255], v[60:63]
ds_read_b64_tr_b16 v[152:153], v165 offset:2048
ds_read_b64_tr_b16 v[154:155], v165 offset:2560
v_mfma_f32_16x16x32_bf16 v[60:63], v[120:123], a[244:247], v[60:63]
buffer_load_dwordx4 v235, s[24:27], s49 offen offset:3072 lds
v_permlane16_swap_b32 v230, v231
s_add_u32 s11, s82, 2195456
s_mov_b32 s60, 4096
s_mov_b32 s61, 527360
s_mov_b32 s62, 919552
s_mov_b32 s63, 1442816
s_mov_b32 s64, 69632
s_mov_b32 s65, 592896
v_mfma_f32_16x16x32_bf16 v[60:63], v[116:119], a[236:239], v[60:63]
ds_read_b64_tr_b16 v[156:157], v165 offset:3072
s_mov_b32 s66, 985088
s_mov_b32 s67, 1508352
s_mov_b32 s68, 135168
s_mov_b32 s69, 658432
s_mov_b32 s70, 1050624
s_mov_b32 s71, 1573888
s_mov_b32 s72, 200704
s_mov_b32 s73, 723968
v_mfma_f32_16x16x32_bf16 v[60:63], v[112:115], a[228:231], v[60:63]
ds_read_b64_tr_b16 v[158:159], v165 offset:3584
s_mov_b32 s74, 1116160
s_mov_b32 s75, 1639424
s_mov_b32 s20, s14
s_waitcnt lgkmcnt(8)
v_mfma_f32_16x16x32_bf16 v[64:67], v[128:131], a[0:3], 0
ds_read_b64_tr_b16 v[112:113], v166 offset:0
s_mov_b32 s21, s15
s_mov_b32 s84, 0x8000
v_mfma_f32_16x16x32_bf16 v[64:67], v[132:135], a[8:11], v[64:67]
ds_read_b64_tr_b16 v[114:115], v166 offset:512
ds_read_b128 v[172:175], v245 offset:0
v_mfma_f32_16x16x32_bf16 v[64:67], v[136:139], a[16:19], v[64:67]
ds_read_b64_tr_b16 v[116:117], v166 offset:1024
ds_read_b128 v[180:183], v245 offset:1024
v_mfma_f32_16x16x32_bf16 v[64:67], v[140:143], a[24:27], v[64:67]
ds_read_b64_tr_b16 v[118:119], v166 offset:1536
v_mfma_f32_16x16x32_bf16 v[68:71], v[140:143], a[28:31], 0
ds_read_b64_tr_b16 v[120:121], v166 offset:2048
v_mfma_f32_16x16x32_bf16 v[68:71], v[136:139], a[20:23], v[68:71]
ds_read_b64_tr_b16 v[122:123], v166 offset:2560
ds_read_b64_tr_b16 v[124:125], v166 offset:3072
s_add_u32 m0, s80, 114688
v_mfma_f32_16x16x32_bf16 v[68:71], v[132:135], a[12:15], v[68:71]
buffer_load_dwordx4 v234, s[24:27], s50 offen lds
v_mfma_f32_16x16x32_bf16 v[68:71], v[128:131], a[4:7], v[68:71]
ds_read_b64_tr_b16 v[126:127], v166 offset:3584
ds_read_b128 v[176:179], v245 offset:64
s_waitcnt lgkmcnt(11)
v_mfma_f32_16x16x32_bf16 v[72:75], v[144:147], a[0:3], 0
ds_read_b64_tr_b16 v[128:129], v167 offset:0
ds_read_b128 v[184:187], v245 offset:1088
v_mfma_f32_16x16x32_bf16 v[72:75], v[148:151], a[8:11], v[72:75]
ds_read_b64_tr_b16 v[130:131], v167 offset:512
v_mfma_f32_16x16x32_bf16 v[72:75], v[152:155], a[16:19], v[72:75]
ds_read_b64_tr_b16 v[132:133], v167 offset:1024
v_mfma_f32_16x16x32_bf16 v[72:75], v[156:159], a[24:27], v[72:75]
ds_read_b64_tr_b16 v[134:135], v167 offset:1536
s_waitcnt lgkmcnt(11)
v_pk_fma_f32 v[188:189], v[230:231], v[172:173], v[180:181] op_sel:[0,0,0] op_sel_hi:[0,1,1]
v_pk_fma_f32 v[190:191], v[230:231], v[174:175], v[182:183] op_sel:[0,0,0] op_sel_hi:[0,1,1]
v_pk_fma_f32 v[192:193], v[230:231], v[172:173], v[180:181] op_sel:[1,0,0] op_sel_hi:[1,1,1]
v_pk_fma_f32 v[194:195], v[230:231], v[174:175], v[182:183] op_sel:[1,0,0] op_sel_hi:[1,1,1]
buffer_load_dwordx4 v235, s[24:27], s50 offen offset:1024 lds
s_waitcnt lgkmcnt(3)
v_pk_fma_f32 v[196:197], v[230:231], v[176:177], v[184:185] op_sel:[0,0,0] op_sel_hi:[0,1,1]
v_pk_fma_f32 v[198:199], v[230:231], v[178:179], v[186:187] op_sel:[0,0,0] op_sel_hi:[0,1,1]
v_pk_fma_f32 v[200:201], v[230:231], v[176:177], v[184:185] op_sel:[1,0,0] op_sel_hi:[1,1,1]
v_pk_fma_f32 v[202:203], v[230:231], v[178:179], v[186:187] op_sel:[1,0,0] op_sel_hi:[1,1,1]
v_pk_fma_f32 v[0:1], v[228:229], v[0:1], v[188:189] op_sel:[0,0,0] op_sel_hi:[0,1,1]
v_pk_fma_f32 v[2:3], v[228:229], v[2:3], v[190:191] op_sel:[0,0,0] op_sel_hi:[0,1,1]
v_pk_fma_f32 v[4:5], v[228:229], v[4:5], v[192:193] op_sel:[1,0,0] op_sel_hi:[1,1,1]
v_pk_fma_f32 v[6:7], v[228:229], v[6:7], v[194:195] op_sel:[1,0,0] op_sel_hi:[1,1,1]
v_pk_fma_f32 v[8:9], v[228:229], v[8:9], v[196:197] op_sel:[0,0,0] op_sel_hi:[0,1,1]
v_pk_fma_f32 v[10:11], v[228:229], v[10:11], v[198:199] op_sel:[0,0,0] op_sel_hi:[0,1,1]
v_pk_fma_f32 v[12:13], v[228:229], v[12:13], v[200:201] op_sel:[1,0,0] op_sel_hi:[1,1,1]
L_pad3:
s_cbranch_execz L_warm0
v_pk_fma_f32 v[14:15], v[228:229], v[14:15], v[202:203] op_sel:[1,0,0] op_sel_hi:[1,1,1]
v_pk_fma_f32 v[188:189], v[0:1], v[0:1], s[76:77] op_sel_hi:[1,1,0]
v_pk_fma_f32 v[190:191], v[2:3], v[2:3], s[76:77] op_sel_hi:[1,1,0]
v_pk_fma_f32 v[192:193], v[4:5], v[4:5], s[76:77] op_sel_hi:[1,1,0]
v_pk_fma_f32 v[194:195], v[6:7], v[6:7], s[76:77] op_sel_hi:[1,1,0]
buffer_load_dwordx4 v234, s[24:27], s51 offen offset:2048 lds
v_pk_fma_f32 v[196:197], v[8:9], v[8:9], s[76:77] op_sel_hi:[1,1,0]
v_pk_fma_f32 v[198:199], v[10:11], v[10:11], s[76:77] op_sel_hi:[1,1,0]
v_pk_fma_f32 v[200:201], v[12:13], v[12:13], s[76:77] op_sel_hi:[1,1,0]
v_pk_fma_f32 v[202:203], v[14:15], v[14:15], s[76:77] op_sel_hi:[1,1,0]
v_pk_mul_f32 v[188:189], v[188:189], v[0:1]
v_pk_mul_f32 v[190:191], v[190:191], v[2:3]
v_pk_mul_f32 v[192:193], v[192:193], v[4:5]
v_pk_mul_f32 v[194:195], v[194:195], v[6:7]
v_pk_mul_f32 v[196:197], v[196:197], v[8:9]
v_pk_mul_f32 v[198:199], v[198:199], v[10:11]
v_pk_mul_f32 v[200:201], v[200:201], v[12:13]
v_pk_mul_f32 v[202:203], v[202:203], v[14:15]
v_exp_f32 v188, v188
v_exp_f32 v189, v189
v_exp_f32 v190, v190
v_exp_f32 v191, v191
v_exp_f32 v192, v192
v_exp_f32 v193, v193
buffer_load_dwordx4 v235, s[24:27], s51 offen offset:3072 lds
v_exp_f32 v194, v194
v_exp_f32 v195, v195
v_exp_f32 v196, v196
v_exp_f32 v197, v197
v_exp_f32 v198, v198
v_exp_f32 v199, v199
v_exp_f32 v200, v200
v_exp_f32 v201, v201
v_exp_f32 v202, v202
v_exp_f32 v203, v203
v_pk_fma_f32 v[188:189], v[188:189], s[76:77], s[76:77] op_sel:[0,1,1] op_sel_hi:[1,1,1]
v_pk_fma_f32 v[190:191], v[190:191], s[76:77], s[76:77] op_sel:[0,1,1] op_sel_hi:[1,1,1]
v_pk_fma_f32 v[192:193], v[192:193], s[76:77], s[76:77] op_sel:[0,1,1] op_sel_hi:[1,1,1]
v_pk_fma_f32 v[194:195], v[194:195], s[76:77], s[76:77] op_sel:[0,1,1] op_sel_hi:[1,1,1]
s_add_u32 m0, s80, 16384
s_nop 0
buffer_load_dwordx4 v236, s[28:31], s48 offen lds
v_pk_fma_f32 v[196:197], v[196:197], s[76:77], s[76:77] op_sel:[0,1,1] op_sel_hi:[1,1,1]
v_pk_fma_f32 v[198:199], v[198:199], s[76:77], s[76:77] op_sel:[0,1,1] op_sel_hi:[1,1,1]
v_pk_fma_f32 v[200:201], v[200:201], s[76:77], s[76:77] op_sel:[0,1,1] op_sel_hi:[1,1,1]
v_pk_fma_f32 v[202:203], v[202:203], s[76:77], s[76:77] op_sel:[0,1,1] op_sel_hi:[1,1,1]
v_rcp_f32 v188, v188
v_rcp_f32 v189, v189
v_rcp_f32 v190, v190
v_rcp_f32 v191, v191
v_rcp_f32 v192, v192
v_rcp_f32 v193, v193
v_rcp_f32 v194, v194
v_rcp_f32 v195, v195
v_rcp_f32 v196, v196
v_rcp_f32 v197, v197
v_rcp_f32 v198, v198
v_rcp_f32 v199, v199
v_rcp_f32 v200, v200
v_rcp_f32 v201, v201
v_rcp_f32 v202, v202
v_rcp_f32 v203, v203
v_pk_mul_f32 v[0:1], v[0:1], v[188:189]
v_pk_mul_f32 v[2:3], v[2:3], v[190:191]
v_pk_mul_f32 v[4:5], v[4:5], v[192:193]
v_pk_mul_f32 v[6:7], v[6:7], v[194:195]
v_pk_mul_f32 v[8:9], v[8:9], v[196:197]
v_pk_mul_f32 v[10:11], v[10:11], v[198:199]
v_pk_mul_f32 v[12:13], v[12:13], v[200:201]
v_pk_mul_f32 v[14:15], v[14:15], v[202:203]
s_add_u32 s49, s49, 1024
buffer_load_dwordx4 v236, s[28:31], s49 offen offset:1024 lds
v_mfma_f32_16x16x32_bf16 v[76:79], v[156:159], a[28:31], 0
ds_read_b64_tr_b16 v[136:137], v167 offset:2048
v_cvt_pk_bf16_f32 v204, v0, v1
v_mfma_f32_16x16x32_bf16 v[76:79], v[152:155], a[20:23], v[76:79]
ds_read_b64_tr_b16 v[138:139], v167 offset:2560
v_cvt_pk_bf16_f32 v205, v2, v3
v_mfma_f32_16x16x32_bf16 v[76:79], v[148:151], a[12:15], v[76:79]
ds_read_b64_tr_b16 v[140:141], v167 offset:3072
v_cvt_pk_bf16_f32 v206, v8, v9
v_mfma_f32_16x16x32_bf16 v[76:79], v[144:147], a[4:7], v[76:79]
ds_read_b64_tr_b16 v[142:143], v167 offset:3584
v_mfma_f32_16x16x32_bf16 v[80:83], v[112:115], a[0:3], 0
ds_read_b64_tr_b16 v[144:145], v164 offset:16384
v_cvt_pk_bf16_f32 v207, v10, v11
v_mfma_f32_16x16x32_bf16 v[80:83], v[116:119], a[8:11], v[80:83]
ds_read_b64_tr_b16 v[146:147], v164 offset:16896
v_cvt_pk_bf16_f32 v208, v4, v5
v_mfma_f32_16x16x32_bf16 v[80:83], v[120:123], a[16:19], v[80:83]
ds_read_b64_tr_b16 v[148:149], v164 offset:17408
v_cvt_pk_bf16_f32 v209, v6, v7
v_mfma_f32_16x16x32_bf16 v[80:83], v[124:127], a[24:27], v[80:83]
ds_read_b64_tr_b16 v[150:151], v164 offset:17920
v_cvt_pk_bf16_f32 v210, v12, v13
v_mfma_f32_16x16x32_bf16 v[84:87], v[124:127], a[28:31], 0
ds_read_b64_tr_b16 v[152:153], v164 offset:18432
v_cvt_pk_bf16_f32 v211, v14, v15
v_mfma_f32_16x16x32_bf16 v[84:87], v[120:123], a[20:23], v[84:87]
ds_read_b64_tr_b16 v[154:155], v164 offset:18944
v_mfma_f32_16x16x32_bf16 v[84:87], v[116:119], a[12:15], v[84:87]
ds_read_b64_tr_b16 v[156:157], v164 offset:19456
v_mfma_f32_16x16x32_bf16 v[84:87], v[112:115], a[4:7], v[84:87]
ds_read_b64_tr_b16 v[158:159], v164 offset:19968
s_waitcnt lgkmcnt(8)
v_mfma_f32_16x16x32_bf16 v[88:91], v[128:131], a[0:3], 0
ds_read_b64_tr_b16 v[112:113], v165 offset:16384
ds_read_b64_tr_b16 v[114:115], v165 offset:16896
v_mfma_f32_16x16x32_bf16 v[88:91], v[132:135], a[8:11], v[88:91]
buffer_store_dwordx4 v[204:207], v251, s[40:43], s88 offen offset:0 sc1
v_mfma_f32_16x16x32_bf16 v[88:91], v[136:139], a[16:19], v[88:91]
ds_read_b64_tr_b16 v[116:117], v165 offset:17408
v_mfma_f32_16x16x32_bf16 v[88:91], v[140:143], a[24:27], v[88:91]
ds_read_b64_tr_b16 v[118:119], v165 offset:17920
v_mfma_f32_16x16x32_bf16 v[92:95], v[140:143], a[28:31], 0
ds_read_b64_tr_b16 v[120:121], v165 offset:18432
ds_read_b64_tr_b16 v[122:123], v165 offset:18944
v_mfma_f32_16x16x32_bf16 v[92:95], v[136:139], a[20:23], v[92:95]
buffer_store_dwordx4 v[208:211], v251, s[40:43], s88 offen offset:128 sc1
v_mfma_f32_16x16x32_bf16 v[92:95], v[132:135], a[12:15], v[92:95]
ds_read_b64_tr_b16 v[124:125], v165 offset:19456
s_add_u32 s88, s88, 4096
v_mfma_f32_16x16x32_bf16 v[92:95], v[128:131], a[4:7], v[92:95]
ds_read_b64_tr_b16 v[126:127], v165 offset:19968
s_waitcnt lgkmcnt(8)
v_mfma_f32_16x16x32_bf16 v[64:67], v[144:147], a[32:35], v[64:67]
ds_read_b64_tr_b16 v[128:129], v166 offset:16384
v_mfma_f32_16x16x32_bf16 v[64:67], v[148:151], a[40:43], v[64:67]
ds_read_b64_tr_b16 v[130:131], v166 offset:16896
ds_read_b64_tr_b16 v[132:133], v166 offset:17408
s_add_u32 s50, s50, 4294965248
v_mfma_f32_16x16x32_bf16 v[64:67], v[152:155], a[48:51], v[64:67]
buffer_load_dwordx4 v236, s[28:31], s50 offen offset:2048 lds
v_mfma_f32_16x16x32_bf16 v[64:67], v[156:159], a[56:59], v[64:67]
ds_read_b64_tr_b16 v[134:135], v166 offset:17920
ds_read_b128 v[172:175], v245 offset:128
v_mfma_f32_16x16x32_bf16 v[68:71], v[156:159], a[60:63], v[68:71]
ds_read_b64_tr_b16 v[136:137], v166 offset:18432
ds_read_b128 v[180:183], v245 offset:1152
v_mfma_f32_16x16x32_bf16 v[68:71], v[152:155], a[52:55], v[68:71]
ds_read_b64_tr_b16 v[138:139], v166 offset:18944
v_mfma_f32_16x16x32_bf16 v[68:71], v[148:151], a[44:47], v[68:71]
ds_read_b64_tr_b16 v[140:141], v166 offset:19456
ds_read_b128 v[176:179], v245 offset:192
v_mfma_f32_16x16x32_bf16 v[68:71], v[144:147], a[36:39], v[68:71]
ds_read_b64_tr_b16 v[142:143], v166 offset:19968
s_waitcnt lgkmcnt(11)
v_mfma_f32_16x16x32_bf16 v[72:75], v[112:115], a[32:35], v[72:75]
ds_read_b64_tr_b16 v[144:145], v167 offset:16384
ds_read_b128 v[184:187], v245 offset:1216
v_mfma_f32_16x16x32_bf16 v[72:75], v[116:119], a[40:43], v[72:75]
ds_read_b64_tr_b16 v[146:147], v167 offset:16896
v_mfma_f32_16x16x32_bf16 v[72:75], v[120:123], a[48:51], v[72:75]
ds_read_b64_tr_b16 v[148:149], v167 offset:17408
v_mfma_f32_16x16x32_bf16 v[72:75], v[124:127], a[56:59], v[72:75]
ds_read_b64_tr_b16 v[150:151], v167 offset:17920
s_waitcnt lgkmcnt(9)
v_pk_fma_f32 v[188:189], v[230:231], v[172:173], v[180:181] op_sel:[0,0,0] op_sel_hi:[0,1,1]
v_pk_fma_f32 v[190:191], v[230:231], v[174:175], v[182:183] op_sel:[0,0,0] op_sel_hi:[0,1,1]
v_pk_fma_f32 v[192:193], v[230:231], v[172:173], v[180:181] op_sel:[1,0,0] op_sel_hi:[1,1,1]
v_pk_fma_f32 v[194:195], v[230:231], v[174:175], v[182:183] op_sel:[1,0,0] op_sel_hi:[1,1,1]
s_add_u32 s51, s51, 4294966272
buffer_load_dwordx4 v236, s[28:31], s51 offen offset:3072 lds
s_waitcnt lgkmcnt(3)
v_pk_fma_f32 v[196:197], v[230:231], v[176:177], v[184:185] op_sel:[0,0,0] op_sel_hi:[0,1,1]
v_pk_fma_f32 v[198:199], v[230:231], v[178:179], v[186:187] op_sel:[0,0,0] op_sel_hi:[0,1,1]
v_pk_fma_f32 v[200:201], v[230:231], v[176:177], v[184:185] op_sel:[1,0,0] op_sel_hi:[1,1,1]
v_pk_fma_f32 v[202:203], v[230:231], v[178:179], v[186:187] op_sel:[1,0,0] op_sel_hi:[1,1,1]
v_pk_fma_f32 v[16:17], v[228:229], v[16:17], v[188:189] op_sel:[0,0,0] op_sel_hi:[0,1,1]
v_pk_fma_f32 v[18:19], v[228:229], v[18:19], v[190:191] op_sel:[0,0,0] op_sel_hi:[0,1,1]
v_pk_fma_f32 v[20:21], v[228:229], v[20:21], v[192:193] op_sel:[1,0,0] op_sel_hi:[1,1,1]
v_pk_fma_f32 v[22:23], v[228:229], v[22:23], v[194:195] op_sel:[1,0,0] op_sel_hi:[1,1,1]
v_pk_fma_f32 v[24:25], v[228:229], v[24:25], v[196:197] op_sel:[0,0,0] op_sel_hi:[0,1,1]
v_pk_fma_f32 v[26:27], v[228:229], v[26:27], v[198:199] op_sel:[0,0,0] op_sel_hi:[0,1,1]
v_pk_fma_f32 v[28:29], v[228:229], v[28:29], v[200:201] op_sel:[1,0,0] op_sel_hi:[1,1,1]
v_pk_fma_f32 v[30:31], v[228:229], v[30:31], v[202:203] op_sel:[1,0,0] op_sel_hi:[1,1,1]
v_pk_fma_f32 v[188:189], v[16:17], v[16:17], s[76:77] op_sel_hi:[1,1,0]
v_pk_fma_f32 v[190:191], v[18:19], v[18:19], s[76:77] op_sel_hi:[1,1,0]
v_pk_fma_f32 v[192:193], v[20:21], v[20:21], s[76:77] op_sel_hi:[1,1,0]
v_pk_fma_f32 v[194:195], v[22:23], v[22:23], s[76:77] op_sel_hi:[1,1,0]
v_pk_fma_f32 v[196:197], v[24:25], v[24:25], s[76:77] op_sel_hi:[1,1,0]
v_pk_fma_f32 v[198:199], v[26:27], v[26:27], s[76:77] op_sel_hi:[1,1,0]
v_pk_fma_f32 v[200:201], v[28:29], v[28:29], s[76:77] op_sel_hi:[1,1,0]
v_pk_fma_f32 v[202:203], v[30:31], v[30:31], s[76:77] op_sel_hi:[1,1,0]
v_pk_mul_f32 v[188:189], v[188:189], v[16:17]
v_pk_mul_f32 v[190:191], v[190:191], v[18:19]
v_pk_mul_f32 v[192:193], v[192:193], v[20:21]
v_pk_mul_f32 v[194:195], v[194:195], v[22:23]
v_pk_mul_f32 v[196:197], v[196:197], v[24:25]
v_pk_mul_f32 v[198:199], v[198:199], v[26:27]
v_pk_mul_f32 v[200:201], v[200:201], v[28:29]
v_pk_mul_f32 v[202:203], v[202:203], v[30:31]
v_exp_f32 v188, v188
v_exp_f32 v189, v189
v_exp_f32 v190, v190
v_exp_f32 v191, v191
v_exp_f32 v192, v192
v_exp_f32 v193, v193
v_exp_f32 v194, v194
v_exp_f32 v195, v195
s_add_u32 m0, s80, 32768
s_nop 0
buffer_load_dwordx4 v234, s[24:27], s52 offen lds
v_exp_f32 v196, v196
v_exp_f32 v197, v197
v_exp_f32 v198, v198
v_exp_f32 v199, v199
v_exp_f32 v200, v200
v_exp_f32 v201, v201
v_exp_f32 v202, v202
v_exp_f32 v203, v203
v_pk_fma_f32 v[188:189], v[188:189], s[76:77], s[76:77] op_sel:[0,1,1] op_sel_hi:[1,1,1]
v_pk_fma_f32 v[190:191], v[190:191], s[76:77], s[76:77] op_sel:[0,1,1] op_sel_hi:[1,1,1]
v_pk_fma_f32 v[192:193], v[192:193], s[76:77], s[76:77] op_sel:[0,1,1] op_sel_hi:[1,1,1]
v_pk_fma_f32 v[194:195], v[194:195], s[76:77], s[76:77] op_sel:[0,1,1] op_sel_hi:[1,1,1]
v_pk_fma_f32 v[196:197], v[196:197], s[76:77], s[76:77] op_sel:[0,1,1] op_sel_hi:[1,1,1]
v_pk_fma_f32 v[198:199], v[198:199], s[76:77], s[76:77] op_sel:[0,1,1] op_sel_hi:[1,1,1]
v_pk_fma_f32 v[200:201], v[200:201], s[76:77], s[76:77] op_sel:[0,1,1] op_sel_hi:[1,1,1]
v_pk_fma_f32 v[202:203], v[202:203], s[76:77], s[76:77] op_sel:[0,1,1] op_sel_hi:[1,1,1]
buffer_load_dwordx4 v235, s[24:27], s52 offen offset:1024 lds
v_rcp_f32 v188, v188
v_rcp_f32 v189, v189
v_rcp_f32 v190, v190
v_rcp_f32 v191, v191
v_rcp_f32 v192, v192
v_rcp_f32 v193, v193
v_rcp_f32 v194, v194
v_rcp_f32 v195, v195
v_rcp_f32 v196, v196
v_rcp_f32 v197, v197
v_rcp_f32 v198, v198
v_rcp_f32 v199, v199
buffer_load_dwordx4 v234, s[24:27], s53 offen offset:2048 lds
v_rcp_f32 v200, v200
v_rcp_f32 v201, v201
v_rcp_f32 v202, v202
v_rcp_f32 v203, v203
v_pk_mul_f32 v[16:17], v[16:17], v[188:189]
v_pk_mul_f32 v[18:19], v[18:19], v[190:191]
v_pk_mul_f32 v[20:21], v[20:21], v[192:193]
v_pk_mul_f32 v[22:23], v[22:23], v[194:195]
v_pk_mul_f32 v[24:25], v[24:25], v[196:197]
v_pk_mul_f32 v[26:27], v[26:27], v[198:199]
v_pk_mul_f32 v[28:29], v[28:29], v[200:201]
v_pk_mul_f32 v[30:31], v[30:31], v[202:203]
v_mfma_f32_16x16x32_bf16 v[76:79], v[124:127], a[60:63], v[76:79]
ds_read_b64_tr_b16 v[152:153], v167 offset:18432
ds_read_b64_tr_b16 v[154:155], v167 offset:18944
v_mfma_f32_16x16x32_bf16 v[76:79], v[120:123], a[52:55], v[76:79]
buffer_load_dwordx4 v235, s[24:27], s53 offen offset:3072 lds
v_mfma_f32_16x16x32_bf16 v[76:79], v[116:119], a[44:47], v[76:79]
ds_read_b64_tr_b16 v[156:157], v167 offset:19456
ds_read_b64_tr_b16 v[158:159], v167 offset:19968
v_mfma_f32_16x16x32_bf16 v[76:79], v[112:115], a[36:39], v[76:79]
v_cvt_pk_bf16_f32 v212, v16, v17
s_waitcnt vmcnt(14)
s_barrier
v_mfma_f32_16x16x32_bf16 v[80:83], v[128:131], a[32:35], v[80:83]
ds_read_b64_tr_b16 v[112:113], v168 offset:0
v_cvt_pk_bf16_f32 v213, v18, v19
v_mfma_f32_16x16x32_bf16 v[80:83], v[132:135], a[40:43], v[80:83]
ds_read_b64_tr_b16 v[114:115], v168 offset:256
ds_read_b64_tr_b16 v[116:117], v168 offset:8192
s_add_u32 m0, s80, 49152
v_mfma_f32_16x16x32_bf16 v[80:83], v[136:139], a[48:51], v[80:83]
buffer_load_dwordx4 v234, s[24:27], s54 offen lds
v_mfma_f32_16x16x32_bf16 v[80:83], v[140:143], a[56:59], v[80:83]
ds_read_b64_tr_b16 v[118:119], v168 offset:8448
v_cvt_pk_bf16_f32 v214, v24, v25
v_mfma_f32_16x16x32_bf16 v[84:87], v[140:143], a[60:63], v[84:87]
ds_read_b64_tr_b16 v[120:121], v168 offset:1024
v_cvt_pk_bf16_f32 v215, v26, v27
v_mfma_f32_16x16x32_bf16 v[84:87], v[136:139], a[52:55], v[84:87]
ds_read_b64_tr_b16 v[122:123], v168 offset:1280
v_cvt_pk_bf16_f32 v216, v20, v21
v_mfma_f32_16x16x32_bf16 v[84:87], v[132:135], a[44:47], v[84:87]
ds_read_b64_tr_b16 v[124:125], v168 offset:9216
v_cvt_pk_bf16_f32 v217, v22, v23
v_mfma_f32_16x16x32_bf16 v[84:87], v[128:131], a[36:39], v[84:87]
ds_read_b64_tr_b16 v[126:127], v168 offset:9472
s_waitcnt lgkmcnt(8)
v_mfma_f32_16x16x32_bf16 v[88:91], v[144:147], a[32:35], v[88:91]
ds_read_b64_tr_b16 v[128:129], v169 offset:0
ds_read_b64_tr_b16 v[130:131], v169 offset:256
v_mfma_f32_16x16x32_bf16 v[88:91], v[148:151], a[40:43], v[88:91]
buffer_store_dwordx4 v[212:215], v251, s[40:43], s88 offen offset:0 sc1
v_mfma_f32_16x16x32_bf16 v[88:91], v[152:155], a[48:51], v[88:91]
ds_read_b64_tr_b16 v[132:133], v169 offset:8192
v_cvt_pk_bf16_f32 v218, v28, v29
v_mfma_f32_16x16x32_bf16 v[88:91], v[156:159], a[56:59], v[88:91]
ds_read_b64_tr_b16 v[134:135], v169 offset:8448
v_cvt_pk_bf16_f32 v219, v30, v31
v_mfma_f32_16x16x32_bf16 v[92:95], v[156:159], a[60:63], v[92:95]
ds_read_b64_tr_b16 v[136:137], v169 offset:1024
ds_read_b64_tr_b16 v[138:139], v169 offset:1280
v_mfma_f32_16x16x32_bf16 v[92:95], v[152:155], a[52:55], v[92:95]
buffer_load_dwordx4 v235, s[24:27], s54 offen offset:1024 lds
v_mfma_f32_16x16x32_bf16 v[92:95], v[148:151], a[44:47], v[92:95]
ds_read_b64_tr_b16 v[140:141], v169 offset:9216
v_mfma_f32_16x16x32_bf16 v[92:95], v[144:147], a[36:39], v[92:95]
ds_read_b64_tr_b16 v[142:143], v169 offset:9472
s_waitcnt lgkmcnt(8)
v_mfma_f32_16x16x32_bf16 v[96:99], v[112:115], a[0:3], 0
ds_read_b64_tr_b16 v[144:145], v168 offset:2048
v_mfma_f32_16x16x32_bf16 v[96:99], v[116:119], a[8:11], v[96:99]
ds_read_b64_tr_b16 v[146:147], v168 offset:2304
v_mfma_f32_16x16x32_bf16 v[96:99], v[120:123], a[16:19], v[96:99]
ds_read_b64_tr_b16 v[148:149], v168 offset:10240
ds_read_b64_tr_b16 v[150:151], v168 offset:10496
v_mfma_f32_16x16x32_bf16 v[96:99], v[124:127], a[24:27], v[96:99]
buffer_store_dwordx4 v[216:219], v251, s[40:43], s88 offen offset:128 sc1
v_mfma_f32_16x16x32_bf16 v[100:103], v[124:127], a[28:31], 0
ds_read_b64_tr_b16 v[152:153], v168 offset:3072
s_add_u32 s88, s88, 4096
v_mfma_f32_16x16x32_bf16 v[100:103], v[120:123], a[20:23], v[100:103]
ds_read_b64_tr_b16 v[154:155], v168 offset:3328
ds_read_b128 v[172:175], v245 offset:256
v_mfma_f32_16x16x32_bf16 v[100:103], v[116:119], a[12:15], v[100:103]
ds_read_b64_tr_b16 v[156:157], v168 offset:11264
ds_read_b128 v[180:183], v245 offset:1280
v_mfma_f32_16x16x32_bf16 v[100:103], v[112:115], a[4:7], v[100:103]
ds_read_b64_tr_b16 v[158:159], v168 offset:11520
s_waitcnt lgkmcnt(10)
v_mfma_f32_16x16x32_bf16 v[104:107], v[128:131], a[0:3], 0
ds_read_b64_tr_b16 v[112:113], v169 offset:2048
ds_read_b64_tr_b16 v[114:115], v169 offset:2304
ds_read_b128 v[176:179], v245 offset:320
v_mfma_f32_16x16x32_bf16 v[104:107], v[132:135], a[8:11], v[104:107]
buffer_load_dwordx4 v234, s[24:27], s55 offen offset:2048 lds
ds_read_b128 v[184:187], v245 offset:1344
v_mfma_f32_16x16x32_bf16 v[104:107], v[136:139], a[16:19], v[104:107]
ds_read_b64_tr_b16 v[116:117], v169 offset:10240
v_mfma_f32_16x16x32_bf16 v[104:107], v[140:143], a[24:27], v[104:107]
ds_read_b64_tr_b16 v[118:119], v169 offset:10496
s_waitcnt lgkmcnt(7)
v_pk_fma_f32 v[188:189], v[230:231], v[172:173], v[180:181] op_sel:[0,0,0] op_sel_hi:[0,1,1]
v_pk_fma_f32 v[190:191], v[230:231], v[174:175], v[182:183] op_sel:[0,0,0] op_sel_hi:[0,1,1]
v_pk_fma_f32 v[192:193], v[230:231], v[172:173], v[180:181] op_sel:[1,0,0] op_sel_hi:[1,1,1]
v_pk_fma_f32 v[194:195], v[230:231], v[174:175], v[182:183] op_sel:[1,0,0] op_sel_hi:[1,1,1]
s_waitcnt lgkmcnt(2)
v_pk_fma_f32 v[196:197], v[230:231], v[176:177], v[184:185] op_sel:[0,0,0] op_sel_hi:[0,1,1]
v_pk_fma_f32 v[198:199], v[230:231], v[178:179], v[186:187] op_sel:[0,0,0] op_sel_hi:[0,1,1]
v_pk_fma_f32 v[200:201], v[230:231], v[176:177], v[184:185] op_sel:[1,0,0] op_sel_hi:[1,1,1]
v_pk_fma_f32 v[202:203], v[230:231], v[178:179], v[186:187] op_sel:[1,0,0] op_sel_hi:[1,1,1]
buffer_load_dwordx4 v235, s[24:27], s55 offen offset:3072 lds
v_pk_fma_f32 v[32:33], v[228:229], v[32:33], v[188:189] op_sel:[0,0,0] op_sel_hi:[0,1,1]
v_pk_fma_f32 v[34:35], v[228:229], v[34:35], v[190:191] op_sel:[0,0,0] op_sel_hi:[0,1,1]
v_pk_fma_f32 v[36:37], v[228:229], v[36:37], v[192:193] op_sel:[1,0,0] op_sel_hi:[1,1,1]
v_pk_fma_f32 v[38:39], v[228:229], v[38:39], v[194:195] op_sel:[1,0,0] op_sel_hi:[1,1,1]
v_pk_fma_f32 v[40:41], v[228:229], v[40:41], v[196:197] op_sel:[0,0,0] op_sel_hi:[0,1,1]
v_pk_fma_f32 v[42:43], v[228:229], v[42:43], v[198:199] op_sel:[0,0,0] op_sel_hi:[0,1,1]
v_pk_fma_f32 v[44:45], v[228:229], v[44:45], v[200:201] op_sel:[1,0,0] op_sel_hi:[1,1,1]
v_pk_fma_f32 v[46:47], v[228:229], v[46:47], v[202:203] op_sel:[1,0,0] op_sel_hi:[1,1,1]
v_pk_fma_f32 v[188:189], v[32:33], v[32:33], s[76:77] op_sel_hi:[1,1,0]
v_pk_fma_f32 v[190:191], v[34:35], v[34:35], s[76:77] op_sel_hi:[1,1,0]
v_pk_fma_f32 v[192:193], v[36:37], v[36:37], s[76:77] op_sel_hi:[1,1,0]
v_pk_fma_f32 v[194:195], v[38:39], v[38:39], s[76:77] op_sel_hi:[1,1,0]
v_pk_fma_f32 v[196:197], v[40:41], v[40:41], s[76:77] op_sel_hi:[1,1,0]
v_pk_fma_f32 v[198:199], v[42:43], v[42:43], s[76:77] op_sel_hi:[1,1,0]
v_pk_fma_f32 v[200:201], v[44:45], v[44:45], s[76:77] op_sel_hi:[1,1,0]
v_pk_fma_f32 v[202:203], v[46:47], v[46:47], s[76:77] op_sel_hi:[1,1,0]
v_pk_mul_f32 v[188:189], v[188:189], v[32:33]
v_pk_mul_f32 v[190:191], v[190:191], v[34:35]
v_pk_mul_f32 v[192:193], v[192:193], v[36:37]
v_pk_mul_f32 v[194:195], v[194:195], v[38:39]
s_add_u32 m0, s80, 65536
s_nop 0
buffer_load_dwordx4 v236, s[28:31], s52 offen lds
v_pk_mul_f32 v[196:197], v[196:197], v[40:41]
v_pk_mul_f32 v[198:199], v[198:199], v[42:43]
v_pk_mul_f32 v[200:201], v[200:201], v[44:45]
v_pk_mul_f32 v[202:203], v[202:203], v[46:47]
v_exp_f32 v188, v188
v_exp_f32 v189, v189
v_exp_f32 v190, v190
v_exp_f32 v191, v191
v_exp_f32 v192, v192
v_exp_f32 v193, v193
v_exp_f32 v194, v194
v_exp_f32 v195, v195
v_exp_f32 v196, v196
v_exp_f32 v197, v197
v_exp_f32 v198, v198
v_exp_f32 v199, v199
v_exp_f32 v200, v200
v_exp_f32 v201, v201
v_exp_f32 v202, v202
v_exp_f32 v203, v203
v_pk_fma_f32 v[188:189], v[188:189], s[76:77], s[76:77] op_sel:[0,1,1] op_sel_hi:[1,1,1]
v_pk_fma_f32 v[190:191], v[190:191], s[76:77], s[76:77] op_sel:[0,1,1] op_sel_hi:[1,1,1]
v_pk_fma_f32 v[192:193], v[192:193], s[76:77], s[76:77] op_sel:[0,1,1] op_sel_hi:[1,1,1]
v_pk_fma_f32 v[194:195], v[194:195], s[76:77], s[76:77] op_sel:[0,1,1] op_sel_hi:[1,1,1]
v_pk_fma_f32 v[196:197], v[196:197], s[76:77], s[76:77] op_sel:[0,1,1] op_sel_hi:[1,1,1]
v_pk_fma_f32 v[198:199], v[198:199], s[76:77], s[76:77] op_sel:[0,1,1] op_sel_hi:[1,1,1]
v_pk_fma_f32 v[200:201], v[200:201], s[76:77], s[76:77] op_sel:[0,1,1] op_sel_hi:[1,1,1]
v_pk_fma_f32 v[202:203], v[202:203], s[76:77], s[76:77] op_sel:[0,1,1] op_sel_hi:[1,1,1]
v_rcp_f32 v188, v188
v_rcp_f32 v189, v189
s_add_u32 s53, s53, 1024
buffer_load_dwordx4 v236, s[28:31], s53 offen offset:1024 lds
v_rcp_f32 v190, v190
v_rcp_f32 v191, v191
v_rcp_f32 v192, v192
v_rcp_f32 v193, v193
v_rcp_f32 v194, v194
v_rcp_f32 v195, v195
v_rcp_f32 v196, v196
v_rcp_f32 v197, v197
v_rcp_f32 v198, v198
v_rcp_f32 v199, v199
v_rcp_f32 v200, v200
v_rcp_f32 v201, v201
v_rcp_f32 v202, v202
v_rcp_f32 v203, v203
v_pk_mul_f32 v[32:33], v[32:33], v[188:189]
v_pk_mul_f32 v[34:35], v[34:35], v[190:191]
v_pk_mul_f32 v[36:37], v[36:37], v[192:193]
v_pk_mul_f32 v[38:39], v[38:39], v[194:195]
v_pk_mul_f32 v[40:41], v[40:41], v[196:197]
v_pk_mul_f32 v[42:43], v[42:43], v[198:199]
v_pk_mul_f32 v[44:45], v[44:45], v[200:201]
v_pk_mul_f32 v[46:47], v[46:47], v[202:203]
v_mfma_f32_16x16x32_bf16 v[108:111], v[140:143], a[28:31], 0
ds_read_b64_tr_b16 v[120:121], v169 offset:3072
ds_read_b64_tr_b16 v[122:123], v169 offset:3328
s_add_u32 s54, s54, 4294965248
v_mfma_f32_16x16x32_bf16 v[108:111], v[136:139], a[20:23], v[108:111]
buffer_load_dwordx4 v236, s[28:31], s54 offen offset:2048 lds
v_mfma_f32_16x16x32_bf16 v[108:111], v[132:135], a[12:15], v[108:111]
ds_read_b64_tr_b16 v[124:125], v169 offset:11264
v_cvt_pk_bf16_f32 v204, v32, v33
v_mfma_f32_16x16x32_bf16 v[108:111], v[128:131], a[4:7], v[108:111]
ds_read_b64_tr_b16 v[126:127], v169 offset:11520
v_mfma_f32_16x16x32_bf16 v[96:99], v[144:147], a[32:35], v[96:99]
ds_read_b64_tr_b16 v[128:129], v164 offset:32768
v_cvt_pk_bf16_f32 v205, v34, v35
v_mfma_f32_16x16x32_bf16 v[96:99], v[148:151], a[40:43], v[96:99]
ds_read_b64_tr_b16 v[130:131], v164 offset:33280
v_cvt_pk_bf16_f32 v206, v40, v41
v_mfma_f32_16x16x32_bf16 v[96:99], v[152:155], a[48:51], v[96:99]
ds_read_b64_tr_b16 v[132:133], v164 offset:33792
v_cvt_pk_bf16_f32 v207, v42, v43
v_mfma_f32_16x16x32_bf16 v[96:99], v[156:159], a[56:59], v[96:99]
ds_read_b64_tr_b16 v[134:135], v164 offset:34304
v_cvt_pk_bf16_f32 v208, v36, v37
v_mfma_f32_16x16x32_bf16 v[100:103], v[156:159], a[60:63], v[100:103]
ds_read_b64_tr_b16 v[136:137], v164 offset:34816
v_cvt_pk_bf16_f32 v209, v38, v39
v_mfma_f32_16x16x32_bf16 v[100:103], v[152:155], a[52:55], v[100:103]
ds_read_b64_tr_b16 v[138:139], v164 offset:35328
v_cvt_pk_bf16_f32 v210, v44, v45
v_mfma_f32_16x16x32_bf16 v[100:103], v[148:151], a[44:47], v[100:103]
ds_read_b64_tr_b16 v[140:141], v164 offset:35840
v_cvt_pk_bf16_f32 v211, v46, v47
v_mfma_f32_16x16x32_bf16 v[100:103], v[144:147], a[36:39], v[100:103]
ds_read_b64_tr_b16 v[142:143], v164 offset:36352
s_waitcnt lgkmcnt(8)
v_mfma_f32_16x16x32_bf16 v[104:107], v[112:115], a[32:35], v[104:107]
ds_read_b64_tr_b16 v[144:145], v165 offset:32768
ds_read_b64_tr_b16 v[146:147], v165 offset:33280
v_mfma_f32_16x16x32_bf16 v[104:107], v[116:119], a[40:43], v[104:107]
buffer_store_dwordx4 v[204:207], v251, s[40:43], s88 offen offset:0 sc1
v_mfma_f32_16x16x32_bf16 v[104:107], v[120:123], a[48:51], v[104:107]
ds_read_b64_tr_b16 v[148:149], v165 offset:33792
v_mfma_f32_16x16x32_bf16 v[104:107], v[124:127], a[56:59], v[104:107]
ds_read_b64_tr_b16 v[150:151], v165 offset:34304
v_mfma_f32_16x16x32_bf16 v[108:111], v[124:127], a[60:63], v[108:111]
ds_read_b64_tr_b16 v[152:153], v165 offset:34816
ds_read_b64_tr_b16 v[154:155], v165 offset:35328
v_mfma_f32_16x16x32_bf16 v[108:111], v[120:123], a[52:55], v[108:111]
buffer_store_dwordx4 v[208:211], v251, s[40:43], s88 offen offset:128 sc1
v_mfma_f32_16x16x32_bf16 v[108:111], v[116:119], a[44:47], v[108:111]
ds_read_b64_tr_b16 v[156:157], v165 offset:35840
s_add_u32 s88, s88, 4096
v_mfma_f32_16x16x32_bf16 v[108:111], v[112:115], a[36:39], v[108:111]
ds_read_b64_tr_b16 v[158:159], v165 offset:36352
s_waitcnt lgkmcnt(8)
v_mfma_f32_16x16x32_bf16 v[64:67], v[128:131], a[64:67], v[64:67]
ds_read_b64_tr_b16 v[112:113], v166 offset:32768
v_mfma_f32_16x16x32_bf16 v[64:67], v[132:135], a[72:75], v[64:67]
ds_read_b64_tr_b16 v[114:115], v166 offset:33280
v_mfma_f32_16x16x32_bf16 v[64:67], v[136:139], a[80:83], v[64:67]
ds_read_b64_tr_b16 v[116:117], v166 offset:33792
ds_read_b64_tr_b16 v[118:119], v166 offset:34304
s_add_u32 s55, s55, 4294966272
v_mfma_f32_16x16x32_bf16 v[64:67], v[140:143], a[88:91], v[64:67]
buffer_load_dwordx4 v236, s[28:31], s55 offen offset:3072 lds
v_mfma_f32_16x16x32_bf16 v[68:71], v[140:143], a[92:95], v[68:71]
ds_read_b64_tr_b16 v[120:121], v166 offset:34816
ds_read_b128 v[172:175], v245 offset:384
v_mfma_f32_16x16x32_bf16 v[68:71], v[136:139], a[84:87], v[68:71]
ds_read_b64_tr_b16 v[122:123], v166 offset:35328
ds_read_b128 v[180:183], v245 offset:1408
v_mfma_f32_16x16x32_bf16 v[68:71], v[132:135], a[76:79], v[68:71]
ds_read_b64_tr_b16 v[124:125], v166 offset:35840
ds_read_b128 v[176:179], v245 offset:448
v_mfma_f32_16x16x32_bf16 v[68:71], v[128:131], a[68:71], v[68:71]
ds_read_b64_tr_b16 v[126:127], v166 offset:36352
s_waitcnt lgkmcnt(11)
v_mfma_f32_16x16x32_bf16 v[72:75], v[144:147], a[64:67], v[72:75]
ds_read_b64_tr_b16 v[128:129], v167 offset:32768
ds_read_b128 v[184:187], v245 offset:1472
v_mfma_f32_16x16x32_bf16 v[72:75], v[148:151], a[72:75], v[72:75]
ds_read_b64_tr_b16 v[130:131], v167 offset:33280
v_mfma_f32_16x16x32_bf16 v[72:75], v[152:155], a[80:83], v[72:75]
ds_read_b64_tr_b16 v[132:133], v167 offset:33792
v_mfma_f32_16x16x32_bf16 v[72:75], v[156:159], a[88:91], v[72:75]
ds_read_b64_tr_b16 v[134:135], v167 offset:34304
s_waitcnt lgkmcnt(8)
v_pk_fma_f32 v[188:189], v[230:231], v[172:173], v[180:181] op_sel:[0,0,0] op_sel_hi:[0,1,1]
v_pk_fma_f32 v[190:191], v[230:231], v[174:175], v[182:183] op_sel:[0,0,0] op_sel_hi:[0,1,1]
v_pk_fma_f32 v[192:193], v[230:231], v[172:173], v[180:181] op_sel:[1,0,0] op_sel_hi:[1,1,1]
v_pk_fma_f32 v[194:195], v[230:231], v[174:175], v[182:183] op_sel:[1,0,0] op_sel_hi:[1,1,1]
s_waitcnt lgkmcnt(3)
v_pk_fma_f32 v[196:197], v[230:231], v[176:177], v[184:185] op_sel:[0,0,0] op_sel_hi:[0,1,1]
v_pk_fma_f32 v[198:199], v[230:231], v[178:179], v[186:187] op_sel:[0,0,0] op_sel_hi:[0,1,1]
v_pk_fma_f32 v[200:201], v[230:231], v[176:177], v[184:185] op_sel:[1,0,0] op_sel_hi:[1,1,1]
v_pk_fma_f32 v[202:203], v[230:231], v[178:179], v[186:187] op_sel:[1,0,0] op_sel_hi:[1,1,1]
v_pk_fma_f32 v[48:49], v[228:229], v[48:49], v[188:189] op_sel:[0,0,0] op_sel_hi:[0,1,1]
v_pk_fma_f32 v[50:51], v[228:229], v[50:51], v[190:191] op_sel:[0,0,0] op_sel_hi:[0,1,1]
v_pk_fma_f32 v[52:53], v[228:229], v[52:53], v[192:193] op_sel:[1,0,0] op_sel_hi:[1,1,1]
v_pk_fma_f32 v[54:55], v[228:229], v[54:55], v[194:195] op_sel:[1,0,0] op_sel_hi:[1,1,1]
v_pk_fma_f32 v[56:57], v[228:229], v[56:57], v[196:197] op_sel:[0,0,0] op_sel_hi:[0,1,1]
v_pk_fma_f32 v[58:59], v[228:229], v[58:59], v[198:199] op_sel:[0,0,0] op_sel_hi:[0,1,1]
v_pk_fma_f32 v[60:61], v[228:229], v[60:61], v[200:201] op_sel:[1,0,0] op_sel_hi:[1,1,1]
v_pk_fma_f32 v[62:63], v[228:229], v[62:63], v[202:203] op_sel:[1,0,0] op_sel_hi:[1,1,1]
v_pk_fma_f32 v[188:189], v[48:49], v[48:49], s[76:77] op_sel_hi:[1,1,0]
v_pk_fma_f32 v[190:191], v[50:51], v[50:51], s[76:77] op_sel_hi:[1,1,0]
v_pk_fma_f32 v[192:193], v[52:53], v[52:53], s[76:77] op_sel_hi:[1,1,0]
v_pk_fma_f32 v[194:195], v[54:55], v[54:55], s[76:77] op_sel_hi:[1,1,0]
v_pk_fma_f32 v[196:197], v[56:57], v[56:57], s[76:77] op_sel_hi:[1,1,0]
v_pk_fma_f32 v[198:199], v[58:59], v[58:59], s[76:77] op_sel_hi:[1,1,0]
v_pk_fma_f32 v[200:201], v[60:61], v[60:61], s[76:77] op_sel_hi:[1,1,0]
v_pk_fma_f32 v[202:203], v[62:63], v[62:63], s[76:77] op_sel_hi:[1,1,0]
v_pk_mul_f32 v[188:189], v[188:189], v[48:49]
v_pk_mul_f32 v[190:191], v[190:191], v[50:51]
v_pk_mul_f32 v[192:193], v[192:193], v[52:53]
v_pk_mul_f32 v[194:195], v[194:195], v[54:55]
v_pk_mul_f32 v[196:197], v[196:197], v[56:57]
v_pk_mul_f32 v[198:199], v[198:199], v[58:59]
v_pk_mul_f32 v[200:201], v[200:201], v[60:61]
v_pk_mul_f32 v[202:203], v[202:203], v[62:63]
v_exp_f32 v188, v188
v_exp_f32 v189, v189
v_exp_f32 v190, v190
v_exp_f32 v191, v191
v_exp_f32 v192, v192
v_exp_f32 v193, v193
v_exp_f32 v194, v194
v_exp_f32 v195, v195
v_exp_f32 v196, v196
v_exp_f32 v197, v197
v_exp_f32 v198, v198
v_exp_f32 v199, v199
v_exp_f32 v200, v200
v_exp_f32 v201, v201
v_exp_f32 v202, v202
v_exp_f32 v203, v203
v_pk_fma_f32 v[188:189], v[188:189], s[76:77], s[76:77] op_sel:[0,1,1] op_sel_hi:[1,1,1]
v_pk_fma_f32 v[190:191], v[190:191], s[76:77], s[76:77] op_sel:[0,1,1] op_sel_hi:[1,1,1]
v_pk_fma_f32 v[192:193], v[192:193], s[76:77], s[76:77] op_sel:[0,1,1] op_sel_hi:[1,1,1]
v_pk_fma_f32 v[194:195], v[194:195], s[76:77], s[76:77] op_sel:[0,1,1] op_sel_hi:[1,1,1]
v_pk_fma_f32 v[196:197], v[196:197], s[76:77], s[76:77] op_sel:[0,1,1] op_sel_hi:[1,1,1]
v_pk_fma_f32 v[198:199], v[198:199], s[76:77], s[76:77] op_sel:[0,1,1] op_sel_hi:[1,1,1]
v_pk_fma_f32 v[200:201], v[200:201], s[76:77], s[76:77] op_sel:[0,1,1] op_sel_hi:[1,1,1]
v_pk_fma_f32 v[202:203], v[202:203], s[76:77], s[76:77] op_sel:[0,1,1] op_sel_hi:[1,1,1]
v_rcp_f32 v188, v188
v_rcp_f32 v189, v189
v_rcp_f32 v190, v190
v_rcp_f32 v191, v191
v_rcp_f32 v192, v192
v_rcp_f32 v193, v193
v_rcp_f32 v194, v194
v_rcp_f32 v195, v195
v_rcp_f32 v196, v196
v_rcp_f32 v197, v197
v_rcp_f32 v198, v198
v_rcp_f32 v199, v199
v_rcp_f32 v200, v200
v_rcp_f32 v201, v201
v_rcp_f32 v202, v202
v_rcp_f32 v203, v203
v_pk_mul_f32 v[48:49], v[48:49], v[188:189]
v_pk_mul_f32 v[50:51], v[50:51], v[190:191]
v_pk_mul_f32 v[52:53], v[52:53], v[192:193]
L_pad4:
s_cbranch_execz L_warm1
v_pk_mul_f32 v[54:55], v[54:55], v[194:195]
v_pk_mul_f32 v[56:57], v[56:57], v[196:197]
v_pk_mul_f32 v[58:59], v[58:59], v[198:199]
v_pk_mul_f32 v[60:61], v[60:61], v[200:201]
v_pk_mul_f32 v[62:63], v[62:63], v[202:203]
v_mfma_f32_16x16x32_bf16 v[76:79], v[156:159], a[92:95], v[76:79]
ds_read_b64_tr_b16 v[136:137], v167 offset:34816
v_cvt_pk_bf16_f32 v212, v48, v49
v_mfma_f32_16x16x32_bf16 v[76:79], v[152:155], a[84:87], v[76:79]
ds_read_b64_tr_b16 v[138:139], v167 offset:35328
v_cvt_pk_bf16_f32 v213, v50, v51
v_mfma_f32_16x16x32_bf16 v[76:79], v[148:151], a[76:79], v[76:79]
ds_read_b64_tr_b16 v[140:141], v167 offset:35840
ds_read_b64_tr_b16 v[142:143], v167 offset:36352
v_mfma_f32_16x16x32_bf16 v[76:79], v[144:147], a[68:71], v[76:79]
v_cvt_pk_bf16_f32 v214, v56, v57
s_waitcnt vmcnt(16)
s_barrier
v_mfma_f32_16x16x32_bf16 v[80:83], v[112:115], a[64:67], v[80:83]
ds_read_b64_tr_b16 v[144:145], v164 offset:49152
ds_read_b64_tr_b16 v[146:147], v164 offset:49664
s_add_u32 m0, s80, 0
v_mfma_f32_16x16x32_bf16 v[80:83], v[116:119], a[72:75], v[80:83]
buffer_load_dwordx4 v234, s[24:27], s56 offen lds
v_mfma_f32_16x16x32_bf16 v[80:83], v[120:123], a[80:83], v[80:83]
ds_read_b64_tr_b16 v[148:149], v164 offset:50176
v_cvt_pk_bf16_f32 v215, v58, v59
v_mfma_f32_16x16x32_bf16 v[80:83], v[124:127], a[88:91], v[80:83]
ds_read_b64_tr_b16 v[150:151], v164 offset:50688
v_add_u32 v244, 1, v242
s_waitcnt vmcnt(9)
buffer_store_dword v244, v248, s[40:43], s86 offen offset:1024 sc1
v_mfma_f32_16x16x32_bf16 v[84:87], v[124:127], a[92:95], v[84:87]
ds_read_b64_tr_b16 v[152:153], v164 offset:51200
ds_read_b64_tr_b16 v[154:155], v164 offset:51712
v_mfma_f32_16x16x32_bf16 v[84:87], v[120:123], a[84:87], v[84:87]
buffer_load_dwordx4 v235, s[24:27], s56 offen offset:1024 lds
v_mfma_f32_16x16x32_bf16 v[84:87], v[116:119], a[76:79], v[84:87]
ds_read_b64_tr_b16 v[156:157], v164 offset:52224
v_cvt_pk_bf16_f32 v216, v52, v53
v_mfma_f32_16x16x32_bf16 v[84:87], v[112:115], a[68:71], v[84:87]
ds_read_b64_tr_b16 v[158:159], v164 offset:52736
s_waitcnt lgkmcnt(8)
v_mfma_f32_16x16x32_bf16 v[88:91], v[128:131], a[64:67], v[88:91]
ds_read_b64_tr_b16 v[112:113], v165 offset:49152
ds_read_b64_tr_b16 v[114:115], v165 offset:49664
v_cvt_pk_bf16_f32 v217, v54, v55
v_mfma_f32_16x16x32_bf16 v[88:91], v[132:135], a[72:75], v[88:91]
buffer_store_dwordx4 v[212:215], v251, s[40:43], s88 offen offset:0 sc1
v_mfma_f32_16x16x32_bf16 v[88:91], v[136:139], a[80:83], v[88:91]
ds_read_b64_tr_b16 v[116:117], v165 offset:50176
v_cvt_pk_bf16_f32 v218, v60, v61
v_mfma_f32_16x16x32_bf16 v[88:91], v[140:143], a[88:91], v[88:91]
ds_read_b64_tr_b16 v[118:119], v165 offset:50688
v_cvt_pk_bf16_f32 v219, v62, v63
v_mfma_f32_16x16x32_bf16 v[92:95], v[140:143], a[92:95], v[92:95]
ds_read_b64_tr_b16 v[120:121], v165 offset:51200
v_mfma_f32_16x16x32_bf16 v[92:95], v[136:139], a[84:87], v[92:95]
ds_read_b64_tr_b16 v[122:123], v165 offset:51712
ds_read_b64_tr_b16 v[124:125], v165 offset:52224
v_mfma_f32_16x16x32_bf16 v[92:95], v[132:135], a[76:79], v[92:95]
buffer_store_dwordx4 v[216:219], v251, s[40:43], s88 offen offset:128 sc1
v_mfma_f32_16x16x32_bf16 v[92:95], v[128:131], a[68:71], v[92:95]
ds_read_b64_tr_b16 v[126:127], v165 offset:52736
s_waitcnt lgkmcnt(8)
v_mfma_f32_16x16x32_bf16 v[64:67], v[144:147], a[96:99], v[64:67]
ds_read_b64_tr_b16 v[128:129], v166 offset:49152
s_add_u32 s88, s88, 4096
v_mfma_f32_16x16x32_bf16 v[64:67], v[148:151], a[104:107], v[64:67]
ds_read_b64_tr_b16 v[130:131], v166 offset:49664
v_mfma_f32_16x16x32_bf16 v[64:67], v[152:155], a[112:115], v[64:67]
ds_read_b64_tr_b16 v[132:133], v166 offset:50176
ds_read_b64_tr_b16 v[134:135], v166 offset:50688
v_mfma_f32_16x16x32_bf16 v[64:67], v[156:159], a[120:123], v[64:67]
buffer_load_dwordx4 v234, s[24:27], s57 offen offset:2048 lds
v_mfma_f32_16x16x32_bf16 v[68:71], v[156:159], a[124:127], v[68:71]
ds_read_b64_tr_b16 v[136:137], v166 offset:51200
v_mfma_f32_16x16x32_bf16 v[68:71], v[152:155], a[116:119], v[68:71]
ds_read_b64_tr_b16 v[138:139], v166 offset:51712
v_mfma_f32_16x16x32_bf16 v[68:71], v[148:151], a[108:111], v[68:71]
ds_read_b64_tr_b16 v[140:141], v166 offset:52224
v_mfma_f32_16x16x32_bf16 v[68:71], v[144:147], a[100:103], v[68:71]
ds_read_b64_tr_b16 v[142:143], v166 offset:52736
s_waitcnt lgkmcnt(8)
v_mfma_f32_16x16x32_bf16 v[72:75], v[112:115], a[96:99], v[72:75]
ds_read_b64_tr_b16 v[144:145], v167 offset:49152
ds_read_b64_tr_b16 v[146:147], v167 offset:49664
v_mfma_f32_16x16x32_bf16 v[72:75], v[116:119], a[104:107], v[72:75]
buffer_load_dwordx4 v235, s[24:27], s57 offen offset:3072 lds
v_mfma_f32_16x16x32_bf16 v[72:75], v[120:123], a[112:115], v[72:75]
ds_read_b64_tr_b16 v[148:149], v167 offset:50176
v_mfma_f32_16x16x32_bf16 v[72:75], v[124:127], a[120:123], v[72:75]
ds_read_b64_tr_b16 v[150:151], v167 offset:50688
v_mfma_f32_16x16x32_bf16 v[76:79], v[124:127], a[124:127], v[76:79]
ds_read_b64_tr_b16 v[152:153], v167 offset:51200
v_mfma_f32_16x16x32_bf16 v[76:79], v[120:123], a[116:119], v[76:79]
ds_read_b64_tr_b16 v[154:155], v167 offset:51712
ds_read_b64_tr_b16 v[156:157], v167 offset:52224
s_add_u32 m0, s80, 81920
v_mfma_f32_16x16x32_bf16 v[76:79], v[116:119], a[108:111], v[76:79]
buffer_load_dwordx4 v234, s[24:27], s58 offen lds
v_mfma_f32_16x16x32_bf16 v[76:79], v[112:115], a[100:103], v[76:79]
ds_read_b64_tr_b16 v[158:159], v167 offset:52736
s_waitcnt lgkmcnt(8)
v_mfma_f32_16x16x32_bf16 v[80:83], v[128:131], a[96:99], v[80:83]
ds_read_b64_tr_b16 v[112:113], v168 offset:16384
v_mfma_f32_16x16x32_bf16 v[80:83], v[132:135], a[104:107], v[80:83]
ds_read_b64_tr_b16 v[114:115], v168 offset:16640
v_mfma_f32_16x16x32_bf16 v[80:83], v[136:139], a[112:115], v[80:83]
ds_read_b64_tr_b16 v[116:117], v168 offset:24576
ds_read_b64_tr_b16 v[118:119], v168 offset:24832
v_mfma_f32_16x16x32_bf16 v[80:83], v[140:143], a[120:123], v[80:83]
buffer_load_dwordx4 v235, s[24:27], s58 offen offset:1024 lds
v_mfma_f32_16x16x32_bf16 v[84:87], v[140:143], a[124:127], v[84:87]
ds_read_b64_tr_b16 v[120:121], v168 offset:17408
v_mfma_f32_16x16x32_bf16 v[84:87], v[136:139], a[116:119], v[84:87]
ds_read_b64_tr_b16 v[122:123], v168 offset:17664
v_mfma_f32_16x16x32_bf16 v[84:87], v[132:135], a[108:111], v[84:87]
ds_read_b64_tr_b16 v[124:125], v168 offset:25600
v_mfma_f32_16x16x32_bf16 v[84:87], v[128:131], a[100:103], v[84:87]
ds_read_b64_tr_b16 v[126:127], v168 offset:25856
s_waitcnt lgkmcnt(8)
v_mfma_f32_16x16x32_bf16 v[88:91], v[144:147], a[96:99], v[88:91]
ds_read_b64_tr_b16 v[128:129], v169 offset:16384
ds_read_b64_tr_b16 v[130:131], v169 offset:16640
v_mfma_f32_16x16x32_bf16 v[88:91], v[148:151], a[104:107], v[88:91]
buffer_load_dwordx4 v234, s[24:27], s59 offen offset:2048 lds
v_mfma_f32_16x16x32_bf16 v[88:91], v[152:155], a[112:115], v[88:91]
ds_read_b64_tr_b16 v[132:133], v169 offset:24576
v_mfma_f32_16x16x32_bf16 v[88:91], v[156:159], a[120:123], v[88:91]
ds_read_b64_tr_b16 v[134:135], v169 offset:24832
v_mfma_f32_16x16x32_bf16 v[92:95], v[156:159], a[124:127], v[92:95]
ds_read_b64_tr_b16 v[136:137], v169 offset:17408
ds_read_b64_tr_b16 v[138:139], v169 offset:17664
v_mfma_f32_16x16x32_bf16 v[92:95], v[152:155], a[116:119], v[92:95]
buffer_load_dwordx4 v235, s[24:27], s59 offen offset:3072 lds
v_mfma_f32_16x16x32_bf16 v[92:95], v[148:151], a[108:111], v[92:95]
ds_read_b64_tr_b16 v[140:141], v169 offset:25600
v_mfma_f32_16x16x32_bf16 v[92:95], v[144:147], a[100:103], v[92:95]
ds_read_b64_tr_b16 v[142:143], v169 offset:25856
s_waitcnt lgkmcnt(8)
v_mfma_f32_16x16x32_bf16 v[96:99], v[112:115], a[64:67], v[96:99]
ds_read_b64_tr_b16 v[144:145], v168 offset:18432
v_mfma_f32_16x16x32_bf16 v[96:99], v[116:119], a[72:75], v[96:99]
ds_read_b64_tr_b16 v[146:147], v168 offset:18688
v_mfma_f32_16x16x32_bf16 v[96:99], v[120:123], a[80:83], v[96:99]
ds_read_b64_tr_b16 v[148:149], v168 offset:26624
v_mfma_f32_16x16x32_bf16 v[96:99], v[124:127], a[88:91], v[96:99]
ds_read_b64_tr_b16 v[150:151], v168 offset:26880
v_mfma_f32_16x16x32_bf16 v[100:103], v[124:127], a[92:95], v[100:103]
ds_read_b64_tr_b16 v[152:153], v168 offset:19456
v_mfma_f32_16x16x32_bf16 v[100:103], v[120:123], a[84:87], v[100:103]
ds_read_b64_tr_b16 v[154:155], v168 offset:19712
v_mfma_f32_16x16x32_bf16 v[100:103], v[116:119], a[76:79], v[100:103]
ds_read_b64_tr_b16 v[156:157], v168 offset:27648
v_mfma_f32_16x16x32_bf16 v[100:103], v[112:115], a[68:71], v[100:103]
ds_read_b64_tr_b16 v[158:159], v168 offset:27904
s_waitcnt lgkmcnt(8)
v_mfma_f32_16x16x32_bf16 v[104:107], v[128:131], a[64:67], v[104:107]
ds_read_b64_tr_b16 v[112:113], v169 offset:18432
v_mfma_f32_16x16x32_bf16 v[104:107], v[132:135], a[72:75], v[104:107]
ds_read_b64_tr_b16 v[114:115], v169 offset:18688
v_mfma_f32_16x16x32_bf16 v[104:107], v[136:139], a[80:83], v[104:107]
ds_read_b64_tr_b16 v[116:117], v169 offset:26624
v_mfma_f32_16x16x32_bf16 v[104:107], v[140:143], a[88:91], v[104:107]
ds_read_b64_tr_b16 v[118:119], v169 offset:26880
v_mfma_f32_16x16x32_bf16 v[108:111], v[140:143], a[92:95], v[108:111]
ds_read_b64_tr_b16 v[120:121], v169 offset:19456
v_mfma_f32_16x16x32_bf16 v[108:111], v[136:139], a[84:87], v[108:111]
ds_read_b64_tr_b16 v[122:123], v169 offset:19712
v_mfma_f32_16x16x32_bf16 v[108:111], v[132:135], a[76:79], v[108:111]
ds_read_b64_tr_b16 v[124:125], v169 offset:27648
ds_read_b64_tr_b16 v[126:127], v169 offset:27904
v_mfma_f32_16x16x32_bf16 v[108:111], v[128:131], a[68:71], v[108:111]
v_add_u32 v244, 2, v242
s_waitcnt vmcnt(6)
buffer_store_dword v244, v248, s[40:43], s86 offen offset:1024 sc1
s_waitcnt lgkmcnt(8)
s_barrier
v_mfma_f32_16x16x32_bf16 v[96:99], v[144:147], a[96:99], v[96:99]
ds_read_b64_tr_b16 v[128:129], v160 offset:32768
ds_read_b64_tr_b16 v[130:131], v160 offset:33280
s_add_u32 m0, s80, 98304
v_mfma_f32_16x16x32_bf16 v[96:99], v[148:151], a[104:107], v[96:99]
buffer_load_dwordx4 v236, s[28:31], s56 offen lds
v_mfma_f32_16x16x32_bf16 v[96:99], v[152:155], a[112:115], v[96:99]
ds_read_b64_tr_b16 v[132:133], v160 offset:33792
v_mfma_f32_16x16x32_bf16 v[96:99], v[156:159], a[120:123], v[96:99]
ds_read_b64_tr_b16 v[134:135], v160 offset:34304
v_mfma_f32_16x16x32_bf16 v[100:103], v[156:159], a[124:127], v[100:103]
ds_read_b64_tr_b16 v[136:137], v160 offset:34816
v_mfma_f32_16x16x32_bf16 v[100:103], v[152:155], a[116:119], v[100:103]
ds_read_b64_tr_b16 v[138:139], v160 offset:35328
v_mfma_f32_16x16x32_bf16 v[100:103], v[148:151], a[108:111], v[100:103]
ds_read_b64_tr_b16 v[140:141], v160 offset:35840
v_mfma_f32_16x16x32_bf16 v[100:103], v[144:147], a[100:103], v[100:103]
ds_read_b64_tr_b16 v[142:143], v160 offset:36352
s_waitcnt lgkmcnt(8)
v_mfma_f32_16x16x32_bf16 v[104:107], v[112:115], a[96:99], v[104:107]
ds_read_b64_tr_b16 v[144:145], v161 offset:32768
ds_read_b64_tr_b16 v[146:147], v161 offset:33280
s_add_u32 s57, s57, 1024
v_mfma_f32_16x16x32_bf16 v[104:107], v[116:119], a[104:107], v[104:107]
buffer_load_dwordx4 v236, s[28:31], s57 offen offset:1024 lds
v_mfma_f32_16x16x32_bf16 v[104:107], v[120:123], a[112:115], v[104:107]
ds_read_b64_tr_b16 v[148:149], v161 offset:33792
v_mfma_f32_16x16x32_bf16 v[104:107], v[124:127], a[120:123], v[104:107]
ds_read_b64_tr_b16 v[150:151], v161 offset:34304
v_mfma_f32_16x16x32_bf16 v[108:111], v[124:127], a[124:127], v[108:111]
ds_read_b64_tr_b16 v[152:153], v161 offset:34816
v_mfma_f32_16x16x32_bf16 v[108:111], v[120:123], a[116:119], v[108:111]
ds_read_b64_tr_b16 v[154:155], v161 offset:35328
v_mfma_f32_16x16x32_bf16 v[108:111], v[116:119], a[108:111], v[108:111]
ds_read_b64_tr_b16 v[156:157], v161 offset:35840
v_mfma_f32_16x16x32_bf16 v[108:111], v[112:115], a[100:103], v[108:111]
ds_read_b64_tr_b16 v[158:159], v161 offset:36352
s_waitcnt lgkmcnt(8)
v_mfma_f32_16x16x32_bf16 v[64:67], v[128:131], a[128:131], v[64:67]
ds_read_b64_tr_b16 v[112:113], v162 offset:32768
ds_read_b64_tr_b16 v[114:115], v162 offset:33280
v_mfma_f32_16x16x32_bf16 v[64:67], v[132:135], a[136:139], v[64:67]
buffer_load_dwordx4 v[188:191], v239, s[40:43], s17 offen offset:0 sc1
v_mfma_f32_16x16x32_bf16 v[64:67], v[136:139], a[144:147], v[64:67]
ds_read_b64_tr_b16 v[116:117], v162 offset:33792
ds_read_b64_tr_b16 v[118:119], v162 offset:34304
v_mfma_f32_16x16x32_bf16 v[64:67], v[140:143], a[152:155], v[64:67]
buffer_load_dwordx4 v[192:195], v239, s[40:43], s17 offen offset:1024 sc1
v_mfma_f32_16x16x32_bf16 v[68:71], v[140:143], a[156:159], v[68:71]
ds_read_b64_tr_b16 v[120:121], v162 offset:34816
ds_read_b64_tr_b16 v[122:123], v162 offset:35328
v_mfma_f32_16x16x32_bf16 v[68:71], v[136:139], a[148:151], v[68:71]
buffer_load_dwordx4 v[196:199], v239, s[40:43], s17 offen offset:2048 sc1
v_mfma_f32_16x16x32_bf16 v[68:71], v[132:135], a[140:143], v[68:71]
ds_read_b64_tr_b16 v[124:125], v162 offset:35840
v_mfma_f32_16x16x32_bf16 v[68:71], v[128:131], a[132:135], v[68:71]
ds_read_b64_tr_b16 v[126:127], v162 offset:36352
s_waitcnt lgkmcnt(8)
v_mfma_f32_16x16x32_bf16 v[72:75], v[144:147], a[128:131], v[72:75]
ds_read_b64_tr_b16 v[128:129], v163 offset:32768
ds_read_b64_tr_b16 v[130:131], v163 offset:33280
v_mfma_f32_16x16x32_bf16 v[72:75], v[148:151], a[136:139], v[72:75]
buffer_load_dwordx4 v[200:203], v239, s[40:43], s17 offen offset:3072 sc1
v_mfma_f32_16x16x32_bf16 v[72:75], v[152:155], a[144:147], v[72:75]
ds_read_b64_tr_b16 v[132:133], v163 offset:33792
v_mfma_f32_16x16x32_bf16 v[72:75], v[156:159], a[152:155], v[72:75]
ds_read_b64_tr_b16 v[134:135], v163 offset:34304
v_mfma_f32_16x16x32_bf16 v[76:79], v[156:159], a[156:159], v[76:79]
ds_read_b64_tr_b16 v[136:137], v163 offset:34816
ds_read_b64_tr_b16 v[138:139], v163 offset:35328
s_add_u32 s58, s58, 4294965248
v_mfma_f32_16x16x32_bf16 v[76:79], v[152:155], a[148:151], v[76:79]
buffer_load_dwordx4 v236, s[28:31], s58 offen offset:2048 lds
v_mfma_f32_16x16x32_bf16 v[76:79], v[148:151], a[140:143], v[76:79]
ds_read_b64_tr_b16 v[140:141], v163 offset:35840
v_mfma_f32_16x16x32_bf16 v[76:79], v[144:147], a[132:135], v[76:79]
ds_read_b64_tr_b16 v[142:143], v163 offset:36352
s_waitcnt lgkmcnt(8)
v_mfma_f32_16x16x32_bf16 v[80:83], v[112:115], a[128:131], v[80:83]
ds_read_b64_tr_b16 v[144:145], v160 offset:49152
v_mfma_f32_16x16x32_bf16 v[80:83], v[116:119], a[136:139], v[80:83]
ds_read_b64_tr_b16 v[146:147], v160 offset:49664
v_mfma_f32_16x16x32_bf16 v[80:83], v[120:123], a[144:147], v[80:83]
ds_read_b64_tr_b16 v[148:149], v160 offset:50176
v_mfma_f32_16x16x32_bf16 v[80:83], v[124:127], a[152:155], v[80:83]
ds_read_b64_tr_b16 v[150:151], v160 offset:50688
v_mfma_f32_16x16x32_bf16 v[84:87], v[124:127], a[156:159], v[84:87]
ds_read_b64_tr_b16 v[152:153], v160 offset:51200
v_mfma_f32_16x16x32_bf16 v[84:87], v[120:123], a[148:151], v[84:87]
ds_read_b64_tr_b16 v[154:155], v160 offset:51712
ds_read_b64_tr_b16 v[156:157], v160 offset:52224
s_add_u32 s59, s59, 4294966272
v_mfma_f32_16x16x32_bf16 v[84:87], v[116:119], a[140:143], v[84:87]
buffer_load_dwordx4 v236, s[28:31], s59 offen offset:3072 lds
v_mfma_f32_16x16x32_bf16 v[84:87], v[112:115], a[132:135], v[84:87]
ds_read_b64_tr_b16 v[158:159], v160 offset:52736
s_waitcnt lgkmcnt(8)
v_mfma_f32_16x16x32_bf16 v[88:91], v[128:131], a[128:131], v[88:91]
ds_read_b64_tr_b16 v[112:113], v161 offset:49152
v_mfma_f32_16x16x32_bf16 v[88:91], v[132:135], a[136:139], v[88:91]
ds_read_b64_tr_b16 v[114:115], v161 offset:49664
v_mfma_f32_16x16x32_bf16 v[88:91], v[136:139], a[144:147], v[88:91]
ds_read_b64_tr_b16 v[116:117], v161 offset:50176
v_mfma_f32_16x16x32_bf16 v[88:91], v[140:143], a[152:155], v[88:91]
ds_read_b64_tr_b16 v[118:119], v161 offset:50688
v_mfma_f32_16x16x32_bf16 v[92:95], v[140:143], a[156:159], v[92:95]
ds_read_b64_tr_b16 v[120:121], v161 offset:51200
v_mfma_f32_16x16x32_bf16 v[92:95], v[136:139], a[148:151], v[92:95]
ds_read_b64_tr_b16 v[122:123], v161 offset:51712
v_mfma_f32_16x16x32_bf16 v[92:95], v[132:135], a[140:143], v[92:95]
ds_read_b64_tr_b16 v[124:125], v161 offset:52224
v_mfma_f32_16x16x32_bf16 v[92:95], v[128:131], a[132:135], v[92:95]
ds_read_b64_tr_b16 v[126:127], v161 offset:52736
s_waitcnt lgkmcnt(8)
v_mfma_f32_16x16x32_bf16 v[64:67], v[144:147], a[160:163], v[64:67]
ds_read_b64_tr_b16 v[128:129], v162 offset:49152
ds_read_b64_tr_b16 v[130:131], v162 offset:49664
s_add_u32 m0, s80, 114688
v_mfma_f32_16x16x32_bf16 v[64:67], v[148:151], a[168:171], v[64:67]
buffer_load_dwordx4 v237, s[32:35], s60 offen lds
v_mfma_f32_16x16x32_bf16 v[64:67], v[152:155], a[176:179], v[64:67]
ds_read_b64_tr_b16 v[132:133], v162 offset:50176
v_mfma_f32_16x16x32_bf16 v[64:67], v[156:159], a[184:187], v[64:67]
ds_read_b64_tr_b16 v[134:135], v162 offset:50688
v_mfma_f32_16x16x32_bf16 v[68:71], v[156:159], a[188:191], v[68:71]
ds_read_b64_tr_b16 v[136:137], v162 offset:51200
v_mfma_f32_16x16x32_bf16 v[68:71], v[152:155], a[180:183], v[68:71]
ds_read_b64_tr_b16 v[138:139], v162 offset:51712
ds_read_b64_tr_b16 v[140:141], v162 offset:52224
v_mfma_f32_16x16x32_bf16 v[68:71], v[148:151], a[172:175], v[68:71]
buffer_load_dwordx4 v237, s[32:35], s61 offen offset:1024 lds
v_mfma_f32_16x16x32_bf16 v[68:71], v[144:147], a[164:167], v[68:71]
ds_read_b64_tr_b16 v[142:143], v162 offset:52736
s_waitcnt lgkmcnt(8)
v_mfma_f32_16x16x32_bf16 v[72:75], v[112:115], a[160:163], v[72:75]
ds_read_b64_tr_b16 v[144:145], v163 offset:49152
v_mfma_f32_16x16x32_bf16 v[72:75], v[116:119], a[168:171], v[72:75]
ds_read_b64_tr_b16 v[146:147], v163 offset:49664
v_mfma_f32_16x16x32_bf16 v[72:75], v[120:123], a[176:179], v[72:75]
ds_read_b64_tr_b16 v[148:149], v163 offset:50176
ds_read_b64_tr_b16 v[150:151], v163 offset:50688
v_mfma_f32_16x16x32_bf16 v[72:75], v[124:127], a[184:187], v[72:75]
buffer_load_dwordx4 v237, s[32:35], s62 offen offset:2048 lds
v_mfma_f32_16x16x32_bf16 v[76:79], v[124:127], a[188:191], v[76:79]
ds_read_b64_tr_b16 v[152:153], v163 offset:51200
v_mfma_f32_16x16x32_bf16 v[76:79], v[120:123], a[180:183], v[76:79]
ds_read_b64_tr_b16 v[154:155], v163 offset:51712
v_mfma_f32_16x16x32_bf16 v[76:79], v[116:119], a[172:175], v[76:79]
ds_read_b64_tr_b16 v[156:157], v163 offset:52224
ds_read_b64_tr_b16 v[158:159], v163 offset:52736
v_mfma_f32_16x16x32_bf16 v[76:79], v[112:115], a[164:167], v[76:79]
s_waitcnt vmcnt(16) lgkmcnt(8)
s_barrier
v_mfma_f32_16x16x32_bf16 v[80:83], v[128:131], a[160:163], v[80:83]
ds_read_b64_tr_b16 v[112:113], v170 offset:0
ds_read_b64_tr_b16 v[114:115], v170 offset:256
v_mfma_f32_16x16x32_bf16 v[80:83], v[132:135], a[168:171], v[80:83]
buffer_load_dwordx4 v237, s[32:35], s63 offen offset:3072 lds
v_mfma_f32_16x16x32_bf16 v[80:83], v[136:139], a[176:179], v[80:83]
ds_read_b64_tr_b16 v[116:117], v170 offset:8192
v_mfma_f32_16x16x32_bf16 v[80:83], v[140:143], a[184:187], v[80:83]
ds_read_b64_tr_b16 v[118:119], v170 offset:8448
v_mfma_f32_16x16x32_bf16 v[84:87], v[140:143], a[188:191], v[84:87]
ds_read_b64_tr_b16 v[120:121], v170 offset:1024
ds_read_b64_tr_b16 v[122:123], v170 offset:1280
s_add_u32 m0, s80, 16384
v_mfma_f32_16x16x32_bf16 v[84:87], v[136:139], a[180:183], v[84:87]
buffer_load_dwordx4 v237, s[32:35], s64 offen lds
v_mfma_f32_16x16x32_bf16 v[84:87], v[132:135], a[172:175], v[84:87]
ds_read_b64_tr_b16 v[124:125], v170 offset:9216
v_mfma_f32_16x16x32_bf16 v[84:87], v[128:131], a[164:167], v[84:87]
ds_read_b64_tr_b16 v[126:127], v170 offset:9472
s_waitcnt lgkmcnt(8)
v_mfma_f32_16x16x32_bf16 v[88:91], v[144:147], a[160:163], v[88:91]
ds_read_b64_tr_b16 v[128:129], v171 offset:0
v_mfma_f32_16x16x32_bf16 v[88:91], v[148:151], a[168:171], v[88:91]
ds_read_b64_tr_b16 v[130:131], v171 offset:256
v_mfma_f32_16x16x32_bf16 v[88:91], v[152:155], a[176:179], v[88:91]
ds_read_b64_tr_b16 v[132:133], v171 offset:8192
ds_read_b64_tr_b16 v[134:135], v171 offset:8448
v_mfma_f32_16x16x32_bf16 v[88:91], v[156:159], a[184:187], v[88:91]
buffer_load_dwordx4 v237, s[32:35], s65 offen offset:1024 lds
v_mfma_f32_16x16x32_bf16 v[92:95], v[156:159], a[188:191], v[92:95]
ds_read_b64_tr_b16 v[136:137], v171 offset:1024
buffer_load_dword v243, v241, s[40:43], s86 offen offset:1024 sc1
v_mfma_f32_16x16x32_bf16 v[92:95], v[152:155], a[180:183], v[92:95]
ds_read_b64_tr_b16 v[138:139], v171 offset:1280
v_mfma_f32_16x16x32_bf16 v[92:95], v[148:151], a[172:175], v[92:95]
ds_read_b64_tr_b16 v[140:141], v171 offset:9216
v_mfma_f32_16x16x32_bf16 v[92:95], v[144:147], a[164:167], v[92:95]
ds_read_b64_tr_b16 v[142:143], v171 offset:9472
s_waitcnt lgkmcnt(8)
v_mfma_f32_16x16x32_bf16 v[96:99], v[112:115], a[128:131], v[96:99]
ds_read_b64_tr_b16 v[144:145], v170 offset:2048
v_mfma_f32_16x16x32_bf16 v[96:99], v[116:119], a[136:139], v[96:99]
ds_read_b64_tr_b16 v[146:147], v170 offset:2304
v_mfma_f32_16x16x32_bf16 v[96:99], v[120:123], a[144:147], v[96:99]
ds_read_b64_tr_b16 v[148:149], v170 offset:10240
v_mfma_f32_16x16x32_bf16 v[96:99], v[124:127], a[152:155], v[96:99]
ds_read_b64_tr_b16 v[150:151], v170 offset:10496
v_mfma_f32_16x16x32_bf16 v[100:103], v[124:127], a[156:159], v[100:103]
ds_read_b64_tr_b16 v[152:153], v170 offset:3072
v_mfma_f32_16x16x32_bf16 v[100:103], v[120:123], a[148:151], v[100:103]
ds_read_b64_tr_b16 v[154:155], v170 offset:3328
v_mfma_f32_16x16x32_bf16 v[100:103], v[116:119], a[140:143], v[100:103]
ds_read_b64_tr_b16 v[156:157], v170 offset:11264
v_mfma_f32_16x16x32_bf16 v[100:103], v[112:115], a[132:135], v[100:103]
ds_read_b64_tr_b16 v[158:159], v170 offset:11520
s_waitcnt lgkmcnt(8)
v_mfma_f32_16x16x32_bf16 v[104:107], v[128:131], a[128:131], v[104:107]
ds_read_b64_tr_b16 v[112:113], v171 offset:2048
v_mfma_f32_16x16x32_bf16 v[104:107], v[132:135], a[136:139], v[104:107]
ds_read_b64_tr_b16 v[114:115], v171 offset:2304
ds_read_b64_tr_b16 v[116:117], v171 offset:10240
v_mfma_f32_16x16x32_bf16 v[104:107], v[136:139], a[144:147], v[104:107]
buffer_load_dwordx4 v237, s[32:35], s66 offen offset:2048 lds
v_mfma_f32_16x16x32_bf16 v[104:107], v[140:143], a[152:155], v[104:107]
ds_read_b64_tr_b16 v[118:119], v171 offset:10496
v_mfma_f32_16x16x32_bf16 v[108:111], v[140:143], a[156:159], v[108:111]
ds_read_b64_tr_b16 v[120:121], v171 offset:3072
v_mfma_f32_16x16x32_bf16 v[108:111], v[136:139], a[148:151], v[108:111]
ds_read_b64_tr_b16 v[122:123], v171 offset:3328
v_mfma_f32_16x16x32_bf16 v[108:111], v[132:135], a[140:143], v[108:111]
ds_read_b64_tr_b16 v[124:125], v171 offset:11264
v_mfma_f32_16x16x32_bf16 v[108:111], v[128:131], a[132:135], v[108:111]
ds_read_b64_tr_b16 v[126:127], v171 offset:11520
s_waitcnt lgkmcnt(8)
v_mfma_f32_16x16x32_bf16 v[96:99], v[144:147], a[160:163], v[96:99]
ds_read_b64_tr_b16 v[128:129], v160 offset:0
ds_read_b64_tr_b16 v[130:131], v160 offset:512
v_mfma_f32_16x16x32_bf16 v[96:99], v[148:151], a[168:171], v[96:99]
buffer_load_dwordx4 v237, s[32:35], s67 offen offset:3072 lds
v_mfma_f32_16x16x32_bf16 v[96:99], v[152:155], a[176:179], v[96:99]
ds_read_b64_tr_b16 v[132:133], v160 offset:1024
s_waitcnt vmcnt(14)
v_xor_b32 v189, v189, v242
v_mfma_f32_16x16x32_bf16 v[96:99], v[156:159], a[184:187], v[96:99]
ds_read_b64_tr_b16 v[134:135], v160 offset:1536
v_bitop3_b32 v189, v189, v191, v242 bitop3:0xf6
v_mfma_f32_16x16x32_bf16 v[100:103], v[156:159], a[188:191], v[100:103]
ds_read_b64_tr_b16 v[136:137], v160 offset:2048
ds_read_b64_tr_b16 v[138:139], v160 offset:2560
s_add_u32 m0, s80, 32768
v_mfma_f32_16x16x32_bf16 v[100:103], v[152:155], a[180:183], v[100:103]
buffer_load_dwordx4 v238, s[32:35], s60 offen lds
v_mfma_f32_16x16x32_bf16 v[100:103], v[148:151], a[172:175], v[100:103]
ds_read_b64_tr_b16 v[140:141], v160 offset:3072
s_waitcnt vmcnt(14)
v_bitop3_b32 v189, v189, v193, v242 bitop3:0xf6
v_mfma_f32_16x16x32_bf16 v[100:103], v[144:147], a[164:167], v[100:103]
ds_read_b64_tr_b16 v[142:143], v160 offset:3584
s_waitcnt lgkmcnt(8)
v_mfma_f32_16x16x32_bf16 v[104:107], v[112:115], a[160:163], v[104:107]
ds_read_b64_tr_b16 v[144:145], v161 offset:0
ds_read_b64_tr_b16 v[146:147], v161 offset:512
v_mfma_f32_16x16x32_bf16 v[104:107], v[116:119], a[168:171], v[104:107]
buffer_load_dwordx4 v238, s[32:35], s61 offen offset:1024 lds
v_mfma_f32_16x16x32_bf16 v[104:107], v[120:123], a[176:179], v[104:107]
ds_read_b64_tr_b16 v[148:149], v161 offset:1024
v_bitop3_b32 v189, v189, v195, v242 bitop3:0xf6
v_mfma_f32_16x16x32_bf16 v[104:107], v[124:127], a[184:187], v[104:107]
ds_read_b64_tr_b16 v[150:151], v161 offset:1536
s_waitcnt vmcnt(14)
v_bitop3_b32 v189, v189, v197, v242 bitop3:0xf6
v_mfma_f32_16x16x32_bf16 v[108:111], v[124:127], a[188:191], v[108:111]
ds_read_b64_tr_b16 v[152:153], v161 offset:2048
v_bitop3_b32 v189, v189, v199, v242 bitop3:0xf6
v_mfma_f32_16x16x32_bf16 v[108:111], v[120:123], a[180:183], v[108:111]
ds_read_b64_tr_b16 v[154:155], v161 offset:2560
ds_read_b64_tr_b16 v[156:157], v161 offset:3072
v_mfma_f32_16x16x32_bf16 v[108:111], v[116:119], a[172:175], v[108:111]
buffer_load_dwordx4 v238, s[32:35], s62 offen offset:2048 lds
s_waitcnt vmcnt(14)
v_bitop3_b32 v189, v189, v201, v242 bitop3:0xf6
v_mfma_f32_16x16x32_bf16 v[108:111], v[112:115], a[164:167], v[108:111]
ds_read_b64_tr_b16 v[158:159], v161 offset:3584
v_bitop3_b32 v189, v189, v203, v242 bitop3:0xf6
s_waitcnt lgkmcnt(8)
v_mfma_f32_16x16x32_bf16 v[64:67], v[128:131], a[192:195], v[64:67]
ds_read_b64_tr_b16 v[112:113], v162 offset:0
v_cmp_ne_u32 vcc, 0, v189
s_cbranch_vccnz L_slow2
L_back2:
v_mfma_f32_16x16x32_bf16 v[64:67], v[132:135], a[200:203], v[64:67]
ds_read_b64_tr_b16 v[114:115], v162 offset:512
v_add_f32 v188, v188, v192
v_add_f32 v190, v190, v194
v_mfma_f32_16x16x32_bf16 v[64:67], v[136:139], a[208:211], v[64:67]
ds_read_b64_tr_b16 v[116:117], v162 offset:1024
ds_read_b64_tr_b16 v[118:119], v162 offset:1536
v_add_f32 v196, v196, v200
v_mfma_f32_16x16x32_bf16 v[64:67], v[140:143], a[216:219], v[64:67]
buffer_load_dwordx4 v238, s[32:35], s63 offen offset:3072 lds
v_add_f32 v198, v198, v202
v_mfma_f32_16x16x32_bf16 v[68:71], v[140:143], a[220:223], v[68:71]
ds_read_b64_tr_b16 v[120:121], v162 offset:2048
v_add_f32 v188, v188, v196
v_add_f32 v190, v190, v198
v_mfma_f32_16x16x32_bf16 v[68:71], v[136:139], a[212:215], v[68:71]
ds_read_b64_tr_b16 v[122:123], v162 offset:2560
v_lshlrev_b32 v250, 16, v250
v_mul_f32 v250, s77, v250
v_mfma_f32_16x16x32_bf16 v[68:71], v[132:135], a[204:207], v[68:71]
ds_read_b64_tr_b16 v[124:125], v162 offset:3072
v_permlane16_swap_b32 v188, v190
v_add_f32 v188, v188, v190
v_mfma_f32_16x16x32_bf16 v[68:71], v[128:131], a[196:199], v[68:71]
ds_read_b64_tr_b16 v[126:127], v162 offset:3584
v_mov_b32 v190, v188
s_waitcnt lgkmcnt(8)
v_mfma_f32_16x16x32_bf16 v[72:75], v[144:147], a[192:195], v[72:75]
ds_read_b64_tr_b16 v[128:129], v163 offset:0
ds_write_b32 v249, v250 offset:1536
v_mfma_f32_16x16x32_bf16 v[72:75], v[148:151], a[200:203], v[72:75]
ds_read_b64_tr_b16 v[130:131], v163 offset:512
v_permlane32_swap_b32 v188, v190
v_mfma_f32_16x16x32_bf16 v[72:75], v[152:155], a[208:211], v[72:75]
ds_read_b64_tr_b16 v[132:133], v163 offset:1024
v_add_f32 v188, v188, v190
v_mfma_f32_16x16x32_bf16 v[72:75], v[156:159], a[216:219], v[72:75]
ds_read_b64_tr_b16 v[134:135], v163 offset:1536
ds_write_b32 v249, v188 offset:512
v_mfma_f32_16x16x32_bf16 v[76:79], v[156:159], a[220:223], v[76:79]
ds_read_b64_tr_b16 v[136:137], v163 offset:2048
s_waitcnt vmcnt(6)
v_mfma_f32_16x16x32_bf16 v[76:79], v[152:155], a[212:215], v[76:79]
ds_read_b64_tr_b16 v[138:139], v163 offset:2560
v_sub_u32 v243, v243, v242
v_mfma_f32_16x16x32_bf16 v[76:79], v[148:151], a[204:207], v[76:79]
ds_read_b64_tr_b16 v[140:141], v163 offset:3072
ds_read_b64_tr_b16 v[142:143], v163 offset:3584
v_mfma_f32_16x16x32_bf16 v[76:79], v[144:147], a[196:199], v[76:79]
v_add_u32 v243, -1, v243
s_waitcnt lgkmcnt(4)
s_barrier
v_mfma_f32_16x16x32_bf16 v[80:83], v[112:115], a[192:195], v[80:83]
ds_read_b64_tr_b16 v[144:145], v164 offset:16384
ds_read_b64_tr_b16 v[146:147], v164 offset:16896
s_add_u32 m0, s80, 49152
v_cmp_le_u32 vcc, 15, v243
s_cbranch_vccnz L_slow3
L_back3:
v_mfma_f32_16x16x32_bf16 v[80:83], v[116:119], a[200:203], v[80:83]
buffer_load_dwordx4 v238, s[32:35], s64 offen lds
v_mfma_f32_16x16x32_bf16 v[80:83], v[120:123], a[208:211], v[80:83]
ds_read_b64_tr_b16 v[148:149], v164 offset:17408
v_mfma_f32_16x16x32_bf16 v[80:83], v[124:127], a[216:219], v[80:83]
ds_read_b64_tr_b16 v[150:151], v164 offset:17920
ds_read_b64_tr_b16 v[152:153], v164 offset:18432
v_mfma_f32_16x16x32_bf16 v[84:87], v[124:127], a[220:223], v[84:87]
buffer_load_dwordx4 a[0:3], v240, s[40:43], s8 offen offset:0 sc1
v_mfma_f32_16x16x32_bf16 v[84:87], v[120:123], a[212:215], v[84:87]
ds_read_b64_tr_b16 v[154:155], v164 offset:18944
v_mfma_f32_16x16x32_bf16 v[84:87], v[116:119], a[204:207], v[84:87]
ds_read_b64_tr_b16 v[156:157], v164 offset:19456
v_mfma_f32_16x16x32_bf16 v[84:87], v[112:115], a[196:199], v[84:87]
ds_read_b64_tr_b16 v[158:159], v164 offset:19968
s_waitcnt lgkmcnt(8)
v_mfma_f32_16x16x32_bf16 v[88:91], v[128:131], a[192:195], v[88:91]
ds_read_b64_tr_b16 v[112:113], v165 offset:16384
ds_read_b64_tr_b16 v[114:115], v165 offset:16896
v_mfma_f32_16x16x32_bf16 v[88:91], v[132:135], a[200:203], v[88:91]
buffer_load_dwordx4 a[4:7], v240, s[40:43], s8 offen offset:128 sc1
v_mfma_f32_16x16x32_bf16 v[88:91], v[136:139], a[208:211], v[88:91]
ds_read_b64_tr_b16 v[116:117], v165 offset:17408
L_pad5:
s_cbranch_execz L_warm1
v_mfma_f32_16x16x32_bf16 v[88:91], v[140:143], a[216:219], v[88:91]
ds_read_b64_tr_b16 v[118:119], v165 offset:17920
ds_read_b64_tr_b16 v[120:121], v165 offset:18432
v_mfma_f32_16x16x32_bf16 v[92:95], v[140:143], a[220:223], v[92:95]
buffer_load_dwordx4 a[8:11], v240, s[40:43], s9 offen offset:0 sc1
v_mfma_f32_16x16x32_bf16 v[92:95], v[136:139], a[212:215], v[92:95]
ds_read_b64_tr_b16 v[122:123], v165 offset:18944
v_mfma_f32_16x16x32_bf16 v[92:95], v[132:135], a[204:207], v[92:95]
ds_read_b64_tr_b16 v[124:125], v165 offset:19456
v_mfma_f32_16x16x32_bf16 v[92:95], v[128:131], a[196:199], v[92:95]
ds_read_b64_tr_b16 v[126:127], v165 offset:19968
s_waitcnt lgkmcnt(8)
v_mfma_f32_16x16x32_bf16 v[64:67], v[144:147], a[224:227], v[64:67]
ds_read_b64_tr_b16 v[128:129], v166 offset:16384
ds_read_b64_tr_b16 v[130:131], v166 offset:16896
v_mfma_f32_16x16x32_bf16 v[64:67], v[148:151], a[232:235], v[64:67]
buffer_load_dwordx4 a[12:15], v240, s[40:43], s9 offen offset:128 sc1
v_mfma_f32_16x16x32_bf16 v[64:67], v[152:155], a[240:243], v[64:67]
ds_read_b64_tr_b16 v[132:133], v166 offset:17408
v_mfma_f32_16x16x32_bf16 v[64:67], v[156:159], a[248:251], v[64:67]
ds_read_b64_tr_b16 v[134:135], v166 offset:17920
ds_read_b64_tr_b16 v[136:137], v166 offset:18432
v_mfma_f32_16x16x32_bf16 v[68:71], v[156:159], a[252:255], v[68:71]
buffer_load_dwordx4 a[16:19], v240, s[40:43], s10 offen offset:0 sc1
v_mfma_f32_16x16x32_bf16 v[68:71], v[152:155], a[244:247], v[68:71]
ds_read_b64_tr_b16 v[138:139], v166 offset:18944
v_mfma_f32_16x16x32_bf16 v[68:71], v[148:151], a[236:239], v[68:71]
ds_read_b64_tr_b16 v[140:141], v166 offset:19456
v_mfma_f32_16x16x32_bf16 v[68:71], v[144:147], a[228:231], v[68:71]
ds_read_b64_tr_b16 v[142:143], v166 offset:19968
s_waitcnt lgkmcnt(8)
v_mfma_f32_16x16x32_bf16 v[72:75], v[112:115], a[224:227], v[72:75]
ds_read_b64_tr_b16 v[144:145], v167 offset:16384
ds_read_b64_tr_b16 v[146:147], v167 offset:16896
v_mfma_f32_16x16x32_bf16 v[72:75], v[116:119], a[232:235], v[72:75]
buffer_load_dwordx4 a[20:23], v240, s[40:43], s10 offen offset:128 sc1
v_mfma_f32_16x16x32_bf16 v[72:75], v[120:123], a[240:243], v[72:75]
ds_read_b64_tr_b16 v[148:149], v167 offset:17408
v_mfma_f32_16x16x32_bf16 v[72:75], v[124:127], a[248:251], v[72:75]
ds_read_b64_tr_b16 v[150:151], v167 offset:17920
ds_read_b64_tr_b16 v[152:153], v167 offset:18432
v_mfma_f32_16x16x32_bf16 v[76:79], v[124:127], a[252:255], v[76:79]
buffer_load_dwordx4 a[24:27], v240, s[40:43], s11 offen offset:0 sc1
v_mfma_f32_16x16x32_bf16 v[76:79], v[120:123], a[244:247], v[76:79]
ds_read_b64_tr_b16 v[154:155], v167 offset:18944
v_mfma_f32_16x16x32_bf16 v[76:79], v[116:119], a[236:239], v[76:79]
ds_read_b64_tr_b16 v[156:157], v167 offset:19456
v_mfma_f32_16x16x32_bf16 v[76:79], v[112:115], a[228:231], v[76:79]
ds_read_b64_tr_b16 v[158:159], v167 offset:19968
s_waitcnt lgkmcnt(8)
v_mfma_f32_16x16x32_bf16 v[80:83], v[128:131], a[224:227], v[80:83]
ds_read_b64_tr_b16 v[112:113], v170 offset:32768
ds_read_b64_tr_b16 v[114:115], v170 offset:33024
v_mfma_f32_16x16x32_bf16 v[80:83], v[132:135], a[232:235], v[80:83]
buffer_load_dwordx4 a[28:31], v240, s[40:43], s11 offen offset:128 sc1
v_mfma_f32_16x16x32_bf16 v[80:83], v[136:139], a[240:243], v[80:83]
ds_read_b64_tr_b16 v[116:117], v170 offset:40960
v_add_u32 v160, v160, v247
v_mfma_f32_16x16x32_bf16 v[80:83], v[140:143], a[248:251], v[80:83]
ds_read_b64_tr_b16 v[118:119], v170 offset:41216
v_add_u32 v161, v161, v247
v_mfma_f32_16x16x32_bf16 v[84:87], v[140:143], a[252:255], v[84:87]
ds_read_b64_tr_b16 v[120:121], v170 offset:33792
ds_read_b64_tr_b16 v[122:123], v170 offset:34048
v_add_u32 v240, 4096, v240
v_mfma_f32_16x16x32_bf16 v[84:87], v[136:139], a[244:247], v[84:87]
buffer_load_dwordx4 a[32:35], v240, s[40:43], s8 offen offset:0 sc1
v_mfma_f32_16x16x32_bf16 v[84:87], v[132:135], a[236:239], v[84:87]
ds_read_b64_tr_b16 v[124:125], v170 offset:41984
v_add_u32 v162, v162, v247
v_mfma_f32_16x16x32_bf16 v[84:87], v[128:131], a[228:231], v[84:87]
ds_read_b64_tr_b16 v[126:127], v170 offset:42240
s_waitcnt lgkmcnt(8)
v_mfma_f32_16x16x32_bf16 v[88:91], v[144:147], a[224:227], v[88:91]
ds_read_b64_tr_b16 v[128:129], v171 offset:32768
ds_read_b64_tr_b16 v[130:131], v171 offset:33024
v_mfma_f32_16x16x32_bf16 v[88:91], v[148:151], a[232:235], v[88:91]
buffer_load_dwordx4 a[36:39], v240, s[40:43], s8 offen offset:128 sc1
v_mfma_f32_16x16x32_bf16 v[88:91], v[152:155], a[240:243], v[88:91]
ds_read_b64_tr_b16 v[132:133], v171 offset:40960
v_add_u32 v163, v163, v247
v_mfma_f32_16x16x32_bf16 v[88:91], v[156:159], a[248:251], v[88:91]
ds_read_b64_tr_b16 v[134:135], v171 offset:41216
v_add_u32 v164, v164, v247
v_mfma_f32_16x16x32_bf16 v[92:95], v[156:159], a[252:255], v[92:95]
ds_read_b64_tr_b16 v[136:137], v171 offset:33792
ds_read_b64_tr_b16 v[138:139], v171 offset:34048
v_mfma_f32_16x16x32_bf16 v[92:95], v[152:155], a[244:247], v[92:95]
buffer_load_dwordx4 a[40:43], v240, s[40:43], s9 offen offset:0 sc1
v_mfma_f32_16x16x32_bf16 v[92:95], v[148:151], a[236:239], v[92:95]
ds_read_b64_tr_b16 v[140:141], v171 offset:41984
v_add_u32 v165, v165, v247
v_mfma_f32_16x16x32_bf16 v[92:95], v[144:147], a[228:231], v[92:95]
ds_read_b64_tr_b16 v[142:143], v171 offset:42240
s_waitcnt lgkmcnt(8)
v_mfma_f32_16x16x32_bf16 v[96:99], v[112:115], a[192:195], v[96:99]
ds_read_b64_tr_b16 v[144:145], v170 offset:34816
ds_read_b64_tr_b16 v[146:147], v170 offset:35072
v_mfma_f32_16x16x32_bf16 v[96:99], v[116:119], a[200:203], v[96:99]
buffer_load_dwordx4 a[44:47], v240, s[40:43], s9 offen offset:128 sc1
v_mfma_f32_16x16x32_bf16 v[96:99], v[120:123], a[208:211], v[96:99]
ds_read_b64_tr_b16 v[148:149], v170 offset:43008
v_add_u32 v166, v166, v247
v_mfma_f32_16x16x32_bf16 v[96:99], v[124:127], a[216:219], v[96:99]
ds_read_b64_tr_b16 v[150:151], v170 offset:43264
v_add_u32 v167, v167, v247
v_mfma_f32_16x16x32_bf16 v[100:103], v[124:127], a[220:223], v[100:103]
ds_read_b64_tr_b16 v[152:153], v170 offset:35840
ds_read_b64_tr_b16 v[154:155], v170 offset:36096
v_mfma_f32_16x16x32_bf16 v[100:103], v[120:123], a[212:215], v[100:103]
buffer_load_dwordx4 a[48:51], v240, s[40:43], s10 offen offset:0 sc1
v_mfma_f32_16x16x32_bf16 v[100:103], v[116:119], a[204:207], v[100:103]
ds_read_b64_tr_b16 v[156:157], v170 offset:44032
ds_read_b128 v[172:175], v245 offset:512
v_mfma_f32_16x16x32_bf16 v[100:103], v[112:115], a[196:199], v[100:103]
ds_read_b64_tr_b16 v[158:159], v170 offset:44288
ds_read_b128 v[180:183], v245 offset:1536
s_waitcnt lgkmcnt(10)
v_mfma_f32_16x16x32_bf16 v[104:107], v[128:131], a[192:195], v[104:107]
ds_read_b64_tr_b16 v[112:113], v171 offset:34816
ds_read_b64_tr_b16 v[114:115], v171 offset:35072
ds_read_b128 v[176:179], v245 offset:576
v_mfma_f32_16x16x32_bf16 v[104:107], v[132:135], a[200:203], v[104:107]
buffer_load_dwordx4 a[52:55], v240, s[40:43], s10 offen offset:128 sc1
ds_read_b128 v[184:187], v245 offset:1600
v_mfma_f32_16x16x32_bf16 v[104:107], v[136:139], a[208:211], v[104:107]
ds_read_b64_tr_b16 v[116:117], v171 offset:43008
s_mov_b32 s44, 266240
v_mfma_f32_16x16x32_bf16 v[104:107], v[140:143], a[216:219], v[104:107]
ds_read_b64_tr_b16 v[118:119], v171 offset:43264
s_mov_b32 s45, 789504
s_waitcnt lgkmcnt(6)
v_pk_fma_f32 v[188:189], v[230:231], v[172:173], v[180:181] op_sel:[0,0,0] op_sel_hi:[0,1,1]
v_pk_fma_f32 v[190:191], v[230:231], v[174:175], v[182:183] op_sel:[0,0,0] op_sel_hi:[0,1,1]
v_pk_fma_f32 v[192:193], v[230:231], v[172:173], v[180:181] op_sel:[1,0,0] op_sel_hi:[1,1,1]
v_pk_fma_f32 v[194:195], v[230:231], v[174:175], v[182:183] op_sel:[1,0,0] op_sel_hi:[1,1,1]
s_waitcnt lgkmcnt(2)
v_pk_fma_f32 v[196:197], v[230:231], v[176:177], v[184:185] op_sel:[0,0,0] op_sel_hi:[0,1,1]
v_pk_fma_f32 v[198:199], v[230:231], v[178:179], v[186:187] op_sel:[0,0,0] op_sel_hi:[0,1,1]
v_pk_fma_f32 v[200:201], v[230:231], v[176:177], v[184:185] op_sel:[1,0,0] op_sel_hi:[1,1,1]
v_pk_fma_f32 v[202:203], v[230:231], v[178:179], v[186:187] op_sel:[1,0,0] op_sel_hi:[1,1,1]
buffer_load_dwordx4 a[56:59], v240, s[40:43], s11 offen offset:0 sc1
v_pk_fma_f32 v[64:65], v[228:229], v[64:65], v[188:189] op_sel:[0,0,0] op_sel_hi:[0,1,1]
v_pk_fma_f32 v[66:67], v[228:229], v[66:67], v[190:191] op_sel:[0,0,0] op_sel_hi:[0,1,1]
v_pk_fma_f32 v[68:69], v[228:229], v[68:69], v[192:193] op_sel:[1,0,0] op_sel_hi:[1,1,1]
v_pk_fma_f32 v[70:71], v[228:229], v[70:71], v[194:195] op_sel:[1,0,0] op_sel_hi:[1,1,1]
v_pk_fma_f32 v[72:73], v[228:229], v[72:73], v[196:197] op_sel:[0,0,0] op_sel_hi:[0,1,1]
v_pk_fma_f32 v[74:75], v[228:229], v[74:75], v[198:199] op_sel:[0,0,0] op_sel_hi:[0,1,1]
v_pk_fma_f32 v[76:77], v[228:229], v[76:77], v[200:201] op_sel:[1,0,0] op_sel_hi:[1,1,1]
v_pk_fma_f32 v[78:79], v[228:229], v[78:79], v[202:203] op_sel:[1,0,0] op_sel_hi:[1,1,1]
v_pk_fma_f32 v[188:189], v[64:65], v[64:65], s[76:77] op_sel_hi:[1,1,0]
v_pk_fma_f32 v[190:191], v[66:67], v[66:67], s[76:77] op_sel_hi:[1,1,0]
v_pk_fma_f32 v[192:193], v[68:69], v[68:69], s[76:77] op_sel_hi:[1,1,0]
v_pk_fma_f32 v[194:195], v[70:71], v[70:71], s[76:77] op_sel_hi:[1,1,0]
v_pk_fma_f32 v[196:197], v[72:73], v[72:73], s[76:77] op_sel_hi:[1,1,0]
v_pk_fma_f32 v[198:199], v[74:75], v[74:75], s[76:77] op_sel_hi:[1,1,0]
v_pk_fma_f32 v[200:201], v[76:77], v[76:77], s[76:77] op_sel_hi:[1,1,0]
v_pk_fma_f32 v[202:203], v[78:79], v[78:79], s[76:77] op_sel_hi:[1,1,0]
buffer_load_dwordx4 a[60:63], v240, s[40:43], s11 offen offset:128 sc1
v_pk_mul_f32 v[188:189], v[188:189], v[64:65]
v_pk_mul_f32 v[190:191], v[190:191], v[66:67]
v_pk_mul_f32 v[192:193], v[192:193], v[68:69]
v_pk_mul_f32 v[194:195], v[194:195], v[70:71]
v_pk_mul_f32 v[196:197], v[196:197], v[72:73]
v_pk_mul_f32 v[198:199], v[198:199], v[74:75]
v_pk_mul_f32 v[200:201], v[200:201], v[76:77]
v_pk_mul_f32 v[202:203], v[202:203], v[78:79]
v_exp_f32 v188, v188
v_exp_f32 v189, v189
v_exp_f32 v190, v190
v_exp_f32 v191, v191
buffer_load_dwordx4 v238, s[32:35], s65 offen offset:1024 lds
v_exp_f32 v192, v192
v_exp_f32 v193, v193
v_exp_f32 v194, v194
v_exp_f32 v195, v195
v_exp_f32 v196, v196
v_exp_f32 v197, v197
v_exp_f32 v198, v198
v_exp_f32 v199, v199
buffer_load_dwordx4 v238, s[32:35], s66 offen offset:2048 lds
v_exp_f32 v200, v200
v_exp_f32 v201, v201
v_exp_f32 v202, v202
v_exp_f32 v203, v203
v_pk_fma_f32 v[188:189], v[188:189], s[76:77], s[76:77] op_sel:[0,1,1] op_sel_hi:[1,1,1]
v_pk_fma_f32 v[190:191], v[190:191], s[76:77], s[76:77] op_sel:[0,1,1] op_sel_hi:[1,1,1]
v_pk_fma_f32 v[192:193], v[192:193], s[76:77], s[76:77] op_sel:[0,1,1] op_sel_hi:[1,1,1]
v_pk_fma_f32 v[194:195], v[194:195], s[76:77], s[76:77] op_sel:[0,1,1] op_sel_hi:[1,1,1]
v_pk_fma_f32 v[196:197], v[196:197], s[76:77], s[76:77] op_sel:[0,1,1] op_sel_hi:[1,1,1]
v_pk_fma_f32 v[198:199], v[198:199], s[76:77], s[76:77] op_sel:[0,1,1] op_sel_hi:[1,1,1]
v_pk_fma_f32 v[200:201], v[200:201], s[76:77], s[76:77] op_sel:[0,1,1] op_sel_hi:[1,1,1]
v_pk_fma_f32 v[202:203], v[202:203], s[76:77], s[76:77] op_sel:[0,1,1] op_sel_hi:[1,1,1]
buffer_load_dwordx4 v238, s[32:35], s67 offen offset:3072 lds
v_rcp_f32 v188, v188
v_rcp_f32 v189, v189
v_rcp_f32 v190, v190
v_rcp_f32 v191, v191
v_rcp_f32 v192, v192
v_rcp_f32 v193, v193
v_rcp_f32 v194, v194
v_rcp_f32 v195, v195
v_rcp_f32 v196, v196
v_rcp_f32 v197, v197
v_rcp_f32 v198, v198
v_rcp_f32 v199, v199
s_add_u32 m0, s80, 65536
s_nop 0
buffer_load_dwordx4 v232, s[32:35], s60 offen lds
v_rcp_f32 v200, v200
v_rcp_f32 v201, v201
v_rcp_f32 v202, v202
v_rcp_f32 v203, v203
v_pk_mul_f32 v[64:65], v[64:65], v[188:189]
v_pk_mul_f32 v[66:67], v[66:67], v[190:191]
v_pk_mul_f32 v[68:69], v[68:69], v[192:193]
v_pk_mul_f32 v[70:71], v[70:71], v[194:195]
v_pk_mul_f32 v[72:73], v[72:73], v[196:197]
v_pk_mul_f32 v[74:75], v[74:75], v[198:199]
v_pk_mul_f32 v[76:77], v[76:77], v[200:201]
v_pk_mul_f32 v[78:79], v[78:79], v[202:203]
v_mfma_f32_16x16x32_bf16 v[108:111], v[140:143], a[220:223], v[108:111]
ds_read_b64_tr_b16 v[120:121], v171 offset:35840
ds_read_b64_tr_b16 v[122:123], v171 offset:36096
v_mfma_f32_16x16x32_bf16 v[108:111], v[136:139], a[212:215], v[108:111]
buffer_load_dwordx4 v232, s[32:35], s61 offen offset:1024 lds
v_mfma_f32_16x16x32_bf16 v[108:111], v[132:135], a[204:207], v[108:111]
ds_read_b64_tr_b16 v[124:125], v171 offset:44032
ds_read_b64_tr_b16 v[126:127], v171 offset:44288
v_mfma_f32_16x16x32_bf16 v[108:111], v[128:131], a[196:199], v[108:111]
v_cvt_pk_bf16_f32 v204, v64, v65
s_waitcnt vmcnt(26)
s_barrier
v_mfma_f32_16x16x32_bf16 v[96:99], v[144:147], a[224:227], v[96:99]
ds_read_b64_tr_b16 v[128:129], v164 offset:49152
ds_read_b64_tr_b16 v[130:131], v164 offset:57344
v_mfma_f32_16x16x32_bf16 v[96:99], v[148:151], a[232:235], v[96:99]
buffer_load_dwordx4 v232, s[32:35], s62 offen offset:2048 lds
v_mfma_f32_16x16x32_bf16 v[96:99], v[152:155], a[240:243], v[96:99]
ds_read_b64_tr_b16 v[132:133], v164 offset:50176
v_cvt_pk_bf16_f32 v205, v66, v67
v_mfma_f32_16x16x32_bf16 v[96:99], v[156:159], a[248:251], v[96:99]
ds_read_b64_tr_b16 v[134:135], v164 offset:58368
v_cvt_pk_bf16_f32 v206, v72, v73
v_mfma_f32_16x16x32_bf16 v[100:103], v[156:159], a[252:255], v[100:103]
ds_read_b64_tr_b16 v[136:137], v164 offset:51200
v_cvt_pk_bf16_f32 v207, v74, v75
v_mfma_f32_16x16x32_bf16 v[100:103], v[152:155], a[244:247], v[100:103]
ds_read_b64_tr_b16 v[138:139], v164 offset:59392
ds_read_b64_tr_b16 v[140:141], v164 offset:52224
v_mfma_f32_16x16x32_bf16 v[100:103], v[148:151], a[236:239], v[100:103]
buffer_load_dwordx4 v232, s[32:35], s63 offen offset:3072 lds
v_cvt_pk_bf16_f32 v208, v68, v69
v_mfma_f32_16x16x32_bf16 v[100:103], v[144:147], a[228:231], v[100:103]
ds_read_b64_tr_b16 v[142:143], v164 offset:60416
s_waitcnt lgkmcnt(8)
v_mfma_f32_16x16x32_bf16 v[104:107], v[112:115], a[224:227], v[104:107]
ds_read_b64_tr_b16 v[144:145], v165 offset:49152
v_cvt_pk_bf16_f32 v209, v70, v71
v_mfma_f32_16x16x32_bf16 v[104:107], v[116:119], a[232:235], v[104:107]
ds_read_b64_tr_b16 v[146:147], v165 offset:57344
v_cvt_pk_bf16_f32 v210, v76, v77
v_mfma_f32_16x16x32_bf16 v[104:107], v[120:123], a[240:243], v[104:107]
ds_read_b64_tr_b16 v[148:149], v165 offset:50176
ds_read_b64_tr_b16 v[150:151], v165 offset:58368
v_mfma_f32_16x16x32_bf16 v[104:107], v[124:127], a[248:251], v[104:107]
buffer_store_dwordx4 v[204:207], v251, s[40:43], s88 offen offset:0 sc1
v_cvt_pk_bf16_f32 v211, v78, v79
v_mfma_f32_16x16x32_bf16 v[108:111], v[124:127], a[252:255], v[108:111]
ds_read_b64_tr_b16 v[152:153], v165 offset:51200
s_mov_b32 s46, 1181696
v_mfma_f32_16x16x32_bf16 v[108:111], v[120:123], a[244:247], v[108:111]
ds_read_b64_tr_b16 v[154:155], v165 offset:59392
s_mov_b32 s47, 1704960
v_mfma_f32_16x16x32_bf16 v[108:111], v[116:119], a[236:239], v[108:111]
ds_read_b64_tr_b16 v[156:157], v165 offset:52224
s_mov_b32 s48, 331776
v_mfma_f32_16x16x32_bf16 v[108:111], v[112:115], a[228:231], v[108:111]
ds_read_b64_tr_b16 v[158:159], v165 offset:60416
s_waitcnt vmcnt(16) lgkmcnt(8)
v_mfma_f32_16x16x32_bf16 v[0:3], v[128:131], a[0:3], 0
ds_read_b64_tr_b16 v[112:113], v166 offset:49152
ds_read_b64_tr_b16 v[114:115], v166 offset:57344
v_mfma_f32_16x16x32_bf16 v[0:3], v[132:135], a[8:11], v[0:3]
buffer_store_dwordx4 v[208:211], v251, s[40:43], s88 offen offset:128 sc1
v_mfma_f32_16x16x32_bf16 v[0:3], v[136:139], a[16:19], v[0:3]
ds_read_b64_tr_b16 v[116:117], v166 offset:50176
s_add_u32 s88, s88, 4096
v_mfma_f32_16x16x32_bf16 v[0:3], v[140:143], a[24:27], v[0:3]
ds_read_b64_tr_b16 v[118:119], v166 offset:58368
ds_read_b128 v[172:175], v245 offset:640
s_mov_b32 s49, 855040
v_mfma_f32_16x16x32_bf16 v[4:7], v[140:143], a[28:31], 0
ds_read_b64_tr_b16 v[120:121], v166 offset:51200
ds_read_b128 v[180:183], v245 offset:1664
v_mfma_f32_16x16x32_bf16 v[4:7], v[136:139], a[20:23], v[4:7]
ds_read_b64_tr_b16 v[122:123], v166 offset:59392
ds_read_b64_tr_b16 v[124:125], v166 offset:52224
s_add_u32 m0, s80, 0
s_mov_b32 s50, 1247232
v_mfma_f32_16x16x32_bf16 v[4:7], v[132:135], a[12:15], v[4:7]
buffer_load_dwordx4 v232, s[32:35], s64 offen lds
v_mfma_f32_16x16x32_bf16 v[4:7], v[128:131], a[4:7], v[4:7]
ds_read_b64_tr_b16 v[126:127], v166 offset:60416
s_waitcnt lgkmcnt(10)
v_mfma_f32_16x16x32_bf16 v[8:11], v[144:147], a[0:3], 0
ds_read_b64_tr_b16 v[128:129], v167 offset:49152
ds_read_b128 v[176:179], v245 offset:704
v_mfma_f32_16x16x32_bf16 v[8:11], v[148:151], a[8:11], v[8:11]
ds_read_b64_tr_b16 v[130:131], v167 offset:57344
ds_read_b128 v[184:187], v245 offset:1728
s_mov_b32 s51, 1770496
v_mfma_f32_16x16x32_bf16 v[8:11], v[152:155], a[16:19], v[8:11]
ds_read_b64_tr_b16 v[132:133], v167 offset:50176
ds_read_b64_tr_b16 v[134:135], v167 offset:58368
s_mov_b32 s52, 397312
v_mfma_f32_16x16x32_bf16 v[8:11], v[156:159], a[24:27], v[8:11]
buffer_load_dwordx4 v232, s[32:35], s65 offen offset:1024 lds
s_mov_b32 s53, 461824
s_waitcnt lgkmcnt(9)
v_pk_fma_f32 v[188:189], v[230:231], v[172:173], v[180:181] op_sel:[0,0,0] op_sel_hi:[0,1,1]
v_pk_fma_f32 v[190:191], v[230:231], v[174:175], v[182:183] op_sel:[0,0,0] op_sel_hi:[0,1,1]
v_pk_fma_f32 v[192:193], v[230:231], v[172:173], v[180:181] op_sel:[1,0,0] op_sel_hi:[1,1,1]
v_pk_fma_f32 v[194:195], v[230:231], v[174:175], v[182:183] op_sel:[1,0,0] op_sel_hi:[1,1,1]
s_waitcnt lgkmcnt(2)
v_pk_fma_f32 v[196:197], v[230:231], v[176:177], v[184:185] op_sel:[0,0,0] op_sel_hi:[0,1,1]
v_pk_fma_f32 v[198:199], v[230:231], v[178:179], v[186:187] op_sel:[0,0,0] op_sel_hi:[0,1,1]
v_pk_fma_f32 v[200:201], v[230:231], v[176:177], v[184:185] op_sel:[1,0,0] op_sel_hi:[1,1,1]
v_pk_fma_f32 v[202:203], v[230:231], v[178:179], v[186:187] op_sel:[1,0,0] op_sel_hi:[1,1,1]
v_pk_fma_f32 v[80:81], v[228:229], v[80:81], v[188:189] op_sel:[0,0,0] op_sel_hi:[0,1,1]
v_pk_fma_f32 v[82:83], v[228:229], v[82:83], v[190:191] op_sel:[0,0,0] op_sel_hi:[0,1,1]
v_pk_fma_f32 v[84:85], v[228:229], v[84:85], v[192:193] op_sel:[1,0,0] op_sel_hi:[1,1,1]
v_pk_fma_f32 v[86:87], v[228:229], v[86:87], v[194:195] op_sel:[1,0,0] op_sel_hi:[1,1,1]
v_pk_fma_f32 v[88:89], v[228:229], v[88:89], v[196:197] op_sel:[0,0,0] op_sel_hi:[0,1,1]
v_pk_fma_f32 v[90:91], v[228:229], v[90:91], v[198:199] op_sel:[0,0,0] op_sel_hi:[0,1,1]
v_pk_fma_f32 v[92:93], v[228:229], v[92:93], v[200:201] op_sel:[1,0,0] op_sel_hi:[1,1,1]
v_pk_fma_f32 v[94:95], v[228:229], v[94:95], v[202:203] op_sel:[1,0,0] op_sel_hi:[1,1,1]
buffer_load_dwordx4 v232, s[32:35], s66 offen offset:2048 lds
v_pk_fma_f32 v[188:189], v[80:81], v[80:81], s[76:77] op_sel_hi:[1,1,0]
v_pk_fma_f32 v[190:191], v[82:83], v[82:83], s[76:77] op_sel_hi:[1,1,0]
v_pk_fma_f32 v[192:193], v[84:85], v[84:85], s[76:77] op_sel_hi:[1,1,0]
v_pk_fma_f32 v[194:195], v[86:87], v[86:87], s[76:77] op_sel_hi:[1,1,0]
v_pk_fma_f32 v[196:197], v[88:89], v[88:89], s[76:77] op_sel_hi:[1,1,0]
v_pk_fma_f32 v[198:199], v[90:91], v[90:91], s[76:77] op_sel_hi:[1,1,0]
v_pk_fma_f32 v[200:201], v[92:93], v[92:93], s[76:77] op_sel_hi:[1,1,0]
v_pk_fma_f32 v[202:203], v[94:95], v[94:95], s[76:77] op_sel_hi:[1,1,0]
v_pk_mul_f32 v[188:189], v[188:189], v[80:81]
v_pk_mul_f32 v[190:191], v[190:191], v[82:83]
v_pk_mul_f32 v[192:193], v[192:193], v[84:85]
v_pk_mul_f32 v[194:195], v[194:195], v[86:87]
v_pk_mul_f32 v[196:197], v[196:197], v[88:89]
v_pk_mul_f32 v[198:199], v[198:199], v[90:91]
v_pk_mul_f32 v[200:201], v[200:201], v[92:93]
v_pk_mul_f32 v[202:203], v[202:203], v[94:95]
v_exp_f32 v188, v188
v_exp_f32 v189, v189
buffer_load_dwordx4 v232, s[32:35], s67 offen offset:3072 lds
v_exp_f32 v190, v190
v_exp_f32 v191, v191
v_exp_f32 v192, v192
v_exp_f32 v193, v193
v_exp_f32 v194, v194
v_exp_f32 v195, v195
v_exp_f32 v196, v196
v_exp_f32 v197, v197
v_exp_f32 v198, v198
v_exp_f32 v199, v199
s_add_u32 m0, s80, 81920
s_nop 0
buffer_load_dwordx4 v237, s[32:35], s68 offen lds
v_exp_f32 v200, v200
v_exp_f32 v201, v201
v_exp_f32 v202, v202
v_exp_f32 v203, v203
v_pk_fma_f32 v[188:189], v[188:189], s[76:77], s[76:77] op_sel:[0,1,1] op_sel_hi:[1,1,1]
v_pk_fma_f32 v[190:191], v[190:191], s[76:77], s[76:77] op_sel:[0,1,1] op_sel_hi:[1,1,1]
v_pk_fma_f32 v[192:193], v[192:193], s[76:77], s[76:77] op_sel:[0,1,1] op_sel_hi:[1,1,1]
v_pk_fma_f32 v[194:195], v[194:195], s[76:77], s[76:77] op_sel:[0,1,1] op_sel_hi:[1,1,1]
v_pk_fma_f32 v[196:197], v[196:197], s[76:77], s[76:77] op_sel:[0,1,1] op_sel_hi:[1,1,1]
v_pk_fma_f32 v[198:199], v[198:199], s[76:77], s[76:77] op_sel:[0,1,1] op_sel_hi:[1,1,1]
v_pk_fma_f32 v[200:201], v[200:201], s[76:77], s[76:77] op_sel:[0,1,1] op_sel_hi:[1,1,1]
v_pk_fma_f32 v[202:203], v[202:203], s[76:77], s[76:77] op_sel:[0,1,1] op_sel_hi:[1,1,1]
v_rcp_f32 v188, v188
v_rcp_f32 v189, v189
buffer_load_dwordx4 v237, s[32:35], s69 offen offset:1024 lds
v_rcp_f32 v190, v190
v_rcp_f32 v191, v191
v_rcp_f32 v192, v192
v_rcp_f32 v193, v193
v_rcp_f32 v194, v194
v_rcp_f32 v195, v195
v_rcp_f32 v196, v196
v_rcp_f32 v197, v197
v_rcp_f32 v198, v198
v_rcp_f32 v199, v199
buffer_load_dwordx4 v237, s[32:35], s70 offen offset:2048 lds
v_rcp_f32 v200, v200
v_rcp_f32 v201, v201
v_rcp_f32 v202, v202
v_rcp_f32 v203, v203
v_pk_mul_f32 v[80:81], v[80:81], v[188:189]
v_pk_mul_f32 v[82:83], v[82:83], v[190:191]
v_pk_mul_f32 v[84:85], v[84:85], v[192:193]
v_pk_mul_f32 v[86:87], v[86:87], v[194:195]
v_pk_mul_f32 v[88:89], v[88:89], v[196:197]
v_pk_mul_f32 v[90:91], v[90:91], v[198:199]
v_pk_mul_f32 v[92:93], v[92:93], v[200:201]
v_pk_mul_f32 v[94:95], v[94:95], v[202:203]
v_mfma_f32_16x16x32_bf16 v[12:15], v[156:159], a[28:31], 0
ds_read_b64_tr_b16 v[136:137], v167 offset:51200
ds_read_b64_tr_b16 v[138:139], v167 offset:59392
s_mov_b32 s54, 1312768
v_mfma_f32_16x16x32_bf16 v[12:15], v[152:155], a[20:23], v[12:15]
buffer_load_dwordx4 v237, s[32:35], s71 offen offset:3072 lds
s_mov_b32 s55, 1377280
v_mfma_f32_16x16x32_bf16 v[12:15], v[148:151], a[12:15], v[12:15]
ds_read_b64_tr_b16 v[140:141], v167 offset:52224
v_cvt_pk_bf16_f32 v212, v80, v81
v_mfma_f32_16x16x32_bf16 v[12:15], v[144:147], a[4:7], v[12:15]
ds_read_b64_tr_b16 v[142:143], v167 offset:60416
v_mfma_f32_16x16x32_bf16 v[16:19], v[112:115], a[0:3], 0
ds_read_b64_tr_b16 v[144:145], v160 offset:16384
buffer_load_dword v243, v241, s[40:43], s86 offen offset:1024 sc1
v_mfma_f32_16x16x32_bf16 v[16:19], v[116:119], a[8:11], v[16:19]
ds_read_b64_tr_b16 v[146:147], v160 offset:24576
v_cvt_pk_bf16_f32 v213, v82, v83
v_mfma_f32_16x16x32_bf16 v[16:19], v[120:123], a[16:19], v[16:19]
ds_read_b64_tr_b16 v[148:149], v160 offset:17408
v_cvt_pk_bf16_f32 v214, v88, v89
v_mfma_f32_16x16x32_bf16 v[16:19], v[124:127], a[24:27], v[16:19]
ds_read_b64_tr_b16 v[150:151], v160 offset:25600
v_cvt_pk_bf16_f32 v215, v90, v91
v_mfma_f32_16x16x32_bf16 v[20:23], v[124:127], a[28:31], 0
ds_read_b64_tr_b16 v[152:153], v160 offset:18432
v_cvt_pk_bf16_f32 v216, v84, v85
v_mfma_f32_16x16x32_bf16 v[20:23], v[120:123], a[20:23], v[20:23]
ds_read_b64_tr_b16 v[154:155], v160 offset:26624
v_cvt_pk_bf16_f32 v217, v86, v87
v_mfma_f32_16x16x32_bf16 v[20:23], v[116:119], a[12:15], v[20:23]
ds_read_b64_tr_b16 v[156:157], v160 offset:19456
v_cvt_pk_bf16_f32 v218, v92, v93
v_mfma_f32_16x16x32_bf16 v[20:23], v[112:115], a[4:7], v[20:23]
ds_read_b64_tr_b16 v[158:159], v160 offset:27648
s_waitcnt lgkmcnt(8)
v_mfma_f32_16x16x32_bf16 v[24:27], v[128:131], a[0:3], 0
ds_read_b64_tr_b16 v[112:113], v161 offset:16384
v_cvt_pk_bf16_f32 v219, v94, v95
v_mfma_f32_16x16x32_bf16 v[24:27], v[132:135], a[8:11], v[24:27]
ds_read_b64_tr_b16 v[114:115], v161 offset:24576
ds_read_b64_tr_b16 v[116:117], v161 offset:17408
v_mfma_f32_16x16x32_bf16 v[24:27], v[136:139], a[16:19], v[24:27]
buffer_store_dwordx4 v[212:215], v251, s[40:43], s88 offen offset:0 sc1
v_mfma_f32_16x16x32_bf16 v[24:27], v[140:143], a[24:27], v[24:27]
ds_read_b64_tr_b16 v[118:119], v161 offset:25600
v_mfma_f32_16x16x32_bf16 v[28:31], v[140:143], a[28:31], 0
ds_read_b64_tr_b16 v[120:121], v161 offset:18432
v_mfma_f32_16x16x32_bf16 v[28:31], v[136:139], a[20:23], v[28:31]
ds_read_b64_tr_b16 v[122:123], v161 offset:26624
v_mfma_f32_16x16x32_bf16 v[28:31], v[132:135], a[12:15], v[28:31]
ds_read_b64_tr_b16 v[124:125], v161 offset:19456
v_mfma_f32_16x16x32_bf16 v[28:31], v[128:131], a[4:7], v[28:31]
ds_read_b64_tr_b16 v[126:127], v161 offset:27648
s_waitcnt vmcnt(19) lgkmcnt(8)
v_mfma_f32_16x16x32_bf16 v[0:3], v[144:147], a[32:35], v[0:3]
ds_read_b64_tr_b16 v[128:129], v162 offset:16384
ds_read_b64_tr_b16 v[130:131], v162 offset:24576
v_mfma_f32_16x16x32_bf16 v[0:3], v[148:151], a[40:43], v[0:3]
buffer_store_dwordx4 v[216:219], v251, s[40:43], s88 offen offset:128 sc1
v_mfma_f32_16x16x32_bf16 v[0:3], v[152:155], a[48:51], v[0:3]
ds_read_b64_tr_b16 v[132:133], v162 offset:17408
s_add_u32 s88, s88, 4096
v_mfma_f32_16x16x32_bf16 v[0:3], v[156:159], a[56:59], v[0:3]
ds_read_b64_tr_b16 v[134:135], v162 offset:25600
v_add_u32 v245, s89, v245
v_mfma_f32_16x16x32_bf16 v[4:7], v[156:159], a[60:63], v[4:7]
ds_read_b64_tr_b16 v[136:137], v162 offset:18432
ds_read_b128 v[172:175], v245 offset:768
v_mfma_f32_16x16x32_bf16 v[4:7], v[152:155], a[52:55], v[4:7]
ds_read_b64_tr_b16 v[138:139], v162 offset:26624
ds_read_b128 v[180:183], v245 offset:1792
v_mfma_f32_16x16x32_bf16 v[4:7], v[148:151], a[44:47], v[4:7]
ds_read_b64_tr_b16 v[140:141], v162 offset:19456
ds_read_b128 v[176:179], v245 offset:832
v_mfma_f32_16x16x32_bf16 v[4:7], v[144:147], a[36:39], v[4:7]
ds_read_b64_tr_b16 v[142:143], v162 offset:27648
s_waitcnt lgkmcnt(11)
v_mfma_f32_16x16x32_bf16 v[8:11], v[112:115], a[32:35], v[8:11]
ds_read_b64_tr_b16 v[144:145], v163 offset:16384
ds_read_b128 v[184:187], v245 offset:1856
v_mfma_f32_16x16x32_bf16 v[8:11], v[116:119], a[40:43], v[8:11]
ds_read_b64_tr_b16 v[146:147], v163 offset:24576
v_mfma_f32_16x16x32_bf16 v[8:11], v[120:123], a[48:51], v[8:11]
ds_read_b64_tr_b16 v[148:149], v163 offset:17408
v_mfma_f32_16x16x32_bf16 v[8:11], v[124:127], a[56:59], v[8:11]
ds_read_b64_tr_b16 v[150:151], v163 offset:25600
s_waitcnt lgkmcnt(8)
v_pk_fma_f32 v[188:189], v[230:231], v[172:173], v[180:181] op_sel:[0,0,0] op_sel_hi:[0,1,1]
v_pk_fma_f32 v[190:191], v[230:231], v[174:175], v[182:183] op_sel:[0,0,0] op_sel_hi:[0,1,1]
v_pk_fma_f32 v[192:193], v[230:231], v[172:173], v[180:181] op_sel:[1,0,0] op_sel_hi:[1,1,1]
v_pk_fma_f32 v[194:195], v[230:231], v[174:175], v[182:183] op_sel:[1,0,0] op_sel_hi:[1,1,1]
s_waitcnt lgkmcnt(3)
v_pk_fma_f32 v[196:197], v[230:231], v[176:177], v[184:185] op_sel:[0,0,0] op_sel_hi:[0,1,1]
v_pk_fma_f32 v[198:199], v[230:231], v[178:179], v[186:187] op_sel:[0,0,0] op_sel_hi:[0,1,1]
v_pk_fma_f32 v[200:201], v[230:231], v[176:177], v[184:185] op_sel:[1,0,0] op_sel_hi:[1,1,1]
v_pk_fma_f32 v[202:203], v[230:231], v[178:179], v[186:187] op_sel:[1,0,0] op_sel_hi:[1,1,1]
v_pk_fma_f32 v[96:97], v[228:229], v[96:97], v[188:189] op_sel:[0,0,0] op_sel_hi:[0,1,1]
v_pk_fma_f32 v[98:99], v[228:229], v[98:99], v[190:191] op_sel:[0,0,0] op_sel_hi:[0,1,1]
v_pk_fma_f32 v[100:101], v[228:229], v[100:101], v[192:193] op_sel:[1,0,0] op_sel_hi:[1,1,1]
v_pk_fma_f32 v[102:103], v[228:229], v[102:103], v[194:195] op_sel:[1,0,0] op_sel_hi:[1,1,1]
v_pk_fma_f32 v[104:105], v[228:229], v[104:105], v[196:197] op_sel:[0,0,0] op_sel_hi:[0,1,1]
v_pk_fma_f32 v[106:107], v[228:229], v[106:107], v[198:199] op_sel:[0,0,0] op_sel_hi:[0,1,1]
v_pk_fma_f32 v[108:109], v[228:229], v[108:109], v[200:201] op_sel:[1,0,0] op_sel_hi:[1,1,1]
v_pk_fma_f32 v[110:111], v[228:229], v[110:111], v[202:203] op_sel:[1,0,0] op_sel_hi:[1,1,1]
v_pk_fma_f32 v[188:189], v[96:97], v[96:97], s[76:77] op_sel_hi:[1,1,0]
v_pk_fma_f32 v[190:191], v[98:99], v[98:99], s[76:77] op_sel_hi:[1,1,0]
v_pk_fma_f32 v[192:193], v[100:101], v[100:101], s[76:77] op_sel_hi:[1,1,0]
v_pk_fma_f32 v[194:195], v[102:103], v[102:103], s[76:77] op_sel_hi:[1,1,0]
v_pk_fma_f32 v[196:197], v[104:105], v[104:105], s[76:77] op_sel_hi:[1,1,0]
v_pk_fma_f32 v[198:199], v[106:107], v[106:107], s[76:77] op_sel_hi:[1,1,0]
v_pk_fma_f32 v[200:201], v[108:109], v[108:109], s[76:77] op_sel_hi:[1,1,0]
v_pk_fma_f32 v[202:203], v[110:111], v[110:111], s[76:77] op_sel_hi:[1,1,0]
v_pk_mul_f32 v[188:189], v[188:189], v[96:97]
v_pk_mul_f32 v[190:191], v[190:191], v[98:99]
v_pk_mul_f32 v[192:193], v[192:193], v[100:101]
v_pk_mul_f32 v[194:195], v[194:195], v[102:103]
v_pk_mul_f32 v[196:197], v[196:197], v[104:105]
v_pk_mul_f32 v[198:199], v[198:199], v[106:107]
v_pk_mul_f32 v[200:201], v[200:201], v[108:109]
v_pk_mul_f32 v[202:203], v[202:203], v[110:111]
v_exp_f32 v188, v188
v_exp_f32 v189, v189
v_exp_f32 v190, v190
v_exp_f32 v191, v191
v_exp_f32 v192, v192
v_exp_f32 v193, v193
v_exp_f32 v194, v194
v_exp_f32 v195, v195
v_exp_f32 v196, v196
v_exp_f32 v197, v197
v_exp_f32 v198, v198
v_exp_f32 v199, v199
v_exp_f32 v200, v200
v_exp_f32 v201, v201
v_exp_f32 v202, v202
v_exp_f32 v203, v203
v_pk_fma_f32 v[188:189], v[188:189], s[76:77], s[76:77] op_sel:[0,1,1] op_sel_hi:[1,1,1]
v_pk_fma_f32 v[190:191], v[190:191], s[76:77], s[76:77] op_sel:[0,1,1] op_sel_hi:[1,1,1]
v_pk_fma_f32 v[192:193], v[192:193], s[76:77], s[76:77] op_sel:[0,1,1] op_sel_hi:[1,1,1]
v_pk_fma_f32 v[194:195], v[194:195], s[76:77], s[76:77] op_sel:[0,1,1] op_sel_hi:[1,1,1]
v_pk_fma_f32 v[196:197], v[196:197], s[76:77], s[76:77] op_sel:[0,1,1] op_sel_hi:[1,1,1]
v_pk_fma_f32 v[198:199], v[198:199], s[76:77], s[76:77] op_sel:[0,1,1] op_sel_hi:[1,1,1]
v_pk_fma_f32 v[200:201], v[200:201], s[76:77], s[76:77] op_sel:[0,1,1] op_sel_hi:[1,1,1]
v_pk_fma_f32 v[202:203], v[202:203], s[76:77], s[76:77] op_sel:[0,1,1] op_sel_hi:[1,1,1]
v_rcp_f32 v188, v188
v_rcp_f32 v189, v189
v_rcp_f32 v190, v190
v_rcp_f32 v191, v191
v_rcp_f32 v192, v192
v_rcp_f32 v193, v193
v_rcp_f32 v194, v194
v_rcp_f32 v195, v195
v_rcp_f32 v196, v196
v_rcp_f32 v197, v197
v_rcp_f32 v198, v198
v_rcp_f32 v199, v199
v_rcp_f32 v200, v200
v_rcp_f32 v201, v201
v_rcp_f32 v202, v202
v_rcp_f32 v203, v203
v_pk_mul_f32 v[96:97], v[96:97], v[188:189]
v_pk_mul_f32 v[98:99], v[98:99], v[190:191]
v_pk_mul_f32 v[100:101], v[100:101], v[192:193]
v_pk_mul_f32 v[102:103], v[102:103], v[194:195]
v_pk_mul_f32 v[104:105], v[104:105], v[196:197]
v_pk_mul_f32 v[106:107], v[106:107], v[198:199]
L_pad6:
s_cbranch_execz L_warm1
v_pk_mul_f32 v[108:109], v[108:109], v[200:201]
v_pk_mul_f32 v[110:111], v[110:111], v[202:203]
v_mfma_f32_16x16x32_bf16 v[12:15], v[124:127], a[60:63], v[12:15]
ds_read_b64_tr_b16 v[152:153], v163 offset:18432
v_cvt_pk_bf16_f32 v204, v96, v97
v_mfma_f32_16x16x32_bf16 v[12:15], v[120:123], a[52:55], v[12:15]
ds_read_b64_tr_b16 v[154:155], v163 offset:26624
v_cvt_pk_bf16_f32 v205, v98, v99
v_mfma_f32_16x16x32_bf16 v[12:15], v[116:119], a[44:47], v[12:15]
ds_read_b64_tr_b16 v[156:157], v163 offset:19456
ds_read_b64_tr_b16 v[158:159], v163 offset:27648
v_mfma_f32_16x16x32_bf16 v[12:15], v[112:115], a[36:39], v[12:15]
v_cvt_pk_bf16_f32 v206, v104, v105
s_waitcnt vmcnt(17)
s_barrier
v_mfma_f32_16x16x32_bf16 v[16:19], v[128:131], a[32:35], v[16:19]
ds_read_b64_tr_b16 v[112:113], v160 offset:32768
ds_read_b64_tr_b16 v[114:115], v160 offset:40960
s_add_u32 m0, s80, 98304
v_mfma_f32_16x16x32_bf16 v[16:19], v[132:135], a[40:43], v[16:19]
buffer_load_dwordx4 v237, s[32:35], s72 offen lds
v_mfma_f32_16x16x32_bf16 v[16:19], v[136:139], a[48:51], v[16:19]
ds_read_b64_tr_b16 v[116:117], v160 offset:33792
v_cvt_pk_bf16_f32 v207, v106, v107
v_mfma_f32_16x16x32_bf16 v[16:19], v[140:143], a[56:59], v[16:19]
ds_read_b64_tr_b16 v[118:119], v160 offset:41984
v_cvt_pk_bf16_f32 v208, v100, v101
v_mfma_f32_16x16x32_bf16 v[20:23], v[140:143], a[60:63], v[20:23]
ds_read_b64_tr_b16 v[120:121], v160 offset:34816
ds_read_b64_tr_b16 v[122:123], v160 offset:43008
v_mfma_f32_16x16x32_bf16 v[20:23], v[136:139], a[52:55], v[20:23]
buffer_store_dwordx4 v[204:207], v251, s[40:43], s88 offen offset:0 sc1
v_mfma_f32_16x16x32_bf16 v[20:23], v[132:135], a[44:47], v[20:23]
ds_read_b64_tr_b16 v[124:125], v160 offset:35840
v_cvt_pk_bf16_f32 v209, v102, v103
v_mfma_f32_16x16x32_bf16 v[20:23], v[128:131], a[36:39], v[20:23]
ds_read_b64_tr_b16 v[126:127], v160 offset:44032
s_waitcnt lgkmcnt(8)
v_mfma_f32_16x16x32_bf16 v[24:27], v[144:147], a[32:35], v[24:27]
ds_read_b64_tr_b16 v[128:129], v161 offset:32768
ds_read_b64_tr_b16 v[130:131], v161 offset:40960
v_mfma_f32_16x16x32_bf16 v[24:27], v[148:151], a[40:43], v[24:27]
buffer_load_dwordx4 v237, s[32:35], s73 offen offset:1024 lds
v_mfma_f32_16x16x32_bf16 v[24:27], v[152:155], a[48:51], v[24:27]
ds_read_b64_tr_b16 v[132:133], v161 offset:33792
v_cvt_pk_bf16_f32 v210, v108, v109
v_mfma_f32_16x16x32_bf16 v[24:27], v[156:159], a[56:59], v[24:27]
ds_read_b64_tr_b16 v[134:135], v161 offset:41984
v_cvt_pk_bf16_f32 v211, v110, v111
v_mfma_f32_16x16x32_bf16 v[28:31], v[156:159], a[60:63], v[28:31]
ds_read_b64_tr_b16 v[136:137], v161 offset:34816
ds_read_b64_tr_b16 v[138:139], v161 offset:43008
v_mfma_f32_16x16x32_bf16 v[28:31], v[152:155], a[52:55], v[28:31]
buffer_load_dwordx4 v237, s[32:35], s74 offen offset:2048 lds
v_mfma_f32_16x16x32_bf16 v[28:31], v[148:151], a[44:47], v[28:31]
ds_read_b64_tr_b16 v[140:141], v161 offset:35840
v_mfma_f32_16x16x32_bf16 v[28:31], v[144:147], a[36:39], v[28:31]
ds_read_b64_tr_b16 v[142:143], v161 offset:44032
s_waitcnt lgkmcnt(8)
v_mfma_f32_16x16x32_bf16 v[32:35], v[112:115], a[0:3], 0
ds_read_b64_tr_b16 v[144:145], v162 offset:32768
ds_read_b64_tr_b16 v[146:147], v162 offset:40960
v_mfma_f32_16x16x32_bf16 v[32:35], v[116:119], a[8:11], v[32:35]
buffer_store_dwordx4 v[208:211], v251, s[40:43], s88 offen offset:128 sc1
v_mfma_f32_16x16x32_bf16 v[32:35], v[120:123], a[16:19], v[32:35]
ds_read_b64_tr_b16 v[148:149], v162 offset:33792
s_add_u32 s88, s88, 4096
s_waitcnt vmcnt(7)
v_mfma_f32_16x16x32_bf16 v[32:35], v[124:127], a[24:27], v[32:35]
ds_read_b64_tr_b16 v[150:151], v162 offset:41984
v_sub_u32 v243, v243, v242
v_add_u32 v243, -2, v243
v_mfma_f32_16x16x32_bf16 v[36:39], v[124:127], a[28:31], 0
ds_read_b64_tr_b16 v[152:153], v162 offset:34816
ds_read_b64_tr_b16 v[154:155], v162 offset:43008
v_cmp_le_u32 vcc, 14, v243
s_cbranch_vccnz L_slow4
L_back4:
v_mfma_f32_16x16x32_bf16 v[36:39], v[120:123], a[20:23], v[36:39]
buffer_load_dwordx4 v237, s[32:35], s75 offen offset:3072 lds
v_mfma_f32_16x16x32_bf16 v[36:39], v[116:119], a[12:15], v[36:39]
ds_read_b64_tr_b16 v[156:157], v162 offset:35840
s_sub_u32 s90, s12, 35651584
v_mfma_f32_16x16x32_bf16 v[36:39], v[112:115], a[4:7], v[36:39]
ds_read_b64_tr_b16 v[158:159], v162 offset:44032
s_waitcnt lgkmcnt(8)
v_mfma_f32_16x16x32_bf16 v[40:43], v[128:131], a[0:3], 0
ds_read_b64_tr_b16 v[112:113], v163 offset:32768
ds_read_b64_tr_b16 v[114:115], v163 offset:40960
v_add_u32 v240, 4096, v240
v_mfma_f32_16x16x32_bf16 v[40:43], v[132:135], a[8:11], v[40:43]
buffer_load_dwordx4 a[64:67], v240, s[40:43], s8 offen offset:0 sc1
v_mfma_f32_16x16x32_bf16 v[40:43], v[136:139], a[16:19], v[40:43]
ds_read_b64_tr_b16 v[116:117], v163 offset:33792
v_add_u32 v247, 4096, v251
v_mfma_f32_16x16x32_bf16 v[40:43], v[140:143], a[24:27], v[40:43]
ds_read_b64_tr_b16 v[118:119], v163 offset:41984
v_mfma_f32_16x16x32_bf16 v[44:47], v[140:143], a[28:31], 0
ds_read_b64_tr_b16 v[120:121], v163 offset:34816
ds_read_b64_tr_b16 v[122:123], v163 offset:43008
v_mfma_f32_16x16x32_bf16 v[44:47], v[136:139], a[20:23], v[44:47]
buffer_load_dwordx4 a[68:71], v240, s[40:43], s8 offen offset:128 sc1
v_mfma_f32_16x16x32_bf16 v[44:47], v[132:135], a[12:15], v[44:47]
ds_read_b64_tr_b16 v[124:125], v163 offset:35840
v_mfma_f32_16x16x32_bf16 v[44:47], v[128:131], a[4:7], v[44:47]
ds_read_b64_tr_b16 v[126:127], v163 offset:44032
s_waitcnt lgkmcnt(8)
v_mfma_f32_16x16x32_bf16 v[48:51], v[144:147], a[0:3], 0
ds_read_b64_tr_b16 v[128:129], v160 offset:49152
ds_read_b64_tr_b16 v[130:131], v160 offset:57344
v_mfma_f32_16x16x32_bf16 v[48:51], v[148:151], a[8:11], v[48:51]
buffer_load_dwordx4 a[72:75], v240, s[40:43], s9 offen offset:0 sc1
v_mfma_f32_16x16x32_bf16 v[48:51], v[152:155], a[16:19], v[48:51]
ds_read_b64_tr_b16 v[132:133], v160 offset:50176
v_add_u32 v244, 3, v242
s_waitcnt vmcnt(9)
buffer_store_dword v244, v248, s[40:43], s86 offen offset:1024 sc1
v_mfma_f32_16x16x32_bf16 v[48:51], v[156:159], a[24:27], v[48:51]
ds_read_b64_tr_b16 v[134:135], v160 offset:58368
v_mfma_f32_16x16x32_bf16 v[52:55], v[156:159], a[28:31], 0
ds_read_b64_tr_b16 v[136:137], v160 offset:51200
ds_read_b64_tr_b16 v[138:139], v160 offset:59392
v_mfma_f32_16x16x32_bf16 v[52:55], v[152:155], a[20:23], v[52:55]
buffer_load_dwordx4 a[76:79], v240, s[40:43], s9 offen offset:128 sc1
v_mfma_f32_16x16x32_bf16 v[52:55], v[148:151], a[12:15], v[52:55]
ds_read_b64_tr_b16 v[140:141], v160 offset:52224
v_mfma_f32_16x16x32_bf16 v[52:55], v[144:147], a[4:7], v[52:55]
ds_read_b64_tr_b16 v[142:143], v160 offset:60416
s_waitcnt lgkmcnt(8)
v_mfma_f32_16x16x32_bf16 v[56:59], v[112:115], a[0:3], 0
ds_read_b64_tr_b16 v[144:145], v161 offset:49152
ds_read_b64_tr_b16 v[146:147], v161 offset:57344
v_mfma_f32_16x16x32_bf16 v[56:59], v[116:119], a[8:11], v[56:59]
buffer_load_dwordx4 a[80:83], v240, s[40:43], s10 offen offset:0 sc1
v_mfma_f32_16x16x32_bf16 v[56:59], v[120:123], a[16:19], v[56:59]
ds_read_b64_tr_b16 v[148:149], v161 offset:50176
v_mfma_f32_16x16x32_bf16 v[56:59], v[124:127], a[24:27], v[56:59]
ds_read_b64_tr_b16 v[150:151], v161 offset:58368
v_mfma_f32_16x16x32_bf16 v[60:63], v[124:127], a[28:31], 0
ds_read_b64_tr_b16 v[152:153], v161 offset:51200
ds_read_b64_tr_b16 v[154:155], v161 offset:59392
v_mfma_f32_16x16x32_bf16 v[60:63], v[120:123], a[20:23], v[60:63]
buffer_load_dwordx4 a[84:87], v240, s[40:43], s10 offen offset:128 sc1
v_mfma_f32_16x16x32_bf16 v[60:63], v[116:119], a[12:15], v[60:63]
ds_read_b64_tr_b16 v[156:157], v161 offset:52224
v_mfma_f32_16x16x32_bf16 v[60:63], v[112:115], a[4:7], v[60:63]
ds_read_b64_tr_b16 v[158:159], v161 offset:60416
s_waitcnt lgkmcnt(8)
v_mfma_f32_16x16x32_bf16 v[32:35], v[128:131], a[32:35], v[32:35]
ds_read_b64_tr_b16 v[112:113], v162 offset:49152
ds_read_b64_tr_b16 v[114:115], v162 offset:57344
v_mfma_f32_16x16x32_bf16 v[32:35], v[132:135], a[40:43], v[32:35]
buffer_load_dwordx4 a[88:91], v240, s[40:43], s11 offen offset:0 sc1
v_mfma_f32_16x16x32_bf16 v[32:35], v[136:139], a[48:51], v[32:35]
ds_read_b64_tr_b16 v[116:117], v162 offset:50176
v_mfma_f32_16x16x32_bf16 v[32:35], v[140:143], a[56:59], v[32:35]
ds_read_b64_tr_b16 v[118:119], v162 offset:58368
v_mfma_f32_16x16x32_bf16 v[36:39], v[140:143], a[60:63], v[36:39]
ds_read_b64_tr_b16 v[120:121], v162 offset:51200
ds_read_b64_tr_b16 v[122:123], v162 offset:59392
v_mfma_f32_16x16x32_bf16 v[36:39], v[136:139], a[52:55], v[36:39]
buffer_load_dwordx4 a[92:95], v240, s[40:43], s11 offen offset:128 sc1
v_mfma_f32_16x16x32_bf16 v[36:39], v[132:135], a[44:47], v[36:39]
ds_read_b64_tr_b16 v[124:125], v162 offset:52224
v_mfma_f32_16x16x32_bf16 v[36:39], v[128:131], a[36:39], v[36:39]
ds_read_b64_tr_b16 v[126:127], v162 offset:60416
s_waitcnt lgkmcnt(8)
v_mfma_f32_16x16x32_bf16 v[40:43], v[144:147], a[32:35], v[40:43]
ds_read_b64_tr_b16 v[128:129], v163 offset:49152
ds_read_b64_tr_b16 v[130:131], v163 offset:57344
v_add_u32 v240, 4096, v240
v_mfma_f32_16x16x32_bf16 v[40:43], v[148:151], a[40:43], v[40:43]
buffer_load_dwordx4 a[96:99], v240, s[40:43], s8 offen offset:0 sc1
v_mfma_f32_16x16x32_bf16 v[40:43], v[152:155], a[48:51], v[40:43]
ds_read_b64_tr_b16 v[132:133], v163 offset:50176
v_mfma_f32_16x16x32_bf16 v[40:43], v[156:159], a[56:59], v[40:43]
ds_read_b64_tr_b16 v[134:135], v163 offset:58368
v_mfma_f32_16x16x32_bf16 v[44:47], v[156:159], a[60:63], v[44:47]
ds_read_b64_tr_b16 v[136:137], v163 offset:51200
ds_read_b64_tr_b16 v[138:139], v163 offset:59392
v_mfma_f32_16x16x32_bf16 v[44:47], v[152:155], a[52:55], v[44:47]
buffer_load_dwordx4 a[100:103], v240, s[40:43], s8 offen offset:128 sc1
v_mfma_f32_16x16x32_bf16 v[44:47], v[148:151], a[44:47], v[44:47]
ds_read_b64_tr_b16 v[140:141], v163 offset:52224
ds_read_b64_tr_b16 v[142:143], v163 offset:60416
v_mfma_f32_16x16x32_bf16 v[44:47], v[144:147], a[36:39], v[44:47]
s_waitcnt lgkmcnt(8)
s_barrier
v_mfma_f32_16x16x32_bf16 v[48:51], v[112:115], a[32:35], v[48:51]
ds_read_b64_tr_b16 v[144:145], v164 offset:0
ds_read_b64_tr_b16 v[146:147], v164 offset:8192
v_mfma_f32_16x16x32_bf16 v[48:51], v[116:119], a[40:43], v[48:51]
buffer_load_dwordx4 a[104:107], v240, s[40:43], s9 offen offset:0 sc1
v_mfma_f32_16x16x32_bf16 v[48:51], v[120:123], a[48:51], v[48:51]
ds_read_b64_tr_b16 v[148:149], v164 offset:1024
v_add_u32 v244, 4, v242
s_waitcnt vmcnt(13)
buffer_store_dword v244, v248, s[40:43], s86 offen offset:1024 sc1
v_mfma_f32_16x16x32_bf16 v[48:51], v[124:127], a[56:59], v[48:51]
ds_read_b64_tr_b16 v[150:151], v164 offset:9216
v_mfma_f32_16x16x32_bf16 v[52:55], v[124:127], a[60:63], v[52:55]
ds_read_b64_tr_b16 v[152:153], v164 offset:2048
ds_read_b64_tr_b16 v[154:155], v164 offset:10240
v_mfma_f32_16x16x32_bf16 v[52:55], v[120:123], a[52:55], v[52:55]
buffer_load_dwordx4 a[108:111], v240, s[40:43], s9 offen offset:128 sc1
v_mfma_f32_16x16x32_bf16 v[52:55], v[116:119], a[44:47], v[52:55]
ds_read_b64_tr_b16 v[156:157], v164 offset:3072
v_mfma_f32_16x16x32_bf16 v[52:55], v[112:115], a[36:39], v[52:55]
ds_read_b64_tr_b16 v[158:159], v164 offset:11264
s_waitcnt lgkmcnt(8)
v_mfma_f32_16x16x32_bf16 v[56:59], v[128:131], a[32:35], v[56:59]
ds_read_b64_tr_b16 v[112:113], v165 offset:0
ds_read_b64_tr_b16 v[114:115], v165 offset:8192
v_mfma_f32_16x16x32_bf16 v[56:59], v[132:135], a[40:43], v[56:59]
buffer_load_dwordx4 a[112:115], v240, s[40:43], s10 offen offset:0 sc1
v_mfma_f32_16x16x32_bf16 v[56:59], v[136:139], a[48:51], v[56:59]
ds_read_b64_tr_b16 v[116:117], v165 offset:1024
v_mfma_f32_16x16x32_bf16 v[56:59], v[140:143], a[56:59], v[56:59]
ds_read_b64_tr_b16 v[118:119], v165 offset:9216
v_mfma_f32_16x16x32_bf16 v[60:63], v[140:143], a[60:63], v[60:63]
ds_read_b64_tr_b16 v[120:121], v165 offset:2048
ds_read_b64_tr_b16 v[122:123], v165 offset:10240
v_mfma_f32_16x16x32_bf16 v[60:63], v[136:139], a[52:55], v[60:63]
buffer_load_dwordx4 a[116:119], v240, s[40:43], s10 offen offset:128 sc1
v_mfma_f32_16x16x32_bf16 v[60:63], v[132:135], a[44:47], v[60:63]
ds_read_b64_tr_b16 v[124:125], v165 offset:3072
v_mfma_f32_16x16x32_bf16 v[60:63], v[128:131], a[36:39], v[60:63]
ds_read_b64_tr_b16 v[126:127], v165 offset:11264
s_waitcnt lgkmcnt(8)
v_mfma_f32_16x16x32_bf16 v[64:67], v[144:147], a[0:3], 0
ds_read_b64_tr_b16 v[128:129], v166 offset:0
v_mfma_f32_16x16x32_bf16 v[64:67], v[148:151], a[8:11], v[64:67]
ds_read_b64_tr_b16 v[130:131], v166 offset:8192
ds_read_b64_tr_b16 v[132:133], v166 offset:1024
v_mfma_f32_16x16x32_bf16 v[64:67], v[152:155], a[16:19], v[64:67]
buffer_load_dwordx4 a[120:123], v240, s[40:43], s11 offen offset:0 sc1
v_mfma_f32_16x16x32_bf16 v[64:67], v[156:159], a[24:27], v[64:67]
ds_read_b64_tr_b16 v[134:135], v166 offset:9216
v_mfma_f32_16x16x32_bf16 v[68:71], v[156:159], a[28:31], 0
ds_read_b64_tr_b16 v[136:137], v166 offset:2048
v_mfma_f32_16x16x32_bf16 v[68:71], v[152:155], a[20:23], v[68:71]
ds_read_b64_tr_b16 v[138:139], v166 offset:10240
ds_read_b64_tr_b16 v[140:141], v166 offset:3072
v_mfma_f32_16x16x32_bf16 v[68:71], v[148:151], a[12:15], v[68:71]
buffer_load_dwordx4 a[124:127], v240, s[40:43], s11 offen offset:128 sc1
v_mfma_f32_16x16x32_bf16 v[68:71], v[144:147], a[4:7], v[68:71]
ds_read_b64_tr_b16 v[142:143], v166 offset:11264
s_waitcnt lgkmcnt(8)
v_mfma_f32_16x16x32_bf16 v[72:75], v[112:115], a[0:3], 0
ds_read_b64_tr_b16 v[144:145], v167 offset:0
v_mfma_f32_16x16x32_bf16 v[72:75], v[116:119], a[8:11], v[72:75]
ds_read_b64_tr_b16 v[146:147], v167 offset:8192
ds_read_b64_tr_b16 v[148:149], v167 offset:1024
s_add_u32 m0, s80, 114688
v_mfma_f32_16x16x32_bf16 v[72:75], v[120:123], a[16:19], v[72:75]
buffer_load_dwordx4 v238, s[32:35], s68 offen lds
v_mfma_f32_16x16x32_bf16 v[72:75], v[124:127], a[24:27], v[72:75]
ds_read_b64_tr_b16 v[150:151], v167 offset:9216
v_mfma_f32_16x16x32_bf16 v[76:79], v[124:127], a[28:31], 0
ds_read_b64_tr_b16 v[152:153], v167 offset:2048
v_mfma_f32_16x16x32_bf16 v[76:79], v[120:123], a[20:23], v[76:79]
ds_read_b64_tr_b16 v[154:155], v167 offset:10240
ds_read_b64_tr_b16 v[156:157], v167 offset:3072
v_mfma_f32_16x16x32_bf16 v[76:79], v[116:119], a[12:15], v[76:79]
buffer_load_dwordx4 v238, s[32:35], s69 offen offset:1024 lds
v_mfma_f32_16x16x32_bf16 v[76:79], v[112:115], a[4:7], v[76:79]
ds_read_b64_tr_b16 v[158:159], v167 offset:11264
s_waitcnt lgkmcnt(8)
v_mfma_f32_16x16x32_bf16 v[80:83], v[128:131], a[0:3], 0
ds_read_b64_tr_b16 v[112:113], v160 offset:0
v_mfma_f32_16x16x32_bf16 v[80:83], v[132:135], a[8:11], v[80:83]
ds_read_b64_tr_b16 v[114:115], v160 offset:8192
ds_read_b64_tr_b16 v[116:117], v160 offset:1024
v_mfma_f32_16x16x32_bf16 v[80:83], v[136:139], a[16:19], v[80:83]
buffer_load_dwordx4 v238, s[32:35], s70 offen offset:2048 lds
v_mfma_f32_16x16x32_bf16 v[80:83], v[140:143], a[24:27], v[80:83]
ds_read_b64_tr_b16 v[118:119], v160 offset:9216
v_mfma_f32_16x16x32_bf16 v[84:87], v[140:143], a[28:31], 0
ds_read_b64_tr_b16 v[120:121], v160 offset:2048
v_mfma_f32_16x16x32_bf16 v[84:87], v[136:139], a[20:23], v[84:87]
ds_read_b64_tr_b16 v[122:123], v160 offset:10240
ds_read_b64_tr_b16 v[124:125], v160 offset:3072
v_mfma_f32_16x16x32_bf16 v[84:87], v[132:135], a[12:15], v[84:87]
buffer_load_dwordx4 v238, s[32:35], s71 offen offset:3072 lds
v_mfma_f32_16x16x32_bf16 v[84:87], v[128:131], a[4:7], v[84:87]
ds_read_b64_tr_b16 v[126:127], v160 offset:11264
s_waitcnt lgkmcnt(8)
v_mfma_f32_16x16x32_bf16 v[88:91], v[144:147], a[0:3], 0
ds_read_b64_tr_b16 v[128:129], v161 offset:0
v_mfma_f32_16x16x32_bf16 v[88:91], v[148:151], a[8:11], v[88:91]
ds_read_b64_tr_b16 v[130:131], v161 offset:8192
ds_read_b64_tr_b16 v[132:133], v161 offset:1024
s_add_u32 m0, s80, 16384
v_mfma_f32_16x16x32_bf16 v[88:91], v[152:155], a[16:19], v[88:91]
buffer_load_dwordx4 v238, s[32:35], s72 offen lds
v_mfma_f32_16x16x32_bf16 v[88:91], v[156:159], a[24:27], v[88:91]
ds_read_b64_tr_b16 v[134:135], v161 offset:9216
v_mfma_f32_16x16x32_bf16 v[92:95], v[156:159], a[28:31], 0
ds_read_b64_tr_b16 v[136:137], v161 offset:2048
v_mfma_f32_16x16x32_bf16 v[92:95], v[152:155], a[20:23], v[92:95]
ds_read_b64_tr_b16 v[138:139], v161 offset:10240
ds_read_b64_tr_b16 v[140:141], v161 offset:3072
v_mfma_f32_16x16x32_bf16 v[92:95], v[148:151], a[12:15], v[92:95]
buffer_load_dwordx4 v238, s[32:35], s73 offen offset:1024 lds
v_mfma_f32_16x16x32_bf16 v[92:95], v[144:147], a[4:7], v[92:95]
ds_read_b64_tr_b16 v[142:143], v161 offset:11264
s_waitcnt lgkmcnt(8)
v_mfma_f32_16x16x32_bf16 v[64:67], v[112:115], a[32:35], v[64:67]
ds_read_b64_tr_b16 v[144:145], v162 offset:0
v_mfma_f32_16x16x32_bf16 v[64:67], v[116:119], a[40:43], v[64:67]
ds_read_b64_tr_b16 v[146:147], v162 offset:8192
ds_read_b64_tr_b16 v[148:149], v162 offset:1024
v_mfma_f32_16x16x32_bf16 v[64:67], v[120:123], a[48:51], v[64:67]
buffer_load_dwordx4 v238, s[32:35], s74 offen offset:2048 lds
v_mfma_f32_16x16x32_bf16 v[64:67], v[124:127], a[56:59], v[64:67]
ds_read_b64_tr_b16 v[150:151], v162 offset:9216
v_mfma_f32_16x16x32_bf16 v[68:71], v[124:127], a[60:63], v[68:71]
ds_read_b64_tr_b16 v[152:153], v162 offset:2048
v_mfma_f32_16x16x32_bf16 v[68:71], v[120:123], a[52:55], v[68:71]
ds_read_b64_tr_b16 v[154:155], v162 offset:10240
ds_read_b64_tr_b16 v[156:157], v162 offset:3072
v_mfma_f32_16x16x32_bf16 v[68:71], v[116:119], a[44:47], v[68:71]
buffer_load_dwordx4 v238, s[32:35], s75 offen offset:3072 lds
v_mfma_f32_16x16x32_bf16 v[68:71], v[112:115], a[36:39], v[68:71]
ds_read_b64_tr_b16 v[158:159], v162 offset:11264
s_waitcnt lgkmcnt(8)
v_mfma_f32_16x16x32_bf16 v[72:75], v[128:131], a[32:35], v[72:75]
ds_read_b64_tr_b16 v[112:113], v163 offset:0
v_mfma_f32_16x16x32_bf16 v[72:75], v[132:135], a[40:43], v[72:75]
ds_read_b64_tr_b16 v[114:115], v163 offset:8192
v_mfma_f32_16x16x32_bf16 v[72:75], v[136:139], a[48:51], v[72:75]
ds_read_b64_tr_b16 v[116:117], v163 offset:1024
ds_read_b64_tr_b16 v[118:119], v163 offset:9216
s_add_u32 m0, s80, 32768
v_mfma_f32_16x16x32_bf16 v[72:75], v[140:143], a[56:59], v[72:75]
buffer_load_dwordx4 v237, s[32:35], s44 offen lds
v_mfma_f32_16x16x32_bf16 v[76:79], v[140:143], a[60:63], v[76:79]
ds_read_b64_tr_b16 v[120:121], v163 offset:2048
v_mfma_f32_16x16x32_bf16 v[76:79], v[136:139], a[52:55], v[76:79]
ds_read_b64_tr_b16 v[122:123], v163 offset:10240
v_mfma_f32_16x16x32_bf16 v[76:79], v[132:135], a[44:47], v[76:79]
ds_read_b64_tr_b16 v[124:125], v163 offset:3072
ds_read_b64_tr_b16 v[126:127], v163 offset:11264
v_mfma_f32_16x16x32_bf16 v[76:79], v[128:131], a[36:39], v[76:79]
s_waitcnt vmcnt(27) lgkmcnt(8)
s_barrier
v_mfma_f32_16x16x32_bf16 v[80:83], v[144:147], a[32:35], v[80:83]
ds_read_b64_tr_b16 v[128:129], v164 offset:16384
ds_read_b64_tr_b16 v[130:131], v164 offset:24576
v_mfma_f32_16x16x32_bf16 v[80:83], v[148:151], a[40:43], v[80:83]
buffer_load_dwordx4 v237, s[32:35], s45 offen offset:1024 lds
v_mfma_f32_16x16x32_bf16 v[80:83], v[152:155], a[48:51], v[80:83]
ds_read_b64_tr_b16 v[132:133], v164 offset:17408
v_mfma_f32_16x16x32_bf16 v[80:83], v[156:159], a[56:59], v[80:83]
ds_read_b64_tr_b16 v[134:135], v164 offset:25600
v_mfma_f32_16x16x32_bf16 v[84:87], v[156:159], a[60:63], v[84:87]
ds_read_b64_tr_b16 v[136:137], v164 offset:18432
ds_read_b64_tr_b16 v[138:139], v164 offset:26624
v_mfma_f32_16x16x32_bf16 v[84:87], v[152:155], a[52:55], v[84:87]
buffer_load_dwordx4 v237, s[32:35], s46 offen offset:2048 lds
v_mfma_f32_16x16x32_bf16 v[84:87], v[148:151], a[44:47], v[84:87]
ds_read_b64_tr_b16 v[140:141], v164 offset:19456
v_mfma_f32_16x16x32_bf16 v[84:87], v[144:147], a[36:39], v[84:87]
ds_read_b64_tr_b16 v[142:143], v164 offset:27648
s_waitcnt lgkmcnt(8)
v_mfma_f32_16x16x32_bf16 v[88:91], v[112:115], a[32:35], v[88:91]
ds_read_b64_tr_b16 v[144:145], v165 offset:16384
ds_read_b64_tr_b16 v[146:147], v165 offset:24576
v_mfma_f32_16x16x32_bf16 v[88:91], v[116:119], a[40:43], v[88:91]
buffer_load_dwordx4 v237, s[32:35], s47 offen offset:3072 lds
buffer_load_dword v243, v241, s[40:43], s86 offen offset:1024 sc1
v_mfma_f32_16x16x32_bf16 v[88:91], v[120:123], a[48:51], v[88:91]
ds_read_b64_tr_b16 v[148:149], v165 offset:17408
v_mfma_f32_16x16x32_bf16 v[88:91], v[124:127], a[56:59], v[88:91]
ds_read_b64_tr_b16 v[150:151], v165 offset:25600
v_mfma_f32_16x16x32_bf16 v[92:95], v[124:127], a[60:63], v[92:95]
ds_read_b64_tr_b16 v[152:153], v165 offset:18432
v_mfma_f32_16x16x32_bf16 v[92:95], v[120:123], a[52:55], v[92:95]
ds_read_b64_tr_b16 v[154:155], v165 offset:26624
v_mfma_f32_16x16x32_bf16 v[92:95], v[116:119], a[44:47], v[92:95]
ds_read_b64_tr_b16 v[156:157], v165 offset:19456
v_mfma_f32_16x16x32_bf16 v[92:95], v[112:115], a[36:39], v[92:95]
ds_read_b64_tr_b16 v[158:159], v165 offset:27648
s_waitcnt vmcnt(22) lgkmcnt(8)
v_mfma_f32_16x16x32_bf16 v[0:3], v[128:131], a[64:67], v[0:3]
ds_read_b64_tr_b16 v[112:113], v166 offset:16384
s_add_u32 s82, s80, 147456
v_mfma_f32_16x16x32_bf16 v[0:3], v[132:135], a[72:75], v[0:3]
ds_read_b64_tr_b16 v[114:115], v166 offset:24576
v_lshrrev_b32 v235, 7, v239
v_mfma_f32_16x16x32_bf16 v[0:3], v[136:139], a[80:83], v[0:3]
ds_read_b64_tr_b16 v[116:117], v166 offset:17408
v_mfma_f32_16x16x32_bf16 v[0:3], v[140:143], a[88:91], v[0:3]
ds_read_b64_tr_b16 v[118:119], v166 offset:25600
ds_read_b64_tr_b16 v[120:121], v166 offset:18432
s_add_u32 m0, s80, 49152
v_mfma_f32_16x16x32_bf16 v[4:7], v[140:143], a[92:95], v[4:7]
buffer_load_dwordx4 v237, s[32:35], s48 offen lds
v_mfma_f32_16x16x32_bf16 v[4:7], v[136:139], a[84:87], v[4:7]
ds_read_b64_tr_b16 v[122:123], v166 offset:26624
v_lshlrev_b32 v246, 11, v235
v_mfma_f32_16x16x32_bf16 v[4:7], v[132:135], a[76:79], v[4:7]
ds_read_b64_tr_b16 v[124:125], v166 offset:19456
v_lshlrev_b32 v235, 4, v235
v_mfma_f32_16x16x32_bf16 v[4:7], v[128:131], a[68:71], v[4:7]
ds_read_b64_tr_b16 v[126:127], v166 offset:27648
s_waitcnt lgkmcnt(8)
v_mfma_f32_16x16x32_bf16 v[8:11], v[144:147], a[64:67], v[8:11]
ds_read_b64_tr_b16 v[128:129], v167 offset:16384
ds_read_b64_tr_b16 v[130:131], v167 offset:24576
v_mfma_f32_16x16x32_bf16 v[8:11], v[148:151], a[72:75], v[8:11]
buffer_load_dwordx4 v237, s[32:35], s49 offen offset:1024 lds
v_mfma_f32_16x16x32_bf16 v[8:11], v[152:155], a[80:83], v[8:11]
ds_read_b64_tr_b16 v[132:133], v167 offset:17408
v_xor_b32 v235, v235, v239
v_mfma_f32_16x16x32_bf16 v[8:11], v[156:159], a[88:91], v[8:11]
ds_read_b64_tr_b16 v[134:135], v167 offset:25600
v_add_u32 v235, s82, v235
v_mfma_f32_16x16x32_bf16 v[12:15], v[156:159], a[92:95], v[12:15]
ds_read_b64_tr_b16 v[136:137], v167 offset:18432
ds_read_b64_tr_b16 v[138:139], v167 offset:26624
v_mfma_f32_16x16x32_bf16 v[12:15], v[152:155], a[84:87], v[12:15]
buffer_load_dwordx4 v237, s[32:35], s50 offen offset:2048 lds
v_mfma_f32_16x16x32_bf16 v[12:15], v[148:151], a[76:79], v[12:15]
ds_read_b64_tr_b16 v[140:141], v167 offset:19456
v_and_b32 v234, 0x70, v239
v_mfma_f32_16x16x32_bf16 v[12:15], v[144:147], a[68:71], v[12:15]
ds_read_b64_tr_b16 v[142:143], v167 offset:27648
s_waitcnt lgkmcnt(8)
v_mfma_f32_16x16x32_bf16 v[16:19], v[112:115], a[64:67], v[16:19]
ds_read_b64_tr_b16 v[144:145], v164 offset:32768
ds_read_b64_tr_b16 v[146:147], v164 offset:40960
v_mfma_f32_16x16x32_bf16 v[16:19], v[116:119], a[72:75], v[16:19]
buffer_load_dwordx4 v237, s[32:35], s51 offen offset:3072 lds
v_mfma_f32_16x16x32_bf16 v[16:19], v[120:123], a[80:83], v[16:19]
ds_read_b64_tr_b16 v[148:149], v164 offset:33792
v_add_u32 v246, v246, v234
v_mfma_f32_16x16x32_bf16 v[16:19], v[124:127], a[88:91], v[16:19]
ds_read_b64_tr_b16 v[150:151], v164 offset:41984
v_lshrrev_b32 v236, 9, v239
v_mfma_f32_16x16x32_bf16 v[20:23], v[124:127], a[92:95], v[20:23]
ds_read_b64_tr_b16 v[152:153], v164 offset:34816
ds_read_b64_tr_b16 v[154:155], v164 offset:43008
s_add_u32 m0, s80, 65536
v_mfma_f32_16x16x32_bf16 v[20:23], v[120:123], a[84:87], v[20:23]
buffer_load_dwordx4 v237, s[32:35], s52 offen lds
v_lshlrev_b32 v236, 4, v236
v_mfma_f32_16x16x32_bf16 v[20:23], v[116:119], a[76:79], v[20:23]
ds_read_b64_tr_b16 v[156:157], v164 offset:35840
v_xor_b32 v234, v234, v236
v_bfe_u32 v236, v239, 8, 1
v_mfma_f32_16x16x32_bf16 v[20:23], v[112:115], a[68:71], v[20:23]
ds_read_b64_tr_b16 v[158:159], v164 offset:44032
s_waitcnt lgkmcnt(8)
v_mfma_f32_16x16x32_bf16 v[24:27], v[128:131], a[64:67], v[24:27]
ds_read_b64_tr_b16 v[112:113], v165 offset:32768
ds_read_b64_tr_b16 v[114:115], v165 offset:40960
v_lshl_add_u32 v234, v236, 3, v234
v_mfma_f32_16x16x32_bf16 v[24:27], v[132:135], a[72:75], v[24:27]
buffer_load_dwordx4 v237, s[32:35], s53 offen offset:1024 lds
v_bfe_u32 v236, v239, 4, 4
v_mfma_f32_16x16x32_bf16 v[24:27], v[136:139], a[80:83], v[24:27]
ds_read_b64_tr_b16 v[116:117], v165 offset:33792
v_lshl_add_u32 v234, v236, 7, v234
v_add_u32 v234, s82, v234
v_mfma_f32_16x16x32_bf16 v[24:27], v[140:143], a[88:91], v[24:27]
ds_read_b64_tr_b16 v[118:119], v165 offset:41984
s_lshl_b32 s82, s16, 16
s_add_u32 s82, s82, s19
v_mfma_f32_16x16x32_bf16 v[28:31], v[140:143], a[92:95], v[28:31]
ds_read_b64_tr_b16 v[120:121], v165 offset:34816
ds_read_b64_tr_b16 v[122:123], v165 offset:43008
v_add_u32 v246, s82, v246
v_mfma_f32_16x16x32_bf16 v[28:31], v[136:139], a[84:87], v[28:31]
buffer_load_dwordx4 v237, s[32:35], s54 offen offset:2048 lds
s_mov_b32 s88, 0x4000
v_mfma_f32_16x16x32_bf16 v[28:31], v[132:135], a[76:79], v[28:31]
ds_read_b64_tr_b16 v[124:125], v165 offset:35840
s_mov_b32 s87, 0xc000
v_mfma_f32_16x16x32_bf16 v[28:31], v[128:131], a[68:71], v[28:31]
ds_read_b64_tr_b16 v[126:127], v165 offset:44032
s_waitcnt vmcnt(20) lgkmcnt(8)
v_mfma_f32_16x16x32_bf16 v[0:3], v[144:147], a[96:99], v[0:3]
ds_read_b64_tr_b16 v[128:129], v166 offset:32768
ds_read_b64_tr_b16 v[130:131], v166 offset:40960
v_mfma_f32_16x16x32_bf16 v[0:3], v[148:151], a[104:107], v[0:3]
buffer_load_dwordx4 v237, s[32:35], s55 offen offset:3072 lds
v_mfma_f32_16x16x32_bf16 v[0:3], v[152:155], a[112:115], v[0:3]
ds_read_b64_tr_b16 v[132:133], v166 offset:33792
v_mfma_f32_16x16x32_bf16 v[0:3], v[156:159], a[120:123], v[0:3]
ds_read_b64_tr_b16 v[134:135], v166 offset:41984
v_mfma_f32_16x16x32_bf16 v[4:7], v[156:159], a[124:127], v[4:7]
ds_read_b64_tr_b16 v[136:137], v166 offset:34816
v_mfma_f32_16x16x32_bf16 v[4:7], v[152:155], a[116:119], v[4:7]
ds_read_b64_tr_b16 v[138:139], v166 offset:43008
v_mfma_f32_16x16x32_bf16 v[4:7], v[148:151], a[108:111], v[4:7]
ds_read_b64_tr_b16 v[140:141], v166 offset:35840
v_mfma_f32_16x16x32_bf16 v[4:7], v[144:147], a[100:103], v[4:7]
ds_read_b64_tr_b16 v[142:143], v166 offset:44032
s_waitcnt lgkmcnt(8)
v_mfma_f32_16x16x32_bf16 v[8:11], v[112:115], a[96:99], v[8:11]
ds_read_b64_tr_b16 v[144:145], v167 offset:32768
s_waitcnt vmcnt(8)
v_mfma_f32_16x16x32_bf16 v[8:11], v[116:119], a[104:107], v[8:11]
ds_read_b64_tr_b16 v[146:147], v167 offset:40960
v_sub_u32 v243, v243, v242
v_mfma_f32_16x16x32_bf16 v[8:11], v[120:123], a[112:115], v[8:11]
ds_read_b64_tr_b16 v[148:149], v167 offset:33792
v_add_u32 v243, -3, v243
v_mfma_f32_16x16x32_bf16 v[8:11], v[124:127], a[120:123], v[8:11]
ds_read_b64_tr_b16 v[150:151], v167 offset:41984
v_cmp_le_u32 vcc, 13, v243
s_cbranch_vccnz L_slow5
L_back5:
v_mfma_f32_16x16x32_bf16 v[12:15], v[124:127], a[124:127], v[12:15]
ds_read_b64_tr_b16 v[152:153], v167 offset:34816
v_mfma_f32_16x16x32_bf16 v[12:15], v[120:123], a[116:119], v[12:15]
ds_read_b64_tr_b16 v[154:155], v167 offset:43008
v_mfma_f32_16x16x32_bf16 v[12:15], v[116:119], a[108:111], v[12:15]
ds_read_b64_tr_b16 v[156:157], v167 offset:35840
ds_read_b64_tr_b16 v[158:159], v167 offset:44032
v_mfma_f32_16x16x32_bf16 v[12:15], v[112:115], a[100:103], v[12:15]
s_waitcnt lgkmcnt(8)
s_barrier
v_mfma_f32_16x16x32_bf16 v[16:19], v[128:131], a[96:99], v[16:19]
ds_read_b64_tr_b16 v[112:113], v164 offset:49152
ds_read_b64_tr_b16 v[114:115], v164 offset:57344
v_add_u32 v240, 4096, v240
v_mfma_f32_16x16x32_bf16 v[16:19], v[132:135], a[104:107], v[16:19]
buffer_load_dwordx4 a[128:131], v240, s[40:43], s8 offen offset:0 sc1
v_mfma_f32_16x16x32_bf16 v[16:19], v[136:139], a[112:115], v[16:19]
ds_read_b64_tr_b16 v[116:117], v164 offset:50176
v_mfma_f32_16x16x32_bf16 v[16:19], v[140:143], a[120:123], v[16:19]
ds_read_b64_tr_b16 v[118:119], v164 offset:58368
v_mfma_f32_16x16x32_bf16 v[20:23], v[140:143], a[124:127], v[20:23]
ds_read_b64_tr_b16 v[120:121], v164 offset:51200
ds_read_b64_tr_b16 v[122:123], v164 offset:59392
v_mfma_f32_16x16x32_bf16 v[20:23], v[136:139], a[116:119], v[20:23]
buffer_load_dwordx4 a[132:135], v240, s[40:43], s8 offen offset:128 sc1
v_mfma_f32_16x16x32_bf16 v[20:23], v[132:135], a[108:111], v[20:23]
ds_read_b64_tr_b16 v[124:125], v164 offset:52224
buffer_load_dword v243, v241, s[40:43], s86 offen offset:1024 sc1
L_pad7:
s_cbranch_execz L_warm1
v_mfma_f32_16x16x32_bf16 v[20:23], v[128:131], a[100:103], v[20:23]
ds_read_b64_tr_b16 v[126:127], v164 offset:60416
s_waitcnt lgkmcnt(8)
v_mfma_f32_16x16x32_bf16 v[24:27], v[144:147], a[96:99], v[24:27]
ds_read_b64_tr_b16 v[128:129], v165 offset:49152
ds_read_b64_tr_b16 v[130:131], v165 offset:57344
v_mfma_f32_16x16x32_bf16 v[24:27], v[148:151], a[104:107], v[24:27]
buffer_load_dwordx4 a[136:139], v240, s[40:43], s9 offen offset:0 sc1
v_mfma_f32_16x16x32_bf16 v[24:27], v[152:155], a[112:115], v[24:27]
ds_read_b64_tr_b16 v[132:133], v165 offset:50176
v_mfma_f32_16x16x32_bf16 v[24:27], v[156:159], a[120:123], v[24:27]
ds_read_b64_tr_b16 v[134:135], v165 offset:58368
v_mfma_f32_16x16x32_bf16 v[28:31], v[156:159], a[124:127], v[28:31]
ds_read_b64_tr_b16 v[136:137], v165 offset:51200
ds_read_b64_tr_b16 v[138:139], v165 offset:59392
v_mfma_f32_16x16x32_bf16 v[28:31], v[152:155], a[116:119], v[28:31]
buffer_load_dwordx4 a[140:143], v240, s[40:43], s9 offen offset:128 sc1
v_mfma_f32_16x16x32_bf16 v[28:31], v[148:151], a[108:111], v[28:31]
ds_read_b64_tr_b16 v[140:141], v165 offset:52224
v_mfma_f32_16x16x32_bf16 v[28:31], v[144:147], a[100:103], v[28:31]
ds_read_b64_tr_b16 v[142:143], v165 offset:60416
s_waitcnt lgkmcnt(8)
v_mfma_f32_16x16x32_bf16 v[32:35], v[112:115], a[64:67], v[32:35]
ds_read_b64_tr_b16 v[144:145], v166 offset:49152
ds_read_b64_tr_b16 v[146:147], v166 offset:57344
v_mfma_f32_16x16x32_bf16 v[32:35], v[116:119], a[72:75], v[32:35]
buffer_load_dwordx4 a[144:147], v240, s[40:43], s10 offen offset:0 sc1
v_mfma_f32_16x16x32_bf16 v[32:35], v[120:123], a[80:83], v[32:35]
ds_read_b64_tr_b16 v[148:149], v166 offset:50176
v_mfma_f32_16x16x32_bf16 v[32:35], v[124:127], a[88:91], v[32:35]
ds_read_b64_tr_b16 v[150:151], v166 offset:58368
v_mfma_f32_16x16x32_bf16 v[36:39], v[124:127], a[92:95], v[36:39]
ds_read_b64_tr_b16 v[152:153], v166 offset:51200
ds_read_b64_tr_b16 v[154:155], v166 offset:59392
v_mfma_f32_16x16x32_bf16 v[36:39], v[120:123], a[84:87], v[36:39]
buffer_load_dwordx4 a[148:151], v240, s[40:43], s10 offen offset:128 sc1
v_mfma_f32_16x16x32_bf16 v[36:39], v[116:119], a[76:79], v[36:39]
ds_read_b64_tr_b16 v[156:157], v166 offset:52224
v_mfma_f32_16x16x32_bf16 v[36:39], v[112:115], a[68:71], v[36:39]
ds_read_b64_tr_b16 v[158:159], v166 offset:60416
s_waitcnt lgkmcnt(8)
v_mfma_f32_16x16x32_bf16 v[40:43], v[128:131], a[64:67], v[40:43]
ds_read_b64_tr_b16 v[112:113], v167 offset:49152
ds_read_b64_tr_b16 v[114:115], v167 offset:57344
v_mfma_f32_16x16x32_bf16 v[40:43], v[132:135], a[72:75], v[40:43]
buffer_load_dwordx4 a[152:155], v240, s[40:43], s11 offen offset:0 sc1
v_mfma_f32_16x16x32_bf16 v[40:43], v[136:139], a[80:83], v[40:43]
ds_read_b64_tr_b16 v[116:117], v167 offset:50176
v_mfma_f32_16x16x32_bf16 v[40:43], v[140:143], a[88:91], v[40:43]
ds_read_b64_tr_b16 v[118:119], v167 offset:58368
v_mfma_f32_16x16x32_bf16 v[44:47], v[140:143], a[92:95], v[44:47]
ds_read_b64_tr_b16 v[120:121], v167 offset:51200
ds_read_b64_tr_b16 v[122:123], v167 offset:59392
v_mfma_f32_16x16x32_bf16 v[44:47], v[136:139], a[84:87], v[44:47]
buffer_load_dwordx4 a[156:159], v240, s[40:43], s11 offen offset:128 sc1
v_mfma_f32_16x16x32_bf16 v[44:47], v[132:135], a[76:79], v[44:47]
ds_read_b64_tr_b16 v[124:125], v167 offset:52224
v_mfma_f32_16x16x32_bf16 v[44:47], v[128:131], a[68:71], v[44:47]
ds_read_b64_tr_b16 v[126:127], v167 offset:60416
s_waitcnt lgkmcnt(8)
v_mfma_f32_16x16x32_bf16 v[48:51], v[144:147], a[64:67], v[48:51]
ds_read_b64_tr_b16 v[128:129], v160 offset:16384
ds_read_b64_tr_b16 v[130:131], v160 offset:24576
v_add_u32 v240, 4096, v240
v_mfma_f32_16x16x32_bf16 v[48:51], v[148:151], a[72:75], v[48:51]
buffer_load_dwordx4 a[160:163], v240, s[40:43], s8 offen offset:0 sc1
v_mfma_f32_16x16x32_bf16 v[48:51], v[152:155], a[80:83], v[48:51]
ds_read_b64_tr_b16 v[132:133], v160 offset:17408
v_mfma_f32_16x16x32_bf16 v[48:51], v[156:159], a[88:91], v[48:51]
ds_read_b64_tr_b16 v[134:135], v160 offset:25600
v_mfma_f32_16x16x32_bf16 v[52:55], v[156:159], a[92:95], v[52:55]
ds_read_b64_tr_b16 v[136:137], v160 offset:18432
ds_read_b64_tr_b16 v[138:139], v160 offset:26624
v_mfma_f32_16x16x32_bf16 v[52:55], v[152:155], a[84:87], v[52:55]
buffer_load_dwordx4 a[164:167], v240, s[40:43], s8 offen offset:128 sc1
v_mfma_f32_16x16x32_bf16 v[52:55], v[148:151], a[76:79], v[52:55]
ds_read_b64_tr_b16 v[140:141], v160 offset:19456
v_mfma_f32_16x16x32_bf16 v[52:55], v[144:147], a[68:71], v[52:55]
ds_read_b64_tr_b16 v[142:143], v160 offset:27648
s_waitcnt lgkmcnt(8)
v_mfma_f32_16x16x32_bf16 v[56:59], v[112:115], a[64:67], v[56:59]
ds_read_b64_tr_b16 v[144:145], v161 offset:16384
ds_read_b64_tr_b16 v[146:147], v161 offset:24576
v_mfma_f32_16x16x32_bf16 v[56:59], v[116:119], a[72:75], v[56:59]
buffer_load_dwordx4 a[168:171], v240, s[40:43], s9 offen offset:0 sc1
v_mfma_f32_16x16x32_bf16 v[56:59], v[120:123], a[80:83], v[56:59]
ds_read_b64_tr_b16 v[148:149], v161 offset:17408
v_mfma_f32_16x16x32_bf16 v[56:59], v[124:127], a[88:91], v[56:59]
ds_read_b64_tr_b16 v[150:151], v161 offset:25600
v_mfma_f32_16x16x32_bf16 v[60:63], v[124:127], a[92:95], v[60:63]
ds_read_b64_tr_b16 v[152:153], v161 offset:18432
ds_read_b64_tr_b16 v[154:155], v161 offset:26624
v_mfma_f32_16x16x32_bf16 v[60:63], v[120:123], a[84:87], v[60:63]
buffer_load_dwordx4 a[172:175], v240, s[40:43], s9 offen offset:128 sc1
v_mfma_f32_16x16x32_bf16 v[60:63], v[116:119], a[76:79], v[60:63]
ds_read_b64_tr_b16 v[156:157], v161 offset:19456
v_mfma_f32_16x16x32_bf16 v[60:63], v[112:115], a[68:71], v[60:63]
ds_read_b64_tr_b16 v[158:159], v161 offset:27648
s_waitcnt lgkmcnt(8)
v_mfma_f32_16x16x32_bf16 v[32:35], v[128:131], a[96:99], v[32:35]
ds_read_b64_tr_b16 v[112:113], v162 offset:16384
ds_read_b64_tr_b16 v[114:115], v162 offset:24576
v_mfma_f32_16x16x32_bf16 v[32:35], v[132:135], a[104:107], v[32:35]
buffer_load_dwordx4 a[176:179], v240, s[40:43], s10 offen offset:0 sc1
v_mfma_f32_16x16x32_bf16 v[32:35], v[136:139], a[112:115], v[32:35]
ds_read_b64_tr_b16 v[116:117], v162 offset:17408
v_mfma_f32_16x16x32_bf16 v[32:35], v[140:143], a[120:123], v[32:35]
ds_read_b64_tr_b16 v[118:119], v162 offset:25600
v_mfma_f32_16x16x32_bf16 v[36:39], v[140:143], a[124:127], v[36:39]
ds_read_b64_tr_b16 v[120:121], v162 offset:18432
ds_read_b64_tr_b16 v[122:123], v162 offset:26624
v_mfma_f32_16x16x32_bf16 v[36:39], v[136:139], a[116:119], v[36:39]
buffer_load_dwordx4 a[180:183], v240, s[40:43], s10 offen offset:128 sc1
v_mfma_f32_16x16x32_bf16 v[36:39], v[132:135], a[108:111], v[36:39]
ds_read_b64_tr_b16 v[124:125], v162 offset:19456
s_waitcnt vmcnt(12)
v_mfma_f32_16x16x32_bf16 v[36:39], v[128:131], a[100:103], v[36:39]
ds_read_b64_tr_b16 v[126:127], v162 offset:27648
s_waitcnt lgkmcnt(8)
v_mfma_f32_16x16x32_bf16 v[40:43], v[144:147], a[96:99], v[40:43]
ds_read_b64_tr_b16 v[128:129], v163 offset:16384
ds_read_b64_tr_b16 v[130:131], v163 offset:24576
v_mfma_f32_16x16x32_bf16 v[40:43], v[148:151], a[104:107], v[40:43]
buffer_load_dwordx4 a[184:187], v240, s[40:43], s11 offen offset:0 sc1
v_sub_u32 v243, v243, v242
v_mfma_f32_16x16x32_bf16 v[40:43], v[152:155], a[112:115], v[40:43]
ds_read_b64_tr_b16 v[132:133], v163 offset:17408
v_add_u32 v243, -4, v243
v_cmp_le_u32 vcc, 12, v243
s_cbranch_vccnz L_slow6
L_back6:
v_mfma_f32_16x16x32_bf16 v[40:43], v[156:159], a[120:123], v[40:43]
ds_read_b64_tr_b16 v[134:135], v163 offset:25600
v_mfma_f32_16x16x32_bf16 v[44:47], v[156:159], a[124:127], v[44:47]
ds_read_b64_tr_b16 v[136:137], v163 offset:18432
ds_read_b64_tr_b16 v[138:139], v163 offset:26624
v_mfma_f32_16x16x32_bf16 v[44:47], v[152:155], a[116:119], v[44:47]
buffer_load_dwordx4 a[188:191], v240, s[40:43], s11 offen offset:128 sc1
v_mfma_f32_16x16x32_bf16 v[44:47], v[148:151], a[108:111], v[44:47]
ds_read_b64_tr_b16 v[140:141], v163 offset:19456
ds_read_b64_tr_b16 v[142:143], v163 offset:27648
v_mfma_f32_16x16x32_bf16 v[44:47], v[144:147], a[100:103], v[44:47]
s_waitcnt lgkmcnt(8)
s_barrier
v_mfma_f32_16x16x32_bf16 v[48:51], v[112:115], a[96:99], v[48:51]
ds_read_b64_tr_b16 v[144:145], v160 offset:32768
ds_read_b64_tr_b16 v[146:147], v160 offset:40960
v_add_u32 v240, 4096, v240
v_mfma_f32_16x16x32_bf16 v[48:51], v[116:119], a[104:107], v[48:51]
buffer_load_dwordx4 a[192:195], v240, s[40:43], s8 offen offset:0 sc1
v_mfma_f32_16x16x32_bf16 v[48:51], v[120:123], a[112:115], v[48:51]
ds_read_b64_tr_b16 v[148:149], v160 offset:33792
v_mfma_f32_16x16x32_bf16 v[48:51], v[124:127], a[120:123], v[48:51]
ds_read_b64_tr_b16 v[150:151], v160 offset:41984
v_mfma_f32_16x16x32_bf16 v[52:55], v[124:127], a[124:127], v[52:55]
ds_read_b64_tr_b16 v[152:153], v160 offset:34816
ds_read_b64_tr_b16 v[154:155], v160 offset:43008
v_mfma_f32_16x16x32_bf16 v[52:55], v[120:123], a[116:119], v[52:55]
buffer_load_dwordx4 a[196:199], v240, s[40:43], s8 offen offset:128 sc1
v_mfma_f32_16x16x32_bf16 v[52:55], v[116:119], a[108:111], v[52:55]
ds_read_b64_tr_b16 v[156:157], v160 offset:35840
v_mfma_f32_16x16x32_bf16 v[52:55], v[112:115], a[100:103], v[52:55]
ds_read_b64_tr_b16 v[158:159], v160 offset:44032
s_waitcnt lgkmcnt(8)
v_mfma_f32_16x16x32_bf16 v[56:59], v[128:131], a[96:99], v[56:59]
ds_read_b64_tr_b16 v[112:113], v161 offset:32768
ds_read_b64_tr_b16 v[114:115], v161 offset:40960
s_add_u32 m0, s80, 0
v_mfma_f32_16x16x32_bf16 v[56:59], v[132:135], a[104:107], v[56:59]
buffer_load_dwordx4 v238, s[32:35], s44 offen lds
v_mfma_f32_16x16x32_bf16 v[56:59], v[136:139], a[112:115], v[56:59]
ds_read_b64_tr_b16 v[116:117], v161 offset:33792
v_mfma_f32_16x16x32_bf16 v[56:59], v[140:143], a[120:123], v[56:59]
ds_read_b64_tr_b16 v[118:119], v161 offset:41984
v_mfma_f32_16x16x32_bf16 v[60:63], v[140:143], a[124:127], v[60:63]
ds_read_b64_tr_b16 v[120:121], v161 offset:34816
ds_read_b64_tr_b16 v[122:123], v161 offset:43008
v_mfma_f32_16x16x32_bf16 v[60:63], v[136:139], a[116:119], v[60:63]
buffer_load_dwordx4 a[200:203], v240, s[40:43], s9 offen offset:0 sc1
v_mfma_f32_16x16x32_bf16 v[60:63], v[132:135], a[108:111], v[60:63]
ds_read_b64_tr_b16 v[124:125], v161 offset:35840
v_mfma_f32_16x16x32_bf16 v[60:63], v[128:131], a[100:103], v[60:63]
ds_read_b64_tr_b16 v[126:127], v161 offset:44032
s_waitcnt vmcnt(12) lgkmcnt(8)
v_mfma_f32_16x16x32_bf16 v[0:3], v[144:147], a[128:131], v[0:3]
ds_read_b64_tr_b16 v[128:129], v162 offset:32768
ds_read_b64_tr_b16 v[130:131], v162 offset:40960
v_mfma_f32_16x16x32_bf16 v[0:3], v[148:151], a[136:139], v[0:3]
buffer_load_dwordx4 v238, s[32:35], s45 offen offset:1024 lds
v_mfma_f32_16x16x32_bf16 v[0:3], v[152:155], a[144:147], v[0:3]
ds_read_b64_tr_b16 v[132:133], v162 offset:33792
ds_read_b64_tr_b16 v[134:135], v162 offset:41984
v_mfma_f32_16x16x32_bf16 v[0:3], v[156:159], a[152:155], v[0:3]
buffer_load_dwordx4 a[204:207], v240, s[40:43], s9 offen offset:128 sc1
v_mfma_f32_16x16x32_bf16 v[4:7], v[156:159], a[156:159], v[4:7]
ds_read_b64_tr_b16 v[136:137], v162 offset:34816
ds_read_b64_tr_b16 v[138:139], v162 offset:43008
v_mfma_f32_16x16x32_bf16 v[4:7], v[152:155], a[148:151], v[4:7]
buffer_load_dwordx4 v238, s[32:35], s46 offen offset:2048 lds
v_mfma_f32_16x16x32_bf16 v[4:7], v[148:151], a[140:143], v[4:7]
ds_read_b64_tr_b16 v[140:141], v162 offset:35840
v_mfma_f32_16x16x32_bf16 v[4:7], v[144:147], a[132:135], v[4:7]
ds_read_b64_tr_b16 v[142:143], v162 offset:44032
s_waitcnt lgkmcnt(8)
v_mfma_f32_16x16x32_bf16 v[8:11], v[112:115], a[128:131], v[8:11]
ds_read_b64_tr_b16 v[144:145], v163 offset:32768
ds_read_b64_tr_b16 v[146:147], v163 offset:40960
v_mfma_f32_16x16x32_bf16 v[8:11], v[116:119], a[136:139], v[8:11]
buffer_load_dwordx4 a[208:211], v240, s[40:43], s10 offen offset:0 sc1
v_mfma_f32_16x16x32_bf16 v[8:11], v[120:123], a[144:147], v[8:11]
ds_read_b64_tr_b16 v[148:149], v163 offset:33792
ds_read_b64_tr_b16 v[150:151], v163 offset:41984
v_mfma_f32_16x16x32_bf16 v[8:11], v[124:127], a[152:155], v[8:11]
buffer_load_dwordx4 v238, s[32:35], s47 offen offset:3072 lds
v_mfma_f32_16x16x32_bf16 v[12:15], v[124:127], a[156:159], v[12:15]
ds_read_b64_tr_b16 v[152:153], v163 offset:34816
ds_read_b64_tr_b16 v[154:155], v163 offset:43008
v_mfma_f32_16x16x32_bf16 v[12:15], v[120:123], a[148:151], v[12:15]
buffer_load_dwordx4 a[212:215], v240, s[40:43], s10 offen offset:128 sc1
v_mfma_f32_16x16x32_bf16 v[12:15], v[116:119], a[140:143], v[12:15]
ds_read_b64_tr_b16 v[156:157], v163 offset:35840
v_mfma_f32_16x16x32_bf16 v[12:15], v[112:115], a[132:135], v[12:15]
ds_read_b64_tr_b16 v[158:159], v163 offset:44032
s_waitcnt lgkmcnt(8)
v_mfma_f32_16x16x32_bf16 v[16:19], v[128:131], a[128:131], v[16:19]
ds_read_b64_tr_b16 v[112:113], v160 offset:49152
ds_read_b64_tr_b16 v[114:115], v160 offset:57344
v_mfma_f32_16x16x32_bf16 v[16:19], v[132:135], a[136:139], v[16:19]
buffer_load_dwordx4 a[216:219], v240, s[40:43], s11 offen offset:0 sc1
v_mfma_f32_16x16x32_bf16 v[16:19], v[136:139], a[144:147], v[16:19]
ds_read_b64_tr_b16 v[116:117], v160 offset:50176
ds_read_b64_tr_b16 v[118:119], v160 offset:58368
v_mfma_f32_16x16x32_bf16 v[16:19], v[140:143], a[152:155], v[16:19]
buffer_load_dwordx4 a[220:223], v240, s[40:43], s11 offen offset:128 sc1
v_mfma_f32_16x16x32_bf16 v[20:23], v[140:143], a[156:159], v[20:23]
ds_read_b64_tr_b16 v[120:121], v160 offset:51200
v_mfma_f32_16x16x32_bf16 v[20:23], v[136:139], a[148:151], v[20:23]
ds_read_b64_tr_b16 v[122:123], v160 offset:59392
v_mfma_f32_16x16x32_bf16 v[20:23], v[132:135], a[140:143], v[20:23]
ds_read_b64_tr_b16 v[124:125], v160 offset:52224
v_mfma_f32_16x16x32_bf16 v[20:23], v[128:131], a[132:135], v[20:23]
ds_read_b64_tr_b16 v[126:127], v160 offset:60416
s_waitcnt lgkmcnt(8)
v_mfma_f32_16x16x32_bf16 v[24:27], v[144:147], a[128:131], v[24:27]
ds_read_b64_tr_b16 v[128:129], v161 offset:49152
ds_read_b64_tr_b16 v[130:131], v161 offset:57344
s_add_u32 m0, s80, 81920
v_mfma_f32_16x16x32_bf16 v[24:27], v[148:151], a[136:139], v[24:27]
buffer_load_dwordx4 v238, s[32:35], s48 offen lds
v_mfma_f32_16x16x32_bf16 v[24:27], v[152:155], a[144:147], v[24:27]
ds_read_b64_tr_b16 v[132:133], v161 offset:50176
v_mfma_f32_16x16x32_bf16 v[24:27], v[156:159], a[152:155], v[24:27]
ds_read_b64_tr_b16 v[134:135], v161 offset:58368
v_mfma_f32_16x16x32_bf16 v[28:31], v[156:159], a[156:159], v[28:31]
ds_read_b64_tr_b16 v[136:137], v161 offset:51200
ds_read_b64_tr_b16 v[138:139], v161 offset:59392
v_mfma_f32_16x16x32_bf16 v[28:31], v[152:155], a[148:151], v[28:31]
buffer_load_dwordx4 v238, s[32:35], s49 offen offset:1024 lds
v_mfma_f32_16x16x32_bf16 v[28:31], v[148:151], a[140:143], v[28:31]
ds_read_b64_tr_b16 v[140:141], v161 offset:52224
v_mfma_f32_16x16x32_bf16 v[28:31], v[144:147], a[132:135], v[28:31]
ds_read_b64_tr_b16 v[142:143], v161 offset:60416
s_waitcnt vmcnt(14) lgkmcnt(8)
v_mfma_f32_16x16x32_bf16 v[0:3], v[112:115], a[160:163], v[0:3]
ds_read_b64_tr_b16 v[144:145], v162 offset:49152
ds_read_b64_tr_b16 v[146:147], v162 offset:57344
v_mfma_f32_16x16x32_bf16 v[0:3], v[116:119], a[168:171], v[0:3]
buffer_load_dwordx4 v238, s[32:35], s50 offen offset:2048 lds
v_mfma_f32_16x16x32_bf16 v[0:3], v[120:123], a[176:179], v[0:3]
ds_read_b64_tr_b16 v[148:149], v162 offset:50176
v_mfma_f32_16x16x32_bf16 v[0:3], v[124:127], a[184:187], v[0:3]
ds_read_b64_tr_b16 v[150:151], v162 offset:58368
v_mfma_f32_16x16x32_bf16 v[4:7], v[124:127], a[188:191], v[4:7]
ds_read_b64_tr_b16 v[152:153], v162 offset:51200
v_mfma_f32_16x16x32_bf16 v[4:7], v[120:123], a[180:183], v[4:7]
ds_read_b64_tr_b16 v[154:155], v162 offset:59392
v_mfma_f32_16x16x32_bf16 v[4:7], v[116:119], a[172:175], v[4:7]
ds_read_b64_tr_b16 v[156:157], v162 offset:52224
v_mfma_f32_16x16x32_bf16 v[4:7], v[112:115], a[164:167], v[4:7]
ds_read_b64_tr_b16 v[158:159], v162 offset:60416
s_waitcnt lgkmcnt(8)
v_mfma_f32_16x16x32_bf16 v[8:11], v[128:131], a[160:163], v[8:11]
ds_read_b64_tr_b16 v[112:113], v163 offset:49152
ds_read_b64_tr_b16 v[114:115], v163 offset:57344
v_mfma_f32_16x16x32_bf16 v[8:11], v[132:135], a[168:171], v[8:11]
buffer_load_dwordx4 v238, s[32:35], s51 offen offset:3072 lds
v_mfma_f32_16x16x32_bf16 v[8:11], v[136:139], a[176:179], v[8:11]
ds_read_b64_tr_b16 v[116:117], v163 offset:50176
v_mfma_f32_16x16x32_bf16 v[8:11], v[140:143], a[184:187], v[8:11]
ds_read_b64_tr_b16 v[118:119], v163 offset:58368
v_mfma_f32_16x16x32_bf16 v[12:15], v[140:143], a[188:191], v[12:15]
ds_read_b64_tr_b16 v[120:121], v163 offset:51200
ds_read_b64_tr_b16 v[122:123], v163 offset:59392
s_add_u32 m0, s80, 98304
v_mfma_f32_16x16x32_bf16 v[12:15], v[136:139], a[180:183], v[12:15]
buffer_load_dwordx4 v238, s[32:35], s52 offen lds
v_mfma_f32_16x16x32_bf16 v[12:15], v[132:135], a[172:175], v[12:15]
ds_read_b64_tr_b16 v[124:125], v163 offset:52224
ds_read_b64_tr_b16 v[126:127], v163 offset:60416
v_mfma_f32_16x16x32_bf16 v[12:15], v[128:131], a[164:167], v[12:15]
s_waitcnt vmcnt(8) lgkmcnt(8)
s_barrier
v_mfma_f32_16x16x32_bf16 v[16:19], v[144:147], a[160:163], v[16:19]
ds_read_b64_tr_b16 v[128:129], v164 offset:0
v_mfma_f32_16x16x32_bf16 v[16:19], v[148:151], a[168:171], v[16:19]
ds_read_b64_tr_b16 v[130:131], v164 offset:8192
ds_read_b64_tr_b16 v[132:133], v164 offset:1024
v_mfma_f32_16x16x32_bf16 v[16:19], v[152:155], a[176:179], v[16:19]
buffer_load_dwordx4 v238, s[32:35], s53 offen offset:1024 lds
v_mfma_f32_16x16x32_bf16 v[16:19], v[156:159], a[184:187], v[16:19]
ds_read_b64_tr_b16 v[134:135], v164 offset:9216
v_mfma_f32_16x16x32_bf16 v[20:23], v[156:159], a[188:191], v[20:23]
ds_read_b64_tr_b16 v[136:137], v164 offset:2048
v_mfma_f32_16x16x32_bf16 v[20:23], v[152:155], a[180:183], v[20:23]
ds_read_b64_tr_b16 v[138:139], v164 offset:10240
v_mfma_f32_16x16x32_bf16 v[20:23], v[148:151], a[172:175], v[20:23]
ds_read_b64_tr_b16 v[140:141], v164 offset:3072
v_mfma_f32_16x16x32_bf16 v[20:23], v[144:147], a[164:167], v[20:23]
ds_read_b64_tr_b16 v[142:143], v164 offset:11264
s_waitcnt lgkmcnt(8)
v_mfma_f32_16x16x32_bf16 v[24:27], v[112:115], a[160:163], v[24:27]
ds_read_b64_tr_b16 v[144:145], v165 offset:0
ds_read_b64_tr_b16 v[146:147], v165 offset:8192
v_mfma_f32_16x16x32_bf16 v[24:27], v[116:119], a[168:171], v[24:27]
buffer_load_dwordx4 v238, s[32:35], s54 offen offset:2048 lds
v_mfma_f32_16x16x32_bf16 v[24:27], v[120:123], a[176:179], v[24:27]
ds_read_b64_tr_b16 v[148:149], v165 offset:1024
v_mfma_f32_16x16x32_bf16 v[24:27], v[124:127], a[184:187], v[24:27]
ds_read_b64_tr_b16 v[150:151], v165 offset:9216
v_mfma_f32_16x16x32_bf16 v[28:31], v[124:127], a[188:191], v[28:31]
ds_read_b64_tr_b16 v[152:153], v165 offset:2048
ds_read_b64_tr_b16 v[154:155], v165 offset:10240
v_mfma_f32_16x16x32_bf16 v[28:31], v[120:123], a[180:183], v[28:31]
buffer_load_dwordx4 v238, s[32:35], s55 offen offset:3072 lds
v_mfma_f32_16x16x32_bf16 v[28:31], v[116:119], a[172:175], v[28:31]
ds_read_b64_tr_b16 v[156:157], v165 offset:3072
v_mfma_f32_16x16x32_bf16 v[28:31], v[112:115], a[164:167], v[28:31]
ds_read_b64_tr_b16 v[158:159], v165 offset:11264
s_waitcnt vmcnt(8) lgkmcnt(8)
v_mfma_f32_16x16x32_bf16 v[0:3], v[128:131], a[192:195], v[0:3]
ds_read_b64_tr_b16 v[112:113], v166 offset:0
v_mfma_f32_16x16x32_bf16 v[0:3], v[132:135], a[200:203], v[0:3]
ds_read_b64_tr_b16 v[114:115], v166 offset:8192
v_mfma_f32_16x16x32_bf16 v[0:3], v[136:139], a[208:211], v[0:3]
ds_read_b64_tr_b16 v[116:117], v166 offset:1024
s_lshl_b32 s82, s79, 7
v_mfma_f32_16x16x32_bf16 v[0:3], v[140:143], a[216:219], v[0:3]
ds_read_b64_tr_b16 v[118:119], v166 offset:9216
ds_read_b64_tr_b16 v[120:121], v166 offset:2048
s_add_u32 m0, s80, 114688
v_mfma_f32_16x16x32_bf16 v[4:7], v[140:143], a[220:223], v[4:7]
buffer_load_dwordx4 v232, s[32:35], s68 offen lds
v_mfma_f32_16x16x32_bf16 v[4:7], v[136:139], a[212:215], v[4:7]
ds_read_b64_tr_b16 v[122:123], v166 offset:10240
v_writelane_b32 v248, s82, 0
v_mfma_f32_16x16x32_bf16 v[4:7], v[132:135], a[204:207], v[4:7]
ds_read_b64_tr_b16 v[124:125], v166 offset:3072
v_mfma_f32_16x16x32_bf16 v[4:7], v[128:131], a[196:199], v[4:7]
ds_read_b64_tr_b16 v[126:127], v166 offset:11264
s_waitcnt lgkmcnt(8)
v_mfma_f32_16x16x32_bf16 v[8:11], v[144:147], a[192:195], v[8:11]
ds_read_b64_tr_b16 v[128:129], v167 offset:0
v_mfma_f32_16x16x32_bf16 v[8:11], v[148:151], a[200:203], v[8:11]
ds_read_b64_tr_b16 v[130:131], v167 offset:8192
v_mfma_f32_16x16x32_bf16 v[8:11], v[152:155], a[208:211], v[8:11]
ds_read_b64_tr_b16 v[132:133], v167 offset:1024
ds_read_b64_tr_b16 v[134:135], v167 offset:9216
v_mfma_f32_16x16x32_bf16 v[8:11], v[156:159], a[216:219], v[8:11]
buffer_load_dwordx4 v232, s[32:35], s69 offen offset:1024 lds
v_mfma_f32_16x16x32_bf16 v[12:15], v[156:159], a[220:223], v[12:15]
ds_read_b64_tr_b16 v[136:137], v167 offset:2048
v_mfma_f32_16x16x32_bf16 v[12:15], v[152:155], a[212:215], v[12:15]
ds_read_b64_tr_b16 v[138:139], v167 offset:10240
v_mfma_f32_16x16x32_bf16 v[12:15], v[148:151], a[204:207], v[12:15]
ds_read_b64_tr_b16 v[140:141], v167 offset:3072
v_mfma_f32_16x16x32_bf16 v[12:15], v[144:147], a[196:199], v[12:15]
ds_read_b64_tr_b16 v[142:143], v167 offset:11264
s_waitcnt lgkmcnt(8)
v_mfma_f32_16x16x32_bf16 v[16:19], v[112:115], a[192:195], v[16:19]
ds_read_b64_tr_b16 v[144:145], v160 offset:0
v_cvt_pk_bf16_f32 v172, v0, v1
v_mfma_f32_16x16x32_bf16 v[16:19], v[116:119], a[200:203], v[16:19]
ds_read_b64_tr_b16 v[146:147], v160 offset:8192
v_cvt_pk_bf16_f32 v173, v2, v3
v_mfma_f32_16x16x32_bf16 v[16:19], v[120:123], a[208:211], v[16:19]
ds_read_b64_tr_b16 v[148:149], v160 offset:1024
ds_read_b64_tr_b16 v[150:151], v160 offset:9216
v_mfma_f32_16x16x32_bf16 v[16:19], v[124:127], a[216:219], v[16:19]
buffer_load_dwordx4 v232, s[32:35], s70 offen offset:2048 lds
v_cvt_pk_bf16_f32 v174, v8, v9
v_mfma_f32_16x16x32_bf16 v[20:23], v[124:127], a[220:223], v[20:23]
ds_read_b64_tr_b16 v[152:153], v160 offset:2048
v_cvt_pk_bf16_f32 v175, v10, v11
v_mfma_f32_16x16x32_bf16 v[20:23], v[120:123], a[212:215], v[20:23]
ds_read_b64_tr_b16 v[154:155], v160 offset:10240
v_cvt_pk_bf16_f32 v176, v4, v5
v_mfma_f32_16x16x32_bf16 v[20:23], v[116:119], a[204:207], v[20:23]
ds_read_b64_tr_b16 v[156:157], v160 offset:3072
v_cvt_pk_bf16_f32 v177, v6, v7
v_mfma_f32_16x16x32_bf16 v[20:23], v[112:115], a[196:199], v[20:23]
ds_read_b64_tr_b16 v[158:159], v160 offset:11264
v_cvt_pk_bf16_f32 v178, v12, v13
s_waitcnt lgkmcnt(8)
v_mfma_f32_16x16x32_bf16 v[24:27], v[128:131], a[192:195], v[24:27]
ds_read_b64_tr_b16 v[112:113], v161 offset:0
ds_read_b64_tr_b16 v[114:115], v161 offset:8192
v_cvt_pk_bf16_f32 v179, v14, v15
v_mfma_f32_16x16x32_bf16 v[24:27], v[132:135], a[200:203], v[24:27]
buffer_store_dwordx4 v[172:175], v251, s[40:43], s12 offen offset:0 sc1
v_mfma_f32_16x16x32_bf16 v[24:27], v[136:139], a[208:211], v[24:27]
ds_read_b64_tr_b16 v[116:117], v161 offset:1024
v_mfma_f32_16x16x32_bf16 v[24:27], v[140:143], a[216:219], v[24:27]
ds_read_b64_tr_b16 v[118:119], v161 offset:9216
v_mfma_f32_16x16x32_bf16 v[28:31], v[140:143], a[220:223], v[28:31]
ds_read_b64_tr_b16 v[120:121], v161 offset:2048
ds_read_b64_tr_b16 v[122:123], v161 offset:10240
v_mfma_f32_16x16x32_bf16 v[28:31], v[136:139], a[212:215], v[28:31]
buffer_store_dwordx4 v[176:179], v251, s[40:43], s12 offen offset:128 sc1
v_mfma_f32_16x16x32_bf16 v[28:31], v[132:135], a[204:207], v[28:31]
ds_read_b64_tr_b16 v[124:125], v161 offset:3072
v_mfma_f32_16x16x32_bf16 v[28:31], v[128:131], a[196:199], v[28:31]
ds_read_b64_tr_b16 v[126:127], v161 offset:11264
s_waitcnt lgkmcnt(8)
v_mfma_f32_16x16x32_bf16 v[32:35], v[144:147], a[128:131], v[32:35]
ds_read_b64_tr_b16 v[128:129], v162 offset:0
ds_read_b64_tr_b16 v[130:131], v162 offset:8192
v_mfma_f32_16x16x32_bf16 v[32:35], v[148:151], a[136:139], v[32:35]
buffer_load_dwordx4 v232, s[32:35], s71 offen offset:3072 lds
v_mfma_f32_16x16x32_bf16 v[32:35], v[152:155], a[144:147], v[32:35]
ds_read_b64_tr_b16 v[132:133], v162 offset:1024
v_cvt_pk_bf16_f32 v180, v16, v17
v_cvt_pk_bf16_f32 v181, v18, v19
v_mfma_f32_16x16x32_bf16 v[32:35], v[156:159], a[152:155], v[32:35]
ds_read_b64_tr_b16 v[134:135], v162 offset:9216
v_cvt_pk_bf16_f32 v182, v24, v25
v_mfma_f32_16x16x32_bf16 v[36:39], v[156:159], a[156:159], v[36:39]
ds_read_b64_tr_b16 v[136:137], v162 offset:2048
v_cvt_pk_bf16_f32 v183, v26, v27
v_mfma_f32_16x16x32_bf16 v[36:39], v[152:155], a[148:151], v[36:39]
ds_read_b64_tr_b16 v[138:139], v162 offset:10240
ds_read_b64_tr_b16 v[140:141], v162 offset:3072
v_mfma_f32_16x16x32_bf16 v[36:39], v[148:151], a[140:143], v[36:39]
buffer_store_dwordx4 v[180:183], v247, s[40:43], s12 offen offset:0 sc1
v_cvt_pk_bf16_f32 v184, v20, v21
v_mfma_f32_16x16x32_bf16 v[36:39], v[144:147], a[132:135], v[36:39]
ds_read_b64_tr_b16 v[142:143], v162 offset:11264
v_cvt_pk_bf16_f32 v185, v22, v23
s_waitcnt lgkmcnt(8)
v_mfma_f32_16x16x32_bf16 v[40:43], v[112:115], a[128:131], v[40:43]
ds_read_b64_tr_b16 v[144:145], v163 offset:0
v_cvt_pk_bf16_f32 v186, v28, v29
v_cvt_pk_bf16_f32 v187, v30, v31
v_mfma_f32_16x16x32_bf16 v[40:43], v[116:119], a[136:139], v[40:43]
ds_read_b64_tr_b16 v[146:147], v163 offset:8192
ds_read_b64_tr_b16 v[148:149], v163 offset:1024
s_add_u32 m0, s80, 16384
v_mfma_f32_16x16x32_bf16 v[40:43], v[120:123], a[144:147], v[40:43]
buffer_load_dwordx4 v232, s[32:35], s72 offen lds
v_mfma_f32_16x16x32_bf16 v[40:43], v[124:127], a[152:155], v[40:43]
ds_read_b64_tr_b16 v[150:151], v163 offset:9216
v_mfma_f32_16x16x32_bf16 v[44:47], v[124:127], a[156:159], v[44:47]
ds_read_b64_tr_b16 v[152:153], v163 offset:2048
ds_read_b64_tr_b16 v[154:155], v163 offset:10240
v_mfma_f32_16x16x32_bf16 v[44:47], v[120:123], a[148:151], v[44:47]
buffer_store_dwordx4 v[184:187], v247, s[40:43], s12 offen offset:128 sc1
v_mfma_f32_16x16x32_bf16 v[44:47], v[116:119], a[140:143], v[44:47]
ds_read_b64_tr_b16 v[156:157], v163 offset:3072
ds_read_b64_tr_b16 v[158:159], v163 offset:11264
v_mfma_f32_16x16x32_bf16 v[44:47], v[112:115], a[132:135], v[44:47]
s_add_u32 s12, s12, 8192
s_waitcnt vmcnt(9) lgkmcnt(8)
s_barrier
v_mfma_f32_16x16x32_bf16 v[48:51], v[128:131], a[128:131], v[48:51]
ds_read_b64_tr_b16 v[112:113], v164 offset:16384
ds_read_b64_tr_b16 v[114:115], v164 offset:24576
v_mfma_f32_16x16x32_bf16 v[48:51], v[132:135], a[136:139], v[48:51]
buffer_load_dwordx4 v232, s[32:35], s73 offen offset:1024 lds
v_mfma_f32_16x16x32_bf16 v[48:51], v[136:139], a[144:147], v[48:51]
ds_read_b64_tr_b16 v[116:117], v164 offset:17408
v_lshlrev_b32 v0, 16, v220
v_mfma_f32_16x16x32_bf16 v[48:51], v[140:143], a[152:155], v[48:51]
ds_read_b64_tr_b16 v[118:119], v164 offset:25600
v_and_b32 v1, 0xffff0000, v220
v_mfma_f32_16x16x32_bf16 v[52:55], v[140:143], a[156:159], v[52:55]
ds_read_b64_tr_b16 v[120:121], v164 offset:18432
v_lshlrev_b32 v2, 16, v221
v_mfma_f32_16x16x32_bf16 v[52:55], v[136:139], a[148:151], v[52:55]
ds_read_b64_tr_b16 v[122:123], v164 offset:26624
ds_read_b64_tr_b16 v[124:125], v164 offset:19456
v_mfma_f32_16x16x32_bf16 v[52:55], v[132:135], a[140:143], v[52:55]
buffer_load_dwordx4 v232, s[32:35], s74 offen offset:2048 lds
v_mfma_f32_16x16x32_bf16 v[52:55], v[128:131], a[132:135], v[52:55]
ds_read_b64_tr_b16 v[126:127], v164 offset:27648
s_waitcnt lgkmcnt(8)
v_mfma_f32_16x16x32_bf16 v[56:59], v[144:147], a[128:131], v[56:59]
ds_read_b64_tr_b16 v[128:129], v165 offset:16384
v_and_b32 v3, 0xffff0000, v221
v_mfma_f32_16x16x32_bf16 v[56:59], v[148:151], a[136:139], v[56:59]
ds_read_b64_tr_b16 v[130:131], v165 offset:24576
v_lshlrev_b32 v4, 16, v220
v_mfma_f32_16x16x32_bf16 v[56:59], v[152:155], a[144:147], v[56:59]
ds_read_b64_tr_b16 v[132:133], v165 offset:17408
v_and_b32 v5, 0xffff0000, v220
v_mfma_f32_16x16x32_bf16 v[56:59], v[156:159], a[152:155], v[56:59]
ds_read_b64_tr_b16 v[134:135], v165 offset:25600
v_lshlrev_b32 v6, 16, v221
v_mfma_f32_16x16x32_bf16 v[60:63], v[156:159], a[156:159], v[60:63]
ds_read_b64_tr_b16 v[136:137], v165 offset:18432
ds_read_b64_tr_b16 v[138:139], v165 offset:26624
v_mfma_f32_16x16x32_bf16 v[60:63], v[152:155], a[148:151], v[60:63]
buffer_load_dwordx4 v232, s[32:35], s75 offen offset:3072 lds
v_mfma_f32_16x16x32_bf16 v[60:63], v[148:151], a[140:143], v[60:63]
ds_read_b64_tr_b16 v[140:141], v165 offset:19456
v_and_b32 v7, 0xffff0000, v221
v_mfma_f32_16x16x32_bf16 v[60:63], v[144:147], a[132:135], v[60:63]
ds_read_b64_tr_b16 v[142:143], v165 offset:27648
s_waitcnt lgkmcnt(8)
v_mfma_f32_16x16x32_bf16 v[32:35], v[112:115], a[160:163], v[32:35]
ds_read_b64_tr_b16 v[144:145], v166 offset:16384
v_lshlrev_b32 v8, 16, v222
v_mfma_f32_16x16x32_bf16 v[32:35], v[116:119], a[168:171], v[32:35]
ds_read_b64_tr_b16 v[146:147], v166 offset:24576
v_and_b32 v9, 0xffff0000, v222
v_mfma_f32_16x16x32_bf16 v[32:35], v[120:123], a[176:179], v[32:35]
ds_read_b64_tr_b16 v[148:149], v166 offset:17408
v_lshlrev_b32 v10, 16, v223
v_mfma_f32_16x16x32_bf16 v[32:35], v[124:127], a[184:187], v[32:35]
ds_read_b64_tr_b16 v[150:151], v166 offset:25600
ds_read_b64_tr_b16 v[152:153], v166 offset:18432
s_add_u32 m0, s80, 32768
v_mfma_f32_16x16x32_bf16 v[36:39], v[124:127], a[188:191], v[36:39]
buffer_load_dwordx4 v232, s[32:35], s44 offen lds
v_mfma_f32_16x16x32_bf16 v[36:39], v[120:123], a[180:183], v[36:39]
L_pad8:
s_cbranch_execz L_warm2
ds_read_b64_tr_b16 v[154:155], v166 offset:26624
v_and_b32 v11, 0xffff0000, v223
v_mfma_f32_16x16x32_bf16 v[36:39], v[116:119], a[172:175], v[36:39]
ds_read_b64_tr_b16 v[156:157], v166 offset:19456
v_lshlrev_b32 v12, 16, v222
v_mfma_f32_16x16x32_bf16 v[36:39], v[112:115], a[164:167], v[36:39]
ds_read_b64_tr_b16 v[158:159], v166 offset:27648
s_waitcnt lgkmcnt(8)
v_mfma_f32_16x16x32_bf16 v[40:43], v[128:131], a[160:163], v[40:43]
ds_read_b64_tr_b16 v[112:113], v167 offset:16384
v_and_b32 v13, 0xffff0000, v222
v_mfma_f32_16x16x32_bf16 v[40:43], v[132:135], a[168:171], v[40:43]
ds_read_b64_tr_b16 v[114:115], v167 offset:24576
v_mfma_f32_16x16x32_bf16 v[40:43], v[136:139], a[176:179], v[40:43]
ds_read_b64_tr_b16 v[116:117], v167 offset:17408
v_lshlrev_b32 v14, 16, v223
v_mfma_f32_16x16x32_bf16 v[40:43], v[140:143], a[184:187], v[40:43]
ds_read_b64_tr_b16 v[118:119], v167 offset:25600
ds_read_b64_tr_b16 v[120:121], v167 offset:18432
v_mfma_f32_16x16x32_bf16 v[44:47], v[140:143], a[188:191], v[44:47]
buffer_load_dwordx4 v232, s[32:35], s45 offen offset:1024 lds
v_mfma_f32_16x16x32_bf16 v[44:47], v[136:139], a[180:183], v[44:47]
ds_read_b64_tr_b16 v[122:123], v167 offset:26624
v_and_b32 v15, 0xffff0000, v223
v_mfma_f32_16x16x32_bf16 v[44:47], v[132:135], a[172:175], v[44:47]
ds_read_b64_tr_b16 v[124:125], v167 offset:19456
v_lshlrev_b32 v16, 16, v224
v_mfma_f32_16x16x32_bf16 v[44:47], v[128:131], a[164:167], v[44:47]
ds_read_b64_tr_b16 v[126:127], v167 offset:27648
s_waitcnt lgkmcnt(8)
v_mfma_f32_16x16x32_bf16 v[48:51], v[144:147], a[160:163], v[48:51]
ds_read_b64_tr_b16 v[128:129], v164 offset:32768
v_and_b32 v17, 0xffff0000, v224
v_mfma_f32_16x16x32_bf16 v[48:51], v[148:151], a[168:171], v[48:51]
ds_read_b64_tr_b16 v[130:131], v164 offset:40960
v_mfma_f32_16x16x32_bf16 v[48:51], v[152:155], a[176:179], v[48:51]
ds_read_b64_tr_b16 v[132:133], v164 offset:33792
v_lshlrev_b32 v18, 16, v225
v_mfma_f32_16x16x32_bf16 v[48:51], v[156:159], a[184:187], v[48:51]
ds_read_b64_tr_b16 v[134:135], v164 offset:41984
ds_read_b64_tr_b16 v[136:137], v164 offset:34816
v_mfma_f32_16x16x32_bf16 v[52:55], v[156:159], a[188:191], v[52:55]
buffer_load_dwordx4 v232, s[32:35], s46 offen offset:2048 lds
v_mfma_f32_16x16x32_bf16 v[52:55], v[152:155], a[180:183], v[52:55]
ds_read_b64_tr_b16 v[138:139], v164 offset:43008
v_and_b32 v19, 0xffff0000, v225
v_mfma_f32_16x16x32_bf16 v[52:55], v[148:151], a[172:175], v[52:55]
ds_read_b64_tr_b16 v[140:141], v164 offset:35840
v_lshlrev_b32 v20, 16, v224
v_mfma_f32_16x16x32_bf16 v[52:55], v[144:147], a[164:167], v[52:55]
ds_read_b64_tr_b16 v[142:143], v164 offset:44032
s_waitcnt lgkmcnt(8)
v_mfma_f32_16x16x32_bf16 v[56:59], v[112:115], a[160:163], v[56:59]
ds_read_b64_tr_b16 v[144:145], v165 offset:32768
v_and_b32 v21, 0xffff0000, v224
v_mfma_f32_16x16x32_bf16 v[56:59], v[116:119], a[168:171], v[56:59]
ds_read_b64_tr_b16 v[146:147], v165 offset:40960
v_mfma_f32_16x16x32_bf16 v[56:59], v[120:123], a[176:179], v[56:59]
ds_read_b64_tr_b16 v[148:149], v165 offset:33792
v_lshlrev_b32 v22, 16, v225
v_mfma_f32_16x16x32_bf16 v[56:59], v[124:127], a[184:187], v[56:59]
ds_read_b64_tr_b16 v[150:151], v165 offset:41984
ds_read_b64_tr_b16 v[152:153], v165 offset:34816
v_mfma_f32_16x16x32_bf16 v[60:63], v[124:127], a[188:191], v[60:63]
buffer_load_dwordx4 v232, s[32:35], s47 offen offset:3072 lds
v_mfma_f32_16x16x32_bf16 v[60:63], v[120:123], a[180:183], v[60:63]
ds_read_b64_tr_b16 v[154:155], v165 offset:43008
v_add_u32 v244, 1, v242
s_waitcnt vmcnt(7)
buffer_store_dword v244, v248, s[40:43], s86 offen offset:1536 sc1
v_mfma_f32_16x16x32_bf16 v[60:63], v[116:119], a[172:175], v[60:63]
ds_read_b64_tr_b16 v[156:157], v165 offset:35840
v_and_b32 v23, 0xffff0000, v225
v_mfma_f32_16x16x32_bf16 v[60:63], v[112:115], a[164:167], v[60:63]
ds_read_b64_tr_b16 v[158:159], v165 offset:44032
s_waitcnt lgkmcnt(8)
v_mfma_f32_16x16x32_bf16 v[32:35], v[128:131], a[192:195], v[32:35]
ds_read_b64_tr_b16 v[112:113], v166 offset:32768
v_lshlrev_b32 v24, 16, v226
v_mfma_f32_16x16x32_bf16 v[32:35], v[132:135], a[200:203], v[32:35]
ds_read_b64_tr_b16 v[114:115], v166 offset:40960
v_and_b32 v25, 0xffff0000, v226
v_mfma_f32_16x16x32_bf16 v[32:35], v[136:139], a[208:211], v[32:35]
ds_read_b64_tr_b16 v[116:117], v166 offset:33792
ds_read_b64_tr_b16 v[118:119], v166 offset:41984
s_add_u32 m0, s80, 49152
v_mfma_f32_16x16x32_bf16 v[32:35], v[140:143], a[216:219], v[32:35]
buffer_load_dwordx4 v232, s[32:35], s48 offen lds
v_mfma_f32_16x16x32_bf16 v[36:39], v[140:143], a[220:223], v[36:39]
ds_read_b64_tr_b16 v[120:121], v166 offset:34816
v_lshlrev_b32 v26, 16, v227
v_mfma_f32_16x16x32_bf16 v[36:39], v[136:139], a[212:215], v[36:39]
ds_read_b64_tr_b16 v[122:123], v166 offset:43008
v_and_b32 v27, 0xffff0000, v227
v_mfma_f32_16x16x32_bf16 v[36:39], v[132:135], a[204:207], v[36:39]
ds_read_b64_tr_b16 v[124:125], v166 offset:35840
v_lshlrev_b32 v28, 16, v226
v_mfma_f32_16x16x32_bf16 v[36:39], v[128:131], a[196:199], v[36:39]
ds_read_b64_tr_b16 v[126:127], v166 offset:44032
s_waitcnt lgkmcnt(8)
v_mfma_f32_16x16x32_bf16 v[40:43], v[144:147], a[192:195], v[40:43]
ds_read_b64_tr_b16 v[128:129], v167 offset:32768
v_and_b32 v29, 0xffff0000, v226
v_mfma_f32_16x16x32_bf16 v[40:43], v[148:151], a[200:203], v[40:43]
ds_read_b64_tr_b16 v[130:131], v167 offset:40960
v_mfma_f32_16x16x32_bf16 v[40:43], v[152:155], a[208:211], v[40:43]
ds_read_b64_tr_b16 v[132:133], v167 offset:33792
ds_read_b64_tr_b16 v[134:135], v167 offset:41984
v_mfma_f32_16x16x32_bf16 v[40:43], v[156:159], a[216:219], v[40:43]
buffer_load_dwordx4 v232, s[32:35], s49 offen offset:1024 lds
v_mfma_f32_16x16x32_bf16 v[44:47], v[156:159], a[220:223], v[44:47]
ds_read_b64_tr_b16 v[136:137], v167 offset:34816
v_lshlrev_b32 v30, 16, v227
v_mfma_f32_16x16x32_bf16 v[44:47], v[152:155], a[212:215], v[44:47]
ds_read_b64_tr_b16 v[138:139], v167 offset:43008
v_and_b32 v31, 0xffff0000, v227
v_mfma_f32_16x16x32_bf16 v[44:47], v[148:151], a[204:207], v[44:47]
ds_read_b64_tr_b16 v[140:141], v167 offset:35840
ds_read_b64_tr_b16 v[142:143], v167 offset:44032
v_mfma_f32_16x16x32_bf16 v[44:47], v[144:147], a[196:199], v[44:47]
s_waitcnt vmcnt(7) lgkmcnt(8)
s_barrier
v_mfma_f32_16x16x32_bf16 v[48:51], v[112:115], a[192:195], v[48:51]
ds_read_b64_tr_b16 v[144:145], v164 offset:49152
v_cvt_pk_bf16_f32 v172, v32, v33
v_mfma_f32_16x16x32_bf16 v[48:51], v[116:119], a[200:203], v[48:51]
ds_read_b64_tr_b16 v[146:147], v164 offset:57344
v_cvt_pk_bf16_f32 v173, v34, v35
v_mfma_f32_16x16x32_bf16 v[48:51], v[120:123], a[208:211], v[48:51]
ds_read_b64_tr_b16 v[148:149], v164 offset:50176
ds_read_b64_tr_b16 v[150:151], v164 offset:58368
v_mfma_f32_16x16x32_bf16 v[48:51], v[124:127], a[216:219], v[48:51]
buffer_load_dwordx4 v232, s[32:35], s50 offen offset:2048 lds
v_cvt_pk_bf16_f32 v174, v40, v41
v_mfma_f32_16x16x32_bf16 v[52:55], v[124:127], a[220:223], v[52:55]
ds_read_b64_tr_b16 v[152:153], v164 offset:51200
v_cvt_pk_bf16_f32 v175, v42, v43
v_mfma_f32_16x16x32_bf16 v[52:55], v[120:123], a[212:215], v[52:55]
ds_read_b64_tr_b16 v[154:155], v164 offset:59392
v_cvt_pk_bf16_f32 v176, v36, v37
v_mfma_f32_16x16x32_bf16 v[52:55], v[116:119], a[204:207], v[52:55]
ds_read_b64_tr_b16 v[156:157], v164 offset:52224
v_cvt_pk_bf16_f32 v177, v38, v39
v_mfma_f32_16x16x32_bf16 v[52:55], v[112:115], a[196:199], v[52:55]
ds_read_b64_tr_b16 v[158:159], v164 offset:60416
v_cvt_pk_bf16_f32 v178, v44, v45
s_waitcnt lgkmcnt(8)
v_mfma_f32_16x16x32_bf16 v[56:59], v[128:131], a[192:195], v[56:59]
ds_read_b64_tr_b16 v[112:113], v165 offset:49152
ds_read_b64_tr_b16 v[114:115], v165 offset:57344
v_cvt_pk_bf16_f32 v179, v46, v47
v_mfma_f32_16x16x32_bf16 v[56:59], v[132:135], a[200:203], v[56:59]
buffer_store_dwordx4 v[172:175], v251, s[40:43], s12 offen offset:0 sc1
v_mfma_f32_16x16x32_bf16 v[56:59], v[136:139], a[208:211], v[56:59]
ds_read_b64_tr_b16 v[116:117], v165 offset:50176
s_xor_b32 s82, s79, 8
v_mfma_f32_16x16x32_bf16 v[56:59], v[140:143], a[216:219], v[56:59]
ds_read_b64_tr_b16 v[118:119], v165 offset:58368
s_lshl_b32 s83, s82, 7
v_mfma_f32_16x16x32_bf16 v[60:63], v[140:143], a[220:223], v[60:63]
ds_read_b64_tr_b16 v[120:121], v165 offset:51200
ds_read_b64_tr_b16 v[122:123], v165 offset:59392
v_mfma_f32_16x16x32_bf16 v[60:63], v[136:139], a[212:215], v[60:63]
buffer_store_dwordx4 v[176:179], v251, s[40:43], s12 offen offset:128 sc1
v_mfma_f32_16x16x32_bf16 v[60:63], v[132:135], a[204:207], v[60:63]
ds_read_b64_tr_b16 v[124:125], v165 offset:52224
v_mov_b32 v245, s83
v_mfma_f32_16x16x32_bf16 v[60:63], v[128:131], a[196:199], v[60:63]
ds_read_b64_tr_b16 v[126:127], v165 offset:60416
s_waitcnt lgkmcnt(8)
v_mfma_f32_16x16x32_bf16 v[64:67], v[144:147], a[64:67], v[64:67]
ds_read_b64_tr_b16 v[128:129], v166 offset:49152
ds_read_b64_tr_b16 v[130:131], v166 offset:57344
s_xor_b32 s13, s90, 1048576
v_mfma_f32_16x16x32_bf16 v[64:67], v[148:151], a[72:75], v[64:67]
buffer_load_dwordx4 v232, s[32:35], s51 offen offset:3072 lds
v_mfma_f32_16x16x32_bf16 v[64:67], v[152:155], a[80:83], v[64:67]
ds_read_b64_tr_b16 v[132:133], v166 offset:50176
s_add_u32 s13, s13, 35651584
v_cvt_pk_bf16_f32 v180, v48, v49
v_mfma_f32_16x16x32_bf16 v[64:67], v[156:159], a[88:91], v[64:67]
ds_read_b64_tr_b16 v[134:135], v166 offset:58368
v_cvt_pk_bf16_f32 v181, v50, v51
v_cvt_pk_bf16_f32 v182, v56, v57
v_mfma_f32_16x16x32_bf16 v[68:71], v[156:159], a[92:95], v[68:71]
ds_read_b64_tr_b16 v[136:137], v166 offset:51200
ds_read_b64_tr_b16 v[138:139], v166 offset:59392
s_add_u32 m0, s80, 65536
v_cvt_pk_bf16_f32 v183, v58, v59
v_mfma_f32_16x16x32_bf16 v[68:71], v[152:155], a[84:87], v[68:71]
buffer_load_dwordx4 v232, s[32:35], s52 offen lds
buffer_load_dword v243, v245, s[40:43], s86 offen offset:1536 sc1
v_mfma_f32_16x16x32_bf16 v[68:71], v[148:151], a[76:79], v[68:71]
ds_read_b64_tr_b16 v[140:141], v166 offset:52224
v_cvt_pk_bf16_f32 v184, v52, v53
v_cvt_pk_bf16_f32 v185, v54, v55
v_mfma_f32_16x16x32_bf16 v[68:71], v[144:147], a[68:71], v[68:71]
ds_read_b64_tr_b16 v[142:143], v166 offset:60416
v_cvt_pk_bf16_f32 v186, v60, v61
s_waitcnt lgkmcnt(8)
v_mfma_f32_16x16x32_bf16 v[72:75], v[112:115], a[64:67], v[72:75]
ds_read_b64_tr_b16 v[144:145], v167 offset:49152
ds_read_b64_tr_b16 v[146:147], v167 offset:57344
v_cvt_pk_bf16_f32 v187, v62, v63
v_mfma_f32_16x16x32_bf16 v[72:75], v[116:119], a[72:75], v[72:75]
buffer_store_dwordx4 v[180:183], v247, s[40:43], s12 offen offset:0 sc1
v_mfma_f32_16x16x32_bf16 v[72:75], v[120:123], a[80:83], v[72:75]
ds_read_b64_tr_b16 v[148:149], v167 offset:50176
v_mfma_f32_16x16x32_bf16 v[72:75], v[124:127], a[88:91], v[72:75]
ds_read_b64_tr_b16 v[150:151], v167 offset:58368
v_mfma_f32_16x16x32_bf16 v[76:79], v[124:127], a[92:95], v[76:79]
ds_read_b64_tr_b16 v[152:153], v167 offset:51200
ds_read_b64_tr_b16 v[154:155], v167 offset:59392
v_mfma_f32_16x16x32_bf16 v[76:79], v[120:123], a[84:87], v[76:79]
buffer_store_dwordx4 v[184:187], v247, s[40:43], s12 offen offset:128 sc1
v_mfma_f32_16x16x32_bf16 v[76:79], v[116:119], a[76:79], v[76:79]
ds_read_b64_tr_b16 v[156:157], v167 offset:52224
s_add_u32 s12, s12, 8192
v_mfma_f32_16x16x32_bf16 v[76:79], v[112:115], a[68:71], v[76:79]
ds_read_b64_tr_b16 v[158:159], v167 offset:60416
s_waitcnt lgkmcnt(8)
v_mfma_f32_16x16x32_bf16 v[80:83], v[128:131], a[64:67], v[80:83]
ds_read_b64_tr_b16 v[112:113], v160 offset:16384
ds_read_b64_tr_b16 v[114:115], v160 offset:24576
v_mfma_f32_16x16x32_bf16 v[80:83], v[132:135], a[72:75], v[80:83]
buffer_load_dwordx4 v232, s[32:35], s53 offen offset:1024 lds
v_mfma_f32_16x16x32_bf16 v[80:83], v[136:139], a[80:83], v[80:83]
ds_read_b64_tr_b16 v[116:117], v160 offset:17408
v_lshrrev_b32 v32, 4, v239
v_mfma_f32_16x16x32_bf16 v[80:83], v[140:143], a[88:91], v[80:83]
ds_read_b64_tr_b16 v[118:119], v160 offset:25600
v_mfma_f32_16x16x32_bf16 v[84:87], v[140:143], a[92:95], v[84:87]
ds_read_b64_tr_b16 v[120:121], v160 offset:18432
v_lshrrev_b32 v33, 4, v32
v_mfma_f32_16x16x32_bf16 v[84:87], v[136:139], a[84:87], v[84:87]
ds_read_b64_tr_b16 v[122:123], v160 offset:26624
v_mfma_f32_16x16x32_bf16 v[84:87], v[132:135], a[76:79], v[84:87]
ds_read_b64_tr_b16 v[124:125], v160 offset:19456
v_bfe_u32 v36, v32, 2, 2
v_mfma_f32_16x16x32_bf16 v[84:87], v[128:131], a[68:71], v[84:87]
ds_read_b64_tr_b16 v[126:127], v160 offset:27648
s_waitcnt lgkmcnt(8)
v_mfma_f32_16x16x32_bf16 v[88:91], v[144:147], a[64:67], v[88:91]
ds_read_b64_tr_b16 v[128:129], v161 offset:16384
ds_read_b64_tr_b16 v[130:131], v161 offset:24576
v_mfma_f32_16x16x32_bf16 v[88:91], v[148:151], a[72:75], v[88:91]
buffer_load_dwordx4 v232, s[32:35], s54 offen offset:2048 lds
v_mfma_f32_16x16x32_bf16 v[88:91], v[152:155], a[80:83], v[88:91]
ds_read_b64_tr_b16 v[132:133], v161 offset:17408
v_and_b32 v37, 1, v32
v_mfma_f32_16x16x32_bf16 v[88:91], v[156:159], a[88:91], v[88:91]
ds_read_b64_tr_b16 v[134:135], v161 offset:25600
v_lshlrev_b32 v37, 4, v37
v_mfma_f32_16x16x32_bf16 v[92:95], v[156:159], a[92:95], v[92:95]
ds_read_b64_tr_b16 v[136:137], v161 offset:18432
v_mov_b32 v34, 0x3f80
v_mfma_f32_16x16x32_bf16 v[92:95], v[152:155], a[84:87], v[92:95]
ds_read_b64_tr_b16 v[138:139], v161 offset:26624
v_mfma_f32_16x16x32_bf16 v[92:95], v[148:151], a[76:79], v[92:95]
ds_read_b64_tr_b16 v[140:141], v161 offset:19456
v_lshlrev_b32 v34, v37, v34
v_mfma_f32_16x16x32_bf16 v[92:95], v[144:147], a[68:71], v[92:95]
ds_read_b64_tr_b16 v[142:143], v161 offset:27648
s_waitcnt lgkmcnt(8)
v_mfma_f32_16x16x32_bf16 v[64:67], v[112:115], a[96:99], v[64:67]
ds_read_b64_tr_b16 v[144:145], v162 offset:16384
ds_read_b64_tr_b16 v[146:147], v162 offset:24576
v_mfma_f32_16x16x32_bf16 v[64:67], v[116:119], a[104:107], v[64:67]
buffer_load_dwordx4 v232, s[32:35], s55 offen offset:3072 lds
v_mfma_f32_16x16x32_bf16 v[64:67], v[120:123], a[112:115], v[64:67]
ds_read_b64_tr_b16 v[148:149], v162 offset:17408
v_cmp_eq_u32 vcc, v33, v36
v_and_b32 v32, 2, v32
v_mov_b32 v36, 0
v_cndmask_b32 v34, 0, v34, vcc
v_mfma_f32_16x16x32_bf16 v[64:67], v[124:127], a[120:123], v[64:67]
ds_read_b64_tr_b16 v[150:151], v162 offset:25600
v_cmp_eq_u32 vcc, 0, v32
v_mov_b32 v37, 0
v_mov_b32 v33, 0
v_cndmask_b32 v35, v34, v33, vcc
v_cndmask_b32 v34, 0, v34, vcc
v_mfma_f32_16x16x32_bf16 v[68:71], v[124:127], a[124:127], v[68:71]
ds_read_b64_tr_b16 v[152:153], v162 offset:18432
v_mov_b32 v32, 0
v_mfma_f32_16x16x32_bf16 v[68:71], v[120:123], a[116:119], v[68:71]
ds_read_b64_tr_b16 v[154:155], v162 offset:26624
ds_read_b64_tr_b16 v[156:157], v162 offset:19456
s_add_u32 m0, s80, 0
v_mfma_f32_16x16x32_bf16 v[68:71], v[116:119], a[108:111], v[68:71]
buffer_load_dwordx4 v233, s[32:35], s60 offen lds
v_mfma_f32_16x16x32_bf16 v[68:71], v[112:115], a[100:103], v[68:71]
ds_read_b64_tr_b16 v[158:159], v162 offset:27648
s_waitcnt lgkmcnt(8)
v_mfma_f32_16x16x32_bf16 v[72:75], v[128:131], a[96:99], v[72:75]
ds_read_b64_tr_b16 v[112:113], v163 offset:16384
v_mfma_f32_16x16x32_bf16 v[72:75], v[132:135], a[104:107], v[72:75]
ds_read_b64_tr_b16 v[114:115], v163 offset:24576
v_mfma_f32_16x16x32_bf16 v[72:75], v[136:139], a[112:115], v[72:75]
ds_read_b64_tr_b16 v[116:117], v163 offset:17408
v_mfma_f32_16x16x32_bf16 v[72:75], v[140:143], a[120:123], v[72:75]
ds_read_b64_tr_b16 v[118:119], v163 offset:25600
v_mfma_f32_16x16x32_bf16 v[76:79], v[140:143], a[124:127], v[76:79]
ds_read_b64_tr_b16 v[120:121], v163 offset:18432
ds_read_b64_tr_b16 v[122:123], v163 offset:26624
v_mfma_f32_16x16x32_bf16 v[76:79], v[136:139], a[116:119], v[76:79]
buffer_load_dwordx4 v233, s[32:35], s61 offen offset:1024 lds
v_mfma_f32_16x16x32_bf16 v[76:79], v[132:135], a[108:111], v[76:79]
ds_read_b64_tr_b16 v[124:125], v163 offset:19456
ds_read_b64_tr_b16 v[126:127], v163 offset:27648
v_mfma_f32_16x16x32_bf16 v[76:79], v[128:131], a[100:103], v[76:79]
s_waitcnt vmcnt(9) lgkmcnt(8)
s_barrier
v_mfma_f32_16x16x32_bf16 v[80:83], v[144:147], a[96:99], v[80:83]
ds_read_b64_tr_b16 v[128:129], v160 offset:32768
v_mfma_f32_16x16x32_bf16 v[80:83], v[148:151], a[104:107], v[80:83]
ds_read_b64_tr_b16 v[130:131], v160 offset:40960
v_mfma_f32_16x16x32_bf16 v[80:83], v[152:155], a[112:115], v[80:83]
ds_read_b64_tr_b16 v[132:133], v160 offset:33792
v_mfma_f32_16x16x32_bf16 v[80:83], v[156:159], a[120:123], v[80:83]
ds_read_b64_tr_b16 v[134:135], v160 offset:41984
v_mfma_f32_16x16x32_bf16 v[84:87], v[156:159], a[124:127], v[84:87]
ds_read_b64_tr_b16 v[136:137], v160 offset:34816
ds_read_b64_tr_b16 v[138:139], v160 offset:43008
v_mfma_f32_16x16x32_bf16 v[84:87], v[152:155], a[116:119], v[84:87]
buffer_load_dwordx4 v233, s[32:35], s62 offen offset:2048 lds
v_mfma_f32_16x16x32_bf16 v[84:87], v[148:151], a[108:111], v[84:87]
ds_read_b64_tr_b16 v[140:141], v160 offset:35840
v_mfma_f32_16x16x32_bf16 v[84:87], v[144:147], a[100:103], v[84:87]
ds_read_b64_tr_b16 v[142:143], v160 offset:44032
s_waitcnt lgkmcnt(8)
v_mfma_f32_16x16x32_bf16 v[88:91], v[112:115], a[96:99], v[88:91]
ds_read_b64_tr_b16 v[144:145], v161 offset:32768
v_mfma_f32_16x16x32_bf16 v[88:91], v[116:119], a[104:107], v[88:91]
ds_read_b64_tr_b16 v[146:147], v161 offset:40960
v_mfma_f32_16x16x32_bf16 v[88:91], v[120:123], a[112:115], v[88:91]
ds_read_b64_tr_b16 v[148:149], v161 offset:33792
v_mfma_f32_16x16x32_bf16 v[88:91], v[124:127], a[120:123], v[88:91]
ds_read_b64_tr_b16 v[150:151], v161 offset:41984
ds_read_b64_tr_b16 v[152:153], v161 offset:34816
v_mfma_f32_16x16x32_bf16 v[92:95], v[124:127], a[124:127], v[92:95]
buffer_load_dwordx4 v233, s[32:35], s63 offen offset:3072 lds
v_mfma_f32_16x16x32_bf16 v[92:95], v[120:123], a[116:119], v[92:95]
ds_read_b64_tr_b16 v[154:155], v161 offset:43008
v_add_u32 v244, 2, v242
s_waitcnt vmcnt(7)
buffer_store_dword v244, v248, s[40:43], s86 offen offset:1536 sc1
v_mfma_f32_16x16x32_bf16 v[92:95], v[116:119], a[108:111], v[92:95]
ds_read_b64_tr_b16 v[156:157], v161 offset:35840
v_mfma_f32_16x16x32_bf16 v[92:95], v[112:115], a[100:103], v[92:95]
ds_read_b64_tr_b16 v[158:159], v161 offset:44032
s_waitcnt lgkmcnt(8)
v_mfma_f32_16x16x32_bf16 v[64:67], v[128:131], a[128:131], v[64:67]
ds_read_b64_tr_b16 v[112:113], v162 offset:32768
v_mfma_f32_16x16x32_bf16 v[64:67], v[132:135], a[136:139], v[64:67]
ds_read_b64_tr_b16 v[114:115], v162 offset:40960
v_mfma_f32_16x16x32_bf16 v[64:67], v[136:139], a[144:147], v[64:67]
ds_read_b64_tr_b16 v[116:117], v162 offset:33792
ds_read_b64_tr_b16 v[118:119], v162 offset:41984
s_add_u32 m0, s80, 81920
v_mfma_f32_16x16x32_bf16 v[64:67], v[140:143], a[152:155], v[64:67]
buffer_load_dwordx4 v233, s[32:35], s64 offen lds
v_mfma_f32_16x16x32_bf16 v[68:71], v[140:143], a[156:159], v[68:71]
ds_read_b64_tr_b16 v[120:121], v162 offset:34816
v_mfma_f32_16x16x32_bf16 v[68:71], v[136:139], a[148:151], v[68:71]
ds_read_b64_tr_b16 v[122:123], v162 offset:43008
v_mfma_f32_16x16x32_bf16 v[68:71], v[132:135], a[140:143], v[68:71]
ds_read_b64_tr_b16 v[124:125], v162 offset:35840
v_mfma_f32_16x16x32_bf16 v[68:71], v[128:131], a[132:135], v[68:71]
ds_read_b64_tr_b16 v[126:127], v162 offset:44032
s_waitcnt lgkmcnt(8)
v_mfma_f32_16x16x32_bf16 v[72:75], v[144:147], a[128:131], v[72:75]
ds_read_b64_tr_b16 v[128:129], v163 offset:32768
v_mfma_f32_16x16x32_bf16 v[72:75], v[148:151], a[136:139], v[72:75]
ds_read_b64_tr_b16 v[130:131], v163 offset:40960
v_mfma_f32_16x16x32_bf16 v[72:75], v[152:155], a[144:147], v[72:75]
ds_read_b64_tr_b16 v[132:133], v163 offset:33792
ds_read_b64_tr_b16 v[134:135], v163 offset:41984
v_mfma_f32_16x16x32_bf16 v[72:75], v[156:159], a[152:155], v[72:75]
buffer_load_dwordx4 v233, s[32:35], s65 offen offset:1024 lds
v_mfma_f32_16x16x32_bf16 v[76:79], v[156:159], a[156:159], v[76:79]
ds_read_b64_tr_b16 v[136:137], v163 offset:34816
v_mfma_f32_16x16x32_bf16 v[76:79], v[152:155], a[148:151], v[76:79]
ds_read_b64_tr_b16 v[138:139], v163 offset:43008
v_sub_u32 v243, v243, v242
v_mfma_f32_16x16x32_bf16 v[76:79], v[148:151], a[140:143], v[76:79]
ds_read_b64_tr_b16 v[140:141], v163 offset:35840
v_add_u32 v243, -1, v243
v_mfma_f32_16x16x32_bf16 v[76:79], v[144:147], a[132:135], v[76:79]
ds_read_b64_tr_b16 v[142:143], v163 offset:44032
v_cmp_le_u32 vcc, 15, v243
s_cbranch_vccnz L_slow7
L_back7:
s_waitcnt lgkmcnt(8)
v_mfma_f32_16x16x32_bf16 v[80:83], v[112:115], a[128:131], v[80:83]
ds_read_b64_tr_b16 v[144:145], v160 offset:49152
v_mfma_f32_16x16x32_bf16 v[80:83], v[116:119], a[136:139], v[80:83]
ds_read_b64_tr_b16 v[146:147], v160 offset:57344
ds_read_b64_tr_b16 v[148:149], v160 offset:50176
v_mfma_f32_16x16x32_bf16 v[80:83], v[120:123], a[144:147], v[80:83]
buffer_load_dwordx4 v[188:191], v251, s[40:43], s13 offen offset:0 sc1
v_mfma_f32_16x16x32_bf16 v[80:83], v[124:127], a[152:155], v[80:83]
ds_read_b64_tr_b16 v[150:151], v160 offset:58368
ds_read_b64_tr_b16 v[152:153], v160 offset:51200
v_mfma_f32_16x16x32_bf16 v[84:87], v[124:127], a[156:159], v[84:87]
buffer_load_dwordx4 v[192:195], v251, s[40:43], s13 offen offset:128 sc1
v_mfma_f32_16x16x32_bf16 v[84:87], v[120:123], a[148:151], v[84:87]
ds_read_b64_tr_b16 v[154:155], v160 offset:59392
ds_read_b64_tr_b16 v[156:157], v160 offset:52224
v_mfma_f32_16x16x32_bf16 v[84:87], v[116:119], a[140:143], v[84:87]
buffer_load_dwordx4 v[196:199], v247, s[40:43], s13 offen offset:0 sc1
v_mfma_f32_16x16x32_bf16 v[84:87], v[112:115], a[132:135], v[84:87]
ds_read_b64_tr_b16 v[158:159], v160 offset:60416
s_waitcnt lgkmcnt(8)
v_mfma_f32_16x16x32_bf16 v[88:91], v[128:131], a[128:131], v[88:91]
ds_read_b64_tr_b16 v[112:113], v161 offset:49152
ds_read_b64_tr_b16 v[114:115], v161 offset:57344
v_mfma_f32_16x16x32_bf16 v[88:91], v[132:135], a[136:139], v[88:91]
buffer_load_dwordx4 v[200:203], v247, s[40:43], s13 offen offset:128 sc1
v_mfma_f32_16x16x32_bf16 v[88:91], v[136:139], a[144:147], v[88:91]
ds_read_b64_tr_b16 v[116:117], v161 offset:50176
v_mfma_f32_16x16x32_bf16 v[88:91], v[140:143], a[152:155], v[88:91]
ds_read_b64_tr_b16 v[118:119], v161 offset:58368
v_mfma_f32_16x16x32_bf16 v[92:95], v[140:143], a[156:159], v[92:95]
ds_read_b64_tr_b16 v[120:121], v161 offset:51200
ds_read_b64_tr_b16 v[122:123], v161 offset:59392
v_mfma_f32_16x16x32_bf16 v[92:95], v[136:139], a[148:151], v[92:95]
buffer_load_dwordx4 v233, s[32:35], s66 offen offset:2048 lds
v_mfma_f32_16x16x32_bf16 v[92:95], v[132:135], a[140:143], v[92:95]
ds_read_b64_tr_b16 v[124:125], v161 offset:52224
v_mfma_f32_16x16x32_bf16 v[92:95], v[128:131], a[132:135], v[92:95]
ds_read_b64_tr_b16 v[126:127], v161 offset:60416
s_waitcnt lgkmcnt(8)
v_mfma_f32_16x16x32_bf16 v[64:67], v[144:147], a[160:163], v[64:67]
ds_read_b64_tr_b16 v[128:129], v162 offset:49152
v_mfma_f32_16x16x32_bf16 v[64:67], v[148:151], a[168:171], v[64:67]
ds_read_b64_tr_b16 v[130:131], v162 offset:57344
v_mfma_f32_16x16x32_bf16 v[64:67], v[152:155], a[176:179], v[64:67]
ds_read_b64_tr_b16 v[132:133], v162 offset:50176
ds_read_b64_tr_b16 v[134:135], v162 offset:58368
v_mfma_f32_16x16x32_bf16 v[64:67], v[156:159], a[184:187], v[64:67]
buffer_load_dwordx4 v233, s[32:35], s67 offen offset:3072 lds
v_mfma_f32_16x16x32_bf16 v[68:71], v[156:159], a[188:191], v[68:71]
ds_read_b64_tr_b16 v[136:137], v162 offset:51200
v_mfma_f32_16x16x32_bf16 v[68:71], v[152:155], a[180:183], v[68:71]
ds_read_b64_tr_b16 v[138:139], v162 offset:59392
v_mfma_f32_16x16x32_bf16 v[68:71], v[148:151], a[172:175], v[68:71]
ds_read_b64_tr_b16 v[140:141], v162 offset:52224
v_mfma_f32_16x16x32_bf16 v[68:71], v[144:147], a[164:167], v[68:71]
ds_read_b64_tr_b16 v[142:143], v162 offset:60416
s_waitcnt lgkmcnt(8)
v_mfma_f32_16x16x32_bf16 v[72:75], v[112:115], a[160:163], v[72:75]
ds_read_b64_tr_b16 v[144:145], v163 offset:49152
ds_read_b64_tr_b16 v[146:147], v163 offset:57344
s_add_u32 m0, s80, 98304
v_mfma_f32_16x16x32_bf16 v[72:75], v[116:119], a[168:171], v[72:75]
buffer_load_dwordx4 v233, s[32:35], s68 offen lds
v_mfma_f32_16x16x32_bf16 v[72:75], v[120:123], a[176:179], v[72:75]
ds_read_b64_tr_b16 v[148:149], v163 offset:50176
v_mfma_f32_16x16x32_bf16 v[72:75], v[124:127], a[184:187], v[72:75]
ds_read_b64_tr_b16 v[150:151], v163 offset:58368
v_mfma_f32_16x16x32_bf16 v[76:79], v[124:127], a[188:191], v[76:79]
ds_read_b64_tr_b16 v[152:153], v163 offset:51200
v_mfma_f32_16x16x32_bf16 v[76:79], v[120:123], a[180:183], v[76:79]
ds_read_b64_tr_b16 v[154:155], v163 offset:59392
v_mfma_f32_16x16x32_bf16 v[76:79], v[116:119], a[172:175], v[76:79]
ds_read_b64_tr_b16 v[156:157], v163 offset:52224
ds_read_b64_tr_b16 v[158:159], v163 offset:60416
v_mfma_f32_16x16x32_bf16 v[76:79], v[112:115], a[164:167], v[76:79]
s_waitcnt vmcnt(10) lgkmcnt(8)
s_barrier
v_mfma_f32_16x16x32_bf16 v[80:83], v[128:131], a[160:163], v[80:83]
ds_read_b64_tr_b16 v[112:113], v164 offset:0
ds_read_b64_tr_b16 v[114:115], v164 offset:8192
v_mfma_f32_16x16x32_bf16 v[80:83], v[132:135], a[168:171], v[80:83]
buffer_load_dwordx4 v233, s[32:35], s69 offen offset:1024 lds
v_mfma_f32_16x16x32_bf16 v[80:83], v[136:139], a[176:179], v[80:83]
ds_read_b64_tr_b16 v[116:117], v164 offset:1024
v_mfma_f32_16x16x32_bf16 v[80:83], v[140:143], a[184:187], v[80:83]
ds_read_b64_tr_b16 v[118:119], v164 offset:9216
v_mfma_f32_16x16x32_bf16 v[84:87], v[140:143], a[188:191], v[84:87]
ds_read_b64_tr_b16 v[120:121], v164 offset:2048
v_mfma_f32_16x16x32_bf16 v[84:87], v[136:139], a[180:183], v[84:87]
ds_read_b64_tr_b16 v[122:123], v164 offset:10240
ds_read_b64_tr_b16 v[124:125], v164 offset:3072
v_mfma_f32_16x16x32_bf16 v[84:87], v[132:135], a[172:175], v[84:87]
buffer_load_dwordx4 v233, s[32:35], s70 offen offset:2048 lds
v_mfma_f32_16x16x32_bf16 v[84:87], v[128:131], a[164:167], v[84:87]
ds_read_b64_tr_b16 v[126:127], v164 offset:11264
s_waitcnt lgkmcnt(8)
v_mfma_f32_16x16x32_bf16 v[88:91], v[144:147], a[160:163], v[88:91]
ds_read_b64_tr_b16 v[128:129], v165 offset:0
v_mfma_f32_16x16x32_bf16 v[88:91], v[148:151], a[168:171], v[88:91]
ds_read_b64_tr_b16 v[130:131], v165 offset:8192
v_mfma_f32_16x16x32_bf16 v[88:91], v[152:155], a[176:179], v[88:91]
ds_read_b64_tr_b16 v[132:133], v165 offset:1024
v_mfma_f32_16x16x32_bf16 v[88:91], v[156:159], a[184:187], v[88:91]
ds_read_b64_tr_b16 v[134:135], v165 offset:9216
v_mfma_f32_16x16x32_bf16 v[92:95], v[156:159], a[188:191], v[92:95]
ds_read_b64_tr_b16 v[136:137], v165 offset:2048
ds_read_b64_tr_b16 v[138:139], v165 offset:10240
v_mfma_f32_16x16x32_bf16 v[92:95], v[152:155], a[180:183], v[92:95]
buffer_load_dwordx4 v233, s[32:35], s71 offen offset:3072 lds
v_mfma_f32_16x16x32_bf16 v[92:95], v[148:151], a[172:175], v[92:95]
ds_read_b64_tr_b16 v[140:141], v165 offset:3072
v_mfma_f32_16x16x32_bf16 v[92:95], v[144:147], a[164:167], v[92:95]
ds_read_b64_tr_b16 v[142:143], v165 offset:11264
s_waitcnt lgkmcnt(8)
v_mfma_f32_16x16x32_bf16 v[64:67], v[112:115], a[192:195], v[64:67]
ds_read_b64_tr_b16 v[144:145], v166 offset:0
v_mfma_f32_16x16x32_bf16 v[64:67], v[116:119], a[200:203], v[64:67]
ds_read_b64_tr_b16 v[146:147], v166 offset:8192
v_mfma_f32_16x16x32_bf16 v[64:67], v[120:123], a[208:211], v[64:67]
ds_read_b64_tr_b16 v[148:149], v166 offset:1024
v_mfma_f32_16x16x32_bf16 v[64:67], v[124:127], a[216:219], v[64:67]
ds_read_b64_tr_b16 v[150:151], v166 offset:9216
ds_read_b64_tr_b16 v[152:153], v166 offset:2048
s_add_u32 m0, s80, 114688
v_mfma_f32_16x16x32_bf16 v[68:71], v[124:127], a[220:223], v[68:71]
buffer_load_dwordx4 v233, s[32:35], s72 offen lds
v_mfma_f32_16x16x32_bf16 v[68:71], v[120:123], a[212:215], v[68:71]
ds_read_b64_tr_b16 v[154:155], v166 offset:10240
v_mfma_f32_16x16x32_bf16 v[68:71], v[116:119], a[204:207], v[68:71]
ds_read_b64_tr_b16 v[156:157], v166 offset:3072
v_mfma_f32_16x16x32_bf16 v[68:71], v[112:115], a[196:199], v[68:71]
ds_read_b64_tr_b16 v[158:159], v166 offset:11264
s_waitcnt lgkmcnt(8)
v_mfma_f32_16x16x32_bf16 v[72:75], v[128:131], a[192:195], v[72:75]
ds_read_b64_tr_b16 v[112:113], v167 offset:0
v_mfma_f32_16x16x32_bf16 v[72:75], v[132:135], a[200:203], v[72:75]
ds_read_b64_tr_b16 v[114:115], v167 offset:8192
v_mfma_f32_16x16x32_bf16 v[72:75], v[136:139], a[208:211], v[72:75]
ds_read_b64_tr_b16 v[116:117], v167 offset:1024
v_mfma_f32_16x16x32_bf16 v[72:75], v[140:143], a[216:219], v[72:75]
ds_read_b64_tr_b16 v[118:119], v167 offset:9216
ds_read_b64_tr_b16 v[120:121], v167 offset:2048
v_mfma_f32_16x16x32_bf16 v[76:79], v[140:143], a[220:223], v[76:79]
buffer_load_dwordx4 v233, s[32:35], s73 offen offset:1024 lds
v_mfma_f32_16x16x32_bf16 v[76:79], v[136:139], a[212:215], v[76:79]
ds_read_b64_tr_b16 v[122:123], v167 offset:10240
v_mfma_f32_16x16x32_bf16 v[76:79], v[132:135], a[204:207], v[76:79]
ds_read_b64_tr_b16 v[124:125], v167 offset:3072
v_mfma_f32_16x16x32_bf16 v[76:79], v[128:131], a[196:199], v[76:79]
ds_read_b64_tr_b16 v[126:127], v167 offset:11264
s_waitcnt lgkmcnt(8)
v_mfma_f32_16x16x32_bf16 v[80:83], v[144:147], a[192:195], v[80:83]
L_pad9:
s_cbranch_execz L_warm2
ds_read_b64_tr_b16 v[128:129], v160 offset:0
v_cvt_pk_bf16_f32 v172, v64, v65
v_mfma_f32_16x16x32_bf16 v[80:83], v[148:151], a[200:203], v[80:83]
ds_read_b64_tr_b16 v[130:131], v160 offset:8192
v_cvt_pk_bf16_f32 v173, v66, v67
v_mfma_f32_16x16x32_bf16 v[80:83], v[152:155], a[208:211], v[80:83]
ds_read_b64_tr_b16 v[132:133], v160 offset:1024
v_cvt_pk_bf16_f32 v174, v72, v73
v_mfma_f32_16x16x32_bf16 v[80:83], v[156:159], a[216:219], v[80:83]
ds_read_b64_tr_b16 v[134:135], v160 offset:9216
ds_read_b64_tr_b16 v[136:137], v160 offset:2048
v_mfma_f32_16x16x32_bf16 v[84:87], v[156:159], a[220:223], v[84:87]
buffer_load_dwordx4 v233, s[32:35], s74 offen offset:2048 lds
v_cvt_pk_bf16_f32 v175, v74, v75
v_mfma_f32_16x16x32_bf16 v[84:87], v[152:155], a[212:215], v[84:87]
ds_read_b64_tr_b16 v[138:139], v160 offset:10240
v_cvt_pk_bf16_f32 v176, v68, v69
v_mfma_f32_16x16x32_bf16 v[84:87], v[148:151], a[204:207], v[84:87]
ds_read_b64_tr_b16 v[140:141], v160 offset:3072
v_cvt_pk_bf16_f32 v177, v70, v71
v_mfma_f32_16x16x32_bf16 v[84:87], v[144:147], a[196:199], v[84:87]
ds_read_b64_tr_b16 v[142:143], v160 offset:11264
v_cvt_pk_bf16_f32 v178, v76, v77
s_waitcnt lgkmcnt(8)
v_mfma_f32_16x16x32_bf16 v[88:91], v[112:115], a[192:195], v[88:91]
ds_read_b64_tr_b16 v[144:145], v161 offset:0
ds_read_b64_tr_b16 v[146:147], v161 offset:8192
v_cvt_pk_bf16_f32 v179, v78, v79
v_mfma_f32_16x16x32_bf16 v[88:91], v[116:119], a[200:203], v[88:91]
buffer_store_dwordx4 v[172:175], v251, s[40:43], s12 offen offset:0 sc1
v_mfma_f32_16x16x32_bf16 v[88:91], v[120:123], a[208:211], v[88:91]
ds_read_b64_tr_b16 v[148:149], v161 offset:1024
v_mfma_f32_16x16x32_bf16 v[88:91], v[124:127], a[216:219], v[88:91]
ds_read_b64_tr_b16 v[150:151], v161 offset:9216
v_mfma_f32_16x16x32_bf16 v[92:95], v[124:127], a[220:223], v[92:95]
ds_read_b64_tr_b16 v[152:153], v161 offset:2048
ds_read_b64_tr_b16 v[154:155], v161 offset:10240
v_mfma_f32_16x16x32_bf16 v[92:95], v[120:123], a[212:215], v[92:95]
buffer_store_dwordx4 v[176:179], v251, s[40:43], s12 offen offset:128 sc1
v_mfma_f32_16x16x32_bf16 v[92:95], v[116:119], a[204:207], v[92:95]
ds_read_b64_tr_b16 v[156:157], v161 offset:3072
v_mfma_f32_16x16x32_bf16 v[92:95], v[112:115], a[196:199], v[92:95]
ds_read_b64_tr_b16 v[158:159], v161 offset:11264
s_waitcnt lgkmcnt(8)
v_mfma_f32_16x16x32_bf16 v[0:3], v[128:131], a[0:3], v[0:3]
ds_read_b64_tr_b16 v[112:113], v162 offset:0
ds_read_b64_tr_b16 v[114:115], v162 offset:8192
v_mfma_f32_16x16x32_bf16 v[0:3], v[132:135], a[8:11], v[0:3]
buffer_load_dwordx4 v233, s[32:35], s75 offen offset:3072 lds
v_mfma_f32_16x16x32_bf16 v[0:3], v[136:139], a[16:19], v[0:3]
ds_read_b64_tr_b16 v[116:117], v162 offset:1024
v_cvt_pk_bf16_f32 v180, v80, v81
v_cvt_pk_bf16_f32 v181, v82, v83
v_mfma_f32_16x16x32_bf16 v[0:3], v[140:143], a[24:27], v[0:3]
ds_read_b64_tr_b16 v[118:119], v162 offset:9216
v_cvt_pk_bf16_f32 v182, v88, v89
v_mfma_f32_16x16x32_bf16 v[4:7], v[140:143], a[28:31], v[4:7]
ds_read_b64_tr_b16 v[120:121], v162 offset:2048
v_cvt_pk_bf16_f32 v183, v90, v91
v_mfma_f32_16x16x32_bf16 v[4:7], v[136:139], a[20:23], v[4:7]
ds_read_b64_tr_b16 v[122:123], v162 offset:10240
ds_read_b64_tr_b16 v[124:125], v162 offset:3072
v_mfma_f32_16x16x32_bf16 v[4:7], v[132:135], a[12:15], v[4:7]
buffer_store_dwordx4 v[180:183], v247, s[40:43], s12 offen offset:0 sc1
v_cvt_pk_bf16_f32 v184, v84, v85
v_mfma_f32_16x16x32_bf16 v[4:7], v[128:131], a[4:7], v[4:7]
ds_read_b64_tr_b16 v[126:127], v162 offset:11264
v_cvt_pk_bf16_f32 v185, v86, v87
s_waitcnt lgkmcnt(8)
v_mfma_f32_16x16x32_bf16 v[8:11], v[144:147], a[0:3], v[8:11]
ds_read_b64_tr_b16 v[128:129], v163 offset:0
v_cvt_pk_bf16_f32 v186, v92, v93
v_cvt_pk_bf16_f32 v187, v94, v95
v_mfma_f32_16x16x32_bf16 v[8:11], v[148:151], a[8:11], v[8:11]
ds_read_b64_tr_b16 v[130:131], v163 offset:8192
ds_read_b64_tr_b16 v[132:133], v163 offset:1024
s_add_u32 m0, s80, 16384
v_mfma_f32_16x16x32_bf16 v[8:11], v[152:155], a[16:19], v[8:11]
buffer_load_dwordx4 v233, s[32:35], s44 offen lds
v_mfma_f32_16x16x32_bf16 v[8:11], v[156:159], a[24:27], v[8:11]
ds_read_b64_tr_b16 v[134:135], v163 offset:9216
v_mfma_f32_16x16x32_bf16 v[12:15], v[156:159], a[28:31], v[12:15]
ds_read_b64_tr_b16 v[136:137], v163 offset:2048
ds_read_b64_tr_b16 v[138:139], v163 offset:10240
v_mfma_f32_16x16x32_bf16 v[12:15], v[152:155], a[20:23], v[12:15]
buffer_store_dwordx4 v[184:187], v247, s[40:43], s12 offen offset:128 sc1
v_mfma_f32_16x16x32_bf16 v[12:15], v[148:151], a[12:15], v[12:15]
ds_read_b64_tr_b16 v[140:141], v163 offset:3072
ds_read_b64_tr_b16 v[142:143], v163 offset:11264
v_mfma_f32_16x16x32_bf16 v[12:15], v[144:147], a[4:7], v[12:15]
s_add_u32 s12, s12, 8192
s_waitcnt vmcnt(9) lgkmcnt(8)
s_barrier
v_mfma_f32_16x16x32_bf16 v[16:19], v[112:115], a[0:3], v[16:19]
ds_read_b64_tr_b16 v[144:145], v164 offset:16384
ds_read_b64_tr_b16 v[146:147], v164 offset:24576
v_mfma_f32_16x16x32_bf16 v[16:19], v[116:119], a[8:11], v[16:19]
buffer_load_dwordx4 v233, s[32:35], s45 offen offset:1024 lds
v_mfma_f32_16x16x32_bf16 v[16:19], v[120:123], a[16:19], v[16:19]
ds_read_b64_tr_b16 v[148:149], v164 offset:17408
s_xor_b32 s82, s79, 12
v_mfma_f32_16x16x32_bf16 v[16:19], v[124:127], a[24:27], v[16:19]
ds_read_b64_tr_b16 v[150:151], v164 offset:25600
s_lshl_b32 s83, s82, 7
v_mfma_f32_16x16x32_bf16 v[20:23], v[124:127], a[28:31], v[20:23]
ds_read_b64_tr_b16 v[152:153], v164 offset:18432
v_mov_b32 v245, s83
v_mfma_f32_16x16x32_bf16 v[20:23], v[120:123], a[20:23], v[20:23]
ds_read_b64_tr_b16 v[154:155], v164 offset:26624
ds_read_b64_tr_b16 v[156:157], v164 offset:19456
v_mfma_f32_16x16x32_bf16 v[20:23], v[116:119], a[12:15], v[20:23]
buffer_load_dwordx4 v233, s[32:35], s46 offen offset:2048 lds
v_mfma_f32_16x16x32_bf16 v[20:23], v[112:115], a[4:7], v[20:23]
ds_read_b64_tr_b16 v[158:159], v164 offset:27648
s_waitcnt lgkmcnt(8)
v_mfma_f32_16x16x32_bf16 v[24:27], v[128:131], a[0:3], v[24:27]
ds_read_b64_tr_b16 v[112:113], v165 offset:16384
s_xor_b32 s13, s90, 1572864
v_mfma_f32_16x16x32_bf16 v[24:27], v[132:135], a[8:11], v[24:27]
ds_read_b64_tr_b16 v[114:115], v165 offset:24576
s_add_u32 s13, s13, 35659776
v_mfma_f32_16x16x32_bf16 v[24:27], v[136:139], a[16:19], v[24:27]
ds_read_b64_tr_b16 v[116:117], v165 offset:17408
v_mfma_f32_16x16x32_bf16 v[24:27], v[140:143], a[24:27], v[24:27]
ds_read_b64_tr_b16 v[118:119], v165 offset:25600
v_mfma_f32_16x16x32_bf16 v[28:31], v[140:143], a[28:31], v[28:31]
ds_read_b64_tr_b16 v[120:121], v165 offset:18432
ds_read_b64_tr_b16 v[122:123], v165 offset:26624
v_mfma_f32_16x16x32_bf16 v[28:31], v[136:139], a[20:23], v[28:31]
buffer_load_dwordx4 v233, s[32:35], s47 offen offset:3072 lds
v_mfma_f32_16x16x32_bf16 v[28:31], v[132:135], a[12:15], v[28:31]
ds_read_b64_tr_b16 v[124:125], v165 offset:19456
buffer_load_dword v243, v245, s[40:43], s86 offen offset:1536 sc1
v_mfma_f32_16x16x32_bf16 v[28:31], v[128:131], a[4:7], v[28:31]
ds_read_b64_tr_b16 v[126:127], v165 offset:27648
s_waitcnt lgkmcnt(8)
v_mfma_f32_16x16x32_bf16 v[0:3], v[144:147], a[32:35], v[0:3]
ds_read_b64_tr_b16 v[128:129], v166 offset:16384
v_mfma_f32_16x16x32_bf16 v[0:3], v[148:151], a[40:43], v[0:3]
ds_read_b64_tr_b16 v[130:131], v166 offset:24576
v_mfma_f32_16x16x32_bf16 v[0:3], v[152:155], a[48:51], v[0:3]
ds_read_b64_tr_b16 v[132:133], v166 offset:17408
v_mfma_f32_16x16x32_bf16 v[0:3], v[156:159], a[56:59], v[0:3]
ds_read_b64_tr_b16 v[134:135], v166 offset:25600
ds_read_b64_tr_b16 v[136:137], v166 offset:18432
s_add_u32 m0, s80, 32768
v_mfma_f32_16x16x32_bf16 v[4:7], v[156:159], a[60:63], v[4:7]
buffer_load_dwordx4 v233, s[32:35], s48 offen lds
v_mfma_f32_16x16x32_bf16 v[4:7], v[152:155], a[52:55], v[4:7]
ds_read_b64_tr_b16 v[138:139], v166 offset:26624
v_mfma_f32_16x16x32_bf16 v[4:7], v[148:151], a[44:47], v[4:7]
ds_read_b64_tr_b16 v[140:141], v166 offset:19456
v_mfma_f32_16x16x32_bf16 v[4:7], v[144:147], a[36:39], v[4:7]
ds_read_b64_tr_b16 v[142:143], v166 offset:27648
s_waitcnt lgkmcnt(8)
v_mfma_f32_16x16x32_bf16 v[8:11], v[112:115], a[32:35], v[8:11]
ds_read_b64_tr_b16 v[144:145], v167 offset:16384
v_mfma_f32_16x16x32_bf16 v[8:11], v[116:119], a[40:43], v[8:11]
ds_read_b64_tr_b16 v[146:147], v167 offset:24576
v_mfma_f32_16x16x32_bf16 v[8:11], v[120:123], a[48:51], v[8:11]
ds_read_b64_tr_b16 v[148:149], v167 offset:17408
v_mfma_f32_16x16x32_bf16 v[8:11], v[124:127], a[56:59], v[8:11]
ds_read_b64_tr_b16 v[150:151], v167 offset:25600
ds_read_b64_tr_b16 v[152:153], v167 offset:18432
v_mfma_f32_16x16x32_bf16 v[12:15], v[124:127], a[60:63], v[12:15]
buffer_load_dwordx4 v233, s[32:35], s49 offen offset:1024 lds
v_mfma_f32_16x16x32_bf16 v[12:15], v[120:123], a[52:55], v[12:15]
ds_read_b64_tr_b16 v[154:155], v167 offset:26624
v_mfma_f32_16x16x32_bf16 v[12:15], v[116:119], a[44:47], v[12:15]
ds_read_b64_tr_b16 v[156:157], v167 offset:19456
v_mfma_f32_16x16x32_bf16 v[12:15], v[112:115], a[36:39], v[12:15]
ds_read_b64_tr_b16 v[158:159], v167 offset:27648
s_waitcnt lgkmcnt(8)
v_mfma_f32_16x16x32_bf16 v[16:19], v[128:131], a[32:35], v[16:19]
ds_read_b64_tr_b16 v[112:113], v164 offset:32768
v_mfma_f32_16x16x32_bf16 v[16:19], v[132:135], a[40:43], v[16:19]
ds_read_b64_tr_b16 v[114:115], v164 offset:40960
v_mfma_f32_16x16x32_bf16 v[16:19], v[136:139], a[48:51], v[16:19]
ds_read_b64_tr_b16 v[116:117], v164 offset:33792
v_mfma_f32_16x16x32_bf16 v[16:19], v[140:143], a[56:59], v[16:19]
ds_read_b64_tr_b16 v[118:119], v164 offset:41984
ds_read_b64_tr_b16 v[120:121], v164 offset:34816
v_mfma_f32_16x16x32_bf16 v[20:23], v[140:143], a[60:63], v[20:23]
buffer_load_dwordx4 v233, s[32:35], s50 offen offset:2048 lds
v_mfma_f32_16x16x32_bf16 v[20:23], v[136:139], a[52:55], v[20:23]
ds_read_b64_tr_b16 v[122:123], v164 offset:43008
v_mfma_f32_16x16x32_bf16 v[20:23], v[132:135], a[44:47], v[20:23]
ds_read_b64_tr_b16 v[124:125], v164 offset:35840
v_mfma_f32_16x16x32_bf16 v[20:23], v[128:131], a[36:39], v[20:23]
ds_read_b64_tr_b16 v[126:127], v164 offset:44032
s_waitcnt lgkmcnt(8)
v_mfma_f32_16x16x32_bf16 v[24:27], v[144:147], a[32:35], v[24:27]
ds_read_b64_tr_b16 v[128:129], v165 offset:32768
v_mfma_f32_16x16x32_bf16 v[24:27], v[148:151], a[40:43], v[24:27]
ds_read_b64_tr_b16 v[130:131], v165 offset:40960
v_mfma_f32_16x16x32_bf16 v[24:27], v[152:155], a[48:51], v[24:27]
ds_read_b64_tr_b16 v[132:133], v165 offset:33792
v_mfma_f32_16x16x32_bf16 v[24:27], v[156:159], a[56:59], v[24:27]
ds_read_b64_tr_b16 v[134:135], v165 offset:41984
ds_read_b64_tr_b16 v[136:137], v165 offset:34816
v_mfma_f32_16x16x32_bf16 v[28:31], v[156:159], a[60:63], v[28:31]
buffer_load_dwordx4 v233, s[32:35], s51 offen offset:3072 lds
v_mfma_f32_16x16x32_bf16 v[28:31], v[152:155], a[52:55], v[28:31]
ds_read_b64_tr_b16 v[138:139], v165 offset:43008
v_add_u32 v244, 3, v242
s_waitcnt vmcnt(8)
buffer_store_dword v244, v248, s[40:43], s86 offen offset:1536 sc1
v_mfma_f32_16x16x32_bf16 v[28:31], v[148:151], a[44:47], v[28:31]
ds_read_b64_tr_b16 v[140:141], v165 offset:35840
v_mfma_f32_16x16x32_bf16 v[28:31], v[144:147], a[36:39], v[28:31]
ds_read_b64_tr_b16 v[142:143], v165 offset:44032
s_waitcnt lgkmcnt(8)
v_mfma_f32_16x16x32_bf16 v[0:3], v[112:115], a[64:67], v[0:3]
ds_read_b64_tr_b16 v[144:145], v166 offset:32768
v_mfma_f32_16x16x32_bf16 v[0:3], v[116:119], a[72:75], v[0:3]
ds_read_b64_tr_b16 v[146:147], v166 offset:40960
v_mfma_f32_16x16x32_bf16 v[0:3], v[120:123], a[80:83], v[0:3]
ds_read_b64_tr_b16 v[148:149], v166 offset:33792
v_mfma_f32_16x16x32_bf16 v[0:3], v[124:127], a[88:91], v[0:3]
ds_read_b64_tr_b16 v[150:151], v166 offset:41984
ds_read_b64_tr_b16 v[152:153], v166 offset:34816
s_add_u32 m0, s80, 49152
v_mfma_f32_16x16x32_bf16 v[4:7], v[124:127], a[92:95], v[4:7]
buffer_load_dwordx4 v233, s[32:35], s52 offen lds
v_mfma_f32_16x16x32_bf16 v[4:7], v[120:123], a[84:87], v[4:7]
ds_read_b64_tr_b16 v[154:155], v166 offset:43008
v_mfma_f32_16x16x32_bf16 v[4:7], v[116:119], a[76:79], v[4:7]
ds_read_b64_tr_b16 v[156:157], v166 offset:35840
v_mfma_f32_16x16x32_bf16 v[4:7], v[112:115], a[68:71], v[4:7]
ds_read_b64_tr_b16 v[158:159], v166 offset:44032
s_waitcnt lgkmcnt(8)
v_mfma_f32_16x16x32_bf16 v[8:11], v[128:131], a[64:67], v[8:11]
ds_read_b64_tr_b16 v[112:113], v167 offset:32768
v_mfma_f32_16x16x32_bf16 v[8:11], v[132:135], a[72:75], v[8:11]
ds_read_b64_tr_b16 v[114:115], v167 offset:40960
v_mfma_f32_16x16x32_bf16 v[8:11], v[136:139], a[80:83], v[8:11]
ds_read_b64_tr_b16 v[116:117], v167 offset:33792
v_mfma_f32_16x16x32_bf16 v[8:11], v[140:143], a[88:91], v[8:11]
ds_read_b64_tr_b16 v[118:119], v167 offset:41984
ds_read_b64_tr_b16 v[120:121], v167 offset:34816
v_mfma_f32_16x16x32_bf16 v[12:15], v[140:143], a[92:95], v[12:15]
buffer_load_dwordx4 v233, s[32:35], s53 offen offset:1024 lds
v_mfma_f32_16x16x32_bf16 v[12:15], v[136:139], a[84:87], v[12:15]
ds_read_b64_tr_b16 v[122:123], v167 offset:43008
v_mfma_f32_16x16x32_bf16 v[12:15], v[132:135], a[76:79], v[12:15]
ds_read_b64_tr_b16 v[124:125], v167 offset:35840
ds_read_b64_tr_b16 v[126:127], v167 offset:44032
v_mfma_f32_16x16x32_bf16 v[12:15], v[128:131], a[68:71], v[12:15]
s_waitcnt vmcnt(8) lgkmcnt(8)
s_barrier
v_mfma_f32_16x16x32_bf16 v[16:19], v[144:147], a[64:67], v[16:19]
ds_read_b64_tr_b16 v[128:129], v164 offset:49152
v_mfma_f32_16x16x32_bf16 v[16:19], v[148:151], a[72:75], v[16:19]
ds_read_b64_tr_b16 v[130:131], v164 offset:57344
v_mfma_f32_16x16x32_bf16 v[16:19], v[152:155], a[80:83], v[16:19]
ds_read_b64_tr_b16 v[132:133], v164 offset:50176
v_mfma_f32_16x16x32_bf16 v[16:19], v[156:159], a[88:91], v[16:19]
ds_read_b64_tr_b16 v[134:135], v164 offset:58368
v_mfma_f32_16x16x32_bf16 v[20:23], v[156:159], a[92:95], v[20:23]
ds_read_b64_tr_b16 v[136:137], v164 offset:51200
ds_read_b64_tr_b16 v[138:139], v164 offset:59392
v_mfma_f32_16x16x32_bf16 v[20:23], v[152:155], a[84:87], v[20:23]
buffer_load_dwordx4 v233, s[32:35], s54 offen offset:2048 lds
v_mfma_f32_16x16x32_bf16 v[20:23], v[148:151], a[76:79], v[20:23]
ds_read_b64_tr_b16 v[140:141], v164 offset:52224
v_mfma_f32_16x16x32_bf16 v[20:23], v[144:147], a[68:71], v[20:23]
ds_read_b64_tr_b16 v[142:143], v164 offset:60416
s_waitcnt lgkmcnt(8)
v_mfma_f32_16x16x32_bf16 v[24:27], v[112:115], a[64:67], v[24:27]
ds_read_b64_tr_b16 v[144:145], v165 offset:49152
v_mfma_f32_16x16x32_bf16 v[24:27], v[116:119], a[72:75], v[24:27]
ds_read_b64_tr_b16 v[146:147], v165 offset:57344
v_mfma_f32_16x16x32_bf16 v[24:27], v[120:123], a[80:83], v[24:27]
ds_read_b64_tr_b16 v[148:149], v165 offset:50176
v_mfma_f32_16x16x32_bf16 v[24:27], v[124:127], a[88:91], v[24:27]
ds_read_b64_tr_b16 v[150:151], v165 offset:58368
ds_read_b64_tr_b16 v[152:153], v165 offset:51200
v_mfma_f32_16x16x32_bf16 v[28:31], v[124:127], a[92:95], v[28:31]
buffer_load_dwordx4 v233, s[32:35], s55 offen offset:3072 lds
v_mfma_f32_16x16x32_bf16 v[28:31], v[120:123], a[84:87], v[28:31]
ds_read_b64_tr_b16 v[154:155], v165 offset:59392
v_mfma_f32_16x16x32_bf16 v[28:31], v[116:119], a[76:79], v[28:31]
ds_read_b64_tr_b16 v[156:157], v165 offset:52224
v_mfma_f32_16x16x32_bf16 v[28:31], v[112:115], a[68:71], v[28:31]
ds_read_b64_tr_b16 v[158:159], v165 offset:60416
s_waitcnt lgkmcnt(8)
v_mfma_f32_16x16x32_bf16 v[0:3], v[128:131], a[96:99], v[0:3]
ds_read_b64_tr_b16 v[112:113], v166 offset:49152
v_mfma_f32_16x16x32_bf16 v[0:3], v[132:135], a[104:107], v[0:3]
ds_read_b64_tr_b16 v[114:115], v166 offset:57344
v_mfma_f32_16x16x32_bf16 v[0:3], v[136:139], a[112:115], v[0:3]
ds_read_b64_tr_b16 v[116:117], v166 offset:50176
v_mfma_f32_16x16x32_bf16 v[0:3], v[140:143], a[120:123], v[0:3]
ds_read_b64_tr_b16 v[118:119], v166 offset:58368
v_mfma_f32_16x16x32_bf16 v[4:7], v[140:143], a[124:127], v[4:7]
ds_read_b64_tr_b16 v[120:121], v166 offset:51200
v_mfma_f32_16x16x32_bf16 v[4:7], v[136:139], a[116:119], v[4:7]
ds_read_b64_tr_b16 v[122:123], v166 offset:59392
v_mfma_f32_16x16x32_bf16 v[4:7], v[132:135], a[108:111], v[4:7]
ds_read_b64_tr_b16 v[124:125], v166 offset:52224
s_waitcnt vmcnt(9)
v_mfma_f32_16x16x32_bf16 v[4:7], v[128:131], a[100:103], v[4:7]
ds_read_b64_tr_b16 v[126:127], v166 offset:60416
s_waitcnt lgkmcnt(8)
v_mfma_f32_16x16x32_bf16 v[8:11], v[144:147], a[96:99], v[8:11]
ds_read_b64_tr_b16 v[128:129], v167 offset:49152
v_sub_u32 v243, v243, v242
v_add_u32 v243, -2, v243
v_mfma_f32_16x16x32_bf16 v[8:11], v[148:151], a[104:107], v[8:11]
ds_read_b64_tr_b16 v[130:131], v167 offset:57344
v_cmp_le_u32 vcc, 14, v243
s_cbranch_vccnz L_slow8
L_back8:
v_mfma_f32_16x16x32_bf16 v[8:11], v[152:155], a[112:115], v[8:11]
ds_read_b64_tr_b16 v[132:133], v167 offset:50176
v_mfma_f32_16x16x32_bf16 v[8:11], v[156:159], a[120:123], v[8:11]
ds_read_b64_tr_b16 v[134:135], v167 offset:58368
ds_read_b64_tr_b16 v[136:137], v167 offset:51200
v_mfma_f32_16x16x32_bf16 v[12:15], v[156:159], a[124:127], v[12:15]
buffer_load_dwordx4 v[96:99], v251, s[40:43], s13 offen offset:0 sc1
v_mfma_f32_16x16x32_bf16 v[12:15], v[152:155], a[116:119], v[12:15]
ds_read_b64_tr_b16 v[138:139], v167 offset:59392
ds_read_b64_tr_b16 v[140:141], v167 offset:52224
v_mfma_f32_16x16x32_bf16 v[12:15], v[148:151], a[108:111], v[12:15]
buffer_load_dwordx4 v[100:103], v251, s[40:43], s13 offen offset:128 sc1
v_mfma_f32_16x16x32_bf16 v[12:15], v[144:147], a[100:103], v[12:15]
ds_read_b64_tr_b16 v[142:143], v167 offset:60416
s_waitcnt lgkmcnt(8)
v_mfma_f32_16x16x32_bf16 v[16:19], v[112:115], a[96:99], v[16:19]
ds_read_b64_tr_b16 v[144:145], v160 offset:16384
ds_read_b64_tr_b16 v[146:147], v160 offset:24576
v_mfma_f32_16x16x32_bf16 v[16:19], v[116:119], a[104:107], v[16:19]
buffer_load_dwordx4 v[104:107], v247, s[40:43], s13 offen offset:0 sc1
v_mfma_f32_16x16x32_bf16 v[16:19], v[120:123], a[112:115], v[16:19]
ds_read_b64_tr_b16 v[148:149], v160 offset:17408
ds_read_b64_tr_b16 v[150:151], v160 offset:25600
v_mfma_f32_16x16x32_bf16 v[16:19], v[124:127], a[120:123], v[16:19]
buffer_load_dwordx4 v[108:111], v247, s[40:43], s13 offen offset:128 sc1
v_mfma_f32_16x16x32_bf16 v[20:23], v[124:127], a[124:127], v[20:23]
ds_read_b64_tr_b16 v[152:153], v160 offset:18432
v_mfma_f32_16x16x32_bf16 v[20:23], v[120:123], a[116:119], v[20:23]
ds_read_b64_tr_b16 v[154:155], v160 offset:26624
v_mfma_f32_16x16x32_bf16 v[20:23], v[116:119], a[108:111], v[20:23]
ds_read_b64_tr_b16 v[156:157], v160 offset:19456
s_xor_b32 s82, s79, 4
v_mfma_f32_16x16x32_bf16 v[20:23], v[112:115], a[100:103], v[20:23]
ds_read_b64_tr_b16 v[158:159], v160 offset:27648
s_waitcnt lgkmcnt(8)
v_mfma_f32_16x16x32_bf16 v[24:27], v[128:131], a[96:99], v[24:27]
ds_read_b64_tr_b16 v[112:113], v161 offset:16384
s_lshl_b32 s83, s82, 7
v_mfma_f32_16x16x32_bf16 v[24:27], v[132:135], a[104:107], v[24:27]
ds_read_b64_tr_b16 v[114:115], v161 offset:24576
v_mov_b32 v245, s83
v_mfma_f32_16x16x32_bf16 v[24:27], v[136:139], a[112:115], v[24:27]
ds_read_b64_tr_b16 v[116:117], v161 offset:17408
s_xor_b32 s13, s90, 524288
v_mfma_f32_16x16x32_bf16 v[24:27], v[140:143], a[120:123], v[24:27]
ds_read_b64_tr_b16 v[118:119], v161 offset:25600
s_add_u32 s13, s13, 35667968
v_mfma_f32_16x16x32_bf16 v[28:31], v[140:143], a[124:127], v[28:31]
ds_read_b64_tr_b16 v[120:121], v161 offset:18432
v_mfma_f32_16x16x32_bf16 v[28:31], v[136:139], a[116:119], v[28:31]
ds_read_b64_tr_b16 v[122:123], v161 offset:26624
v_mfma_f32_16x16x32_bf16 v[28:31], v[132:135], a[108:111], v[28:31]
ds_read_b64_tr_b16 v[124:125], v161 offset:19456
v_mfma_f32_16x16x32_bf16 v[28:31], v[128:131], a[100:103], v[28:31]
ds_read_b64_tr_b16 v[126:127], v161 offset:27648
s_waitcnt lgkmcnt(8)
v_mfma_f32_16x16x32_bf16 v[0:3], v[144:147], a[128:131], v[0:3]
ds_read_b64_tr_b16 v[128:129], v162 offset:16384
v_mfma_f32_16x16x32_bf16 v[0:3], v[148:151], a[136:139], v[0:3]
ds_read_b64_tr_b16 v[130:131], v162 offset:24576
v_mfma_f32_16x16x32_bf16 v[0:3], v[152:155], a[144:147], v[0:3]
ds_read_b64_tr_b16 v[132:133], v162 offset:17408
v_mfma_f32_16x16x32_bf16 v[0:3], v[156:159], a[152:155], v[0:3]
v_mfma_f32_16x16x32_bf16 v[0:3], v[34:37], v[188:191], v[0:3]
ds_read_b64_tr_b16 v[134:135], v162 offset:25600
buffer_load_dword v243, v245, s[40:43], s86 offen offset:1536 sc1
v_mfma_f32_16x16x32_bf16 v[4:7], v[156:159], a[156:159], v[4:7]
ds_read_b64_tr_b16 v[136:137], v162 offset:18432
v_mfma_f32_16x16x32_bf16 v[4:7], v[152:155], a[148:151], v[4:7]
ds_read_b64_tr_b16 v[138:139], v162 offset:26624
v_mfma_f32_16x16x32_bf16 v[4:7], v[148:151], a[140:143], v[4:7]
ds_read_b64_tr_b16 v[140:141], v162 offset:19456
v_mfma_f32_16x16x32_bf16 v[4:7], v[144:147], a[132:135], v[4:7]
v_mfma_f32_16x16x32_bf16 v[4:7], v[34:37], v[192:195], v[4:7]
ds_read_b64_tr_b16 v[142:143], v162 offset:27648
s_waitcnt lgkmcnt(8)
v_mfma_f32_16x16x32_bf16 v[8:11], v[112:115], a[128:131], v[8:11]
ds_read_b64_tr_b16 v[144:145], v163 offset:16384
v_mfma_f32_16x16x32_bf16 v[8:11], v[116:119], a[136:139], v[8:11]
ds_read_b64_tr_b16 v[146:147], v163 offset:24576
v_mfma_f32_16x16x32_bf16 v[8:11], v[120:123], a[144:147], v[8:11]
ds_read_b64_tr_b16 v[148:149], v163 offset:17408
v_mfma_f32_16x16x32_bf16 v[8:11], v[124:127], a[152:155], v[8:11]
v_mfma_f32_16x16x32_bf16 v[8:11], v[32:35], v[188:191], v[8:11]
ds_read_b64_tr_b16 v[150:151], v163 offset:25600
v_mfma_f32_16x16x32_bf16 v[12:15], v[124:127], a[156:159], v[12:15]
ds_read_b64_tr_b16 v[152:153], v163 offset:18432
v_mfma_f32_16x16x32_bf16 v[12:15], v[120:123], a[148:151], v[12:15]
ds_read_b64_tr_b16 v[154:155], v163 offset:26624
v_mfma_f32_16x16x32_bf16 v[12:15], v[116:119], a[140:143], v[12:15]
ds_read_b64_tr_b16 v[156:157], v163 offset:19456
ds_read_b64_tr_b16 v[158:159], v163 offset:27648
v_mfma_f32_16x16x32_bf16 v[12:15], v[112:115], a[132:135], v[12:15]
v_mfma_f32_16x16x32_bf16 v[12:15], v[32:35], v[192:195], v[12:15]
s_waitcnt vmcnt(5) lgkmcnt(8)
s_barrier
v_mfma_f32_16x16x32_bf16 v[16:19], v[128:131], a[128:131], v[16:19]
ds_read_b64_tr_b16 v[112:113], v160 offset:32768
v_mfma_f32_16x16x32_bf16 v[16:19], v[132:135], a[136:139], v[16:19]
ds_read_b64_tr_b16 v[114:115], v160 offset:40960
v_mfma_f32_16x16x32_bf16 v[16:19], v[136:139], a[144:147], v[16:19]
ds_read_b64_tr_b16 v[116:117], v160 offset:33792
v_mfma_f32_16x16x32_bf16 v[16:19], v[140:143], a[152:155], v[16:19]
v_mfma_f32_16x16x32_bf16 v[16:19], v[34:37], v[196:199], v[16:19]
ds_read_b64_tr_b16 v[118:119], v160 offset:41984
v_mfma_f32_16x16x32_bf16 v[20:23], v[140:143], a[156:159], v[20:23]
ds_read_b64_tr_b16 v[120:121], v160 offset:34816
v_mfma_f32_16x16x32_bf16 v[20:23], v[136:139], a[148:151], v[20:23]
ds_read_b64_tr_b16 v[122:123], v160 offset:43008
v_mfma_f32_16x16x32_bf16 v[20:23], v[132:135], a[140:143], v[20:23]
ds_read_b64_tr_b16 v[124:125], v160 offset:35840
v_mfma_f32_16x16x32_bf16 v[20:23], v[128:131], a[132:135], v[20:23]
v_mfma_f32_16x16x32_bf16 v[20:23], v[34:37], v[200:203], v[20:23]
ds_read_b64_tr_b16 v[126:127], v160 offset:44032
s_waitcnt lgkmcnt(8)
v_mfma_f32_16x16x32_bf16 v[24:27], v[144:147], a[128:131], v[24:27]
ds_read_b64_tr_b16 v[128:129], v161 offset:32768
v_mfma_f32_16x16x32_bf16 v[24:27], v[148:151], a[136:139], v[24:27]
ds_read_b64_tr_b16 v[130:131], v161 offset:40960
v_mfma_f32_16x16x32_bf16 v[24:27], v[152:155], a[144:147], v[24:27]
ds_read_b64_tr_b16 v[132:133], v161 offset:33792
v_mfma_f32_16x16x32_bf16 v[24:27], v[156:159], a[152:155], v[24:27]
v_mfma_f32_16x16x32_bf16 v[24:27], v[32:35], v[196:199], v[24:27]
ds_read_b64_tr_b16 v[134:135], v161 offset:41984
v_mfma_f32_16x16x32_bf16 v[28:31], v[156:159], a[156:159], v[28:31]
ds_read_b64_tr_b16 v[136:137], v161 offset:34816
v_mfma_f32_16x16x32_bf16 v[28:31], v[152:155], a[148:151], v[28:31]
ds_read_b64_tr_b16 v[138:139], v161 offset:43008
v_mfma_f32_16x16x32_bf16 v[28:31], v[148:151], a[140:143], v[28:31]
ds_read_b64_tr_b16 v[140:141], v161 offset:35840
v_mfma_f32_16x16x32_bf16 v[28:31], v[144:147], a[132:135], v[28:31]
v_mfma_f32_16x16x32_bf16 v[28:31], v[32:35], v[200:203], v[28:31]
ds_read_b64_tr_b16 v[142:143], v161 offset:44032
s_waitcnt lgkmcnt(8)
v_mfma_f32_16x16x32_bf16 v[0:3], v[112:115], a[160:163], v[0:3]
ds_read_b64_tr_b16 v[144:145], v162 offset:32768
v_mfma_f32_16x16x32_bf16 v[0:3], v[116:119], a[168:171], v[0:3]
ds_read_b64_tr_b16 v[146:147], v162 offset:40960
v_mfma_f32_16x16x32_bf16 v[0:3], v[120:123], a[176:179], v[0:3]
ds_read_b64_tr_b16 v[148:149], v162 offset:33792
v_mfma_f32_16x16x32_bf16 v[0:3], v[124:127], a[184:187], v[0:3]
s_waitcnt vmcnt(4)
v_mfma_f32_16x16x32_bf16 v[0:3], v[34:37], v[96:99], v[0:3]
ds_read_b64_tr_b16 v[150:151], v162 offset:41984
v_mfma_f32_16x16x32_bf16 v[4:7], v[124:127], a[188:191], v[4:7]
ds_read_b64_tr_b16 v[152:153], v162 offset:34816
v_mfma_f32_16x16x32_bf16 v[4:7], v[120:123], a[180:183], v[4:7]
ds_read_b64_tr_b16 v[154:155], v162 offset:43008
v_mfma_f32_16x16x32_bf16 v[4:7], v[116:119], a[172:175], v[4:7]
ds_read_b64_tr_b16 v[156:157], v162 offset:35840
v_mfma_f32_16x16x32_bf16 v[4:7], v[112:115], a[164:167], v[4:7]
s_waitcnt vmcnt(3)
v_mfma_f32_16x16x32_bf16 v[4:7], v[34:37], v[100:103], v[4:7]
ds_read_b64_tr_b16 v[158:159], v162 offset:44032
s_waitcnt lgkmcnt(8)
v_mfma_f32_16x16x32_bf16 v[8:11], v[128:131], a[160:163], v[8:11]
ds_read_b64_tr_b16 v[112:113], v163 offset:32768
v_mfma_f32_16x16x32_bf16 v[8:11], v[132:135], a[168:171], v[8:11]
ds_read_b64_tr_b16 v[114:115], v163 offset:40960
v_mfma_f32_16x16x32_bf16 v[8:11], v[136:139], a[176:179], v[8:11]
ds_read_b64_tr_b16 v[116:117], v163 offset:33792
v_mfma_f32_16x16x32_bf16 v[8:11], v[140:143], a[184:187], v[8:11]
v_mfma_f32_16x16x32_bf16 v[8:11], v[32:35], v[96:99], v[8:11]
ds_read_b64_tr_b16 v[118:119], v163 offset:41984
s_waitcnt vmcnt(0)
v_mfma_f32_16x16x32_bf16 v[12:15], v[140:143], a[188:191], v[12:15]
ds_read_b64_tr_b16 v[120:121], v163 offset:34816
v_sub_u32 v243, v243, v242
v_mfma_f32_16x16x32_bf16 v[12:15], v[136:139], a[180:183], v[12:15]
ds_read_b64_tr_b16 v[122:123], v163 offset:43008
v_add_u32 v243, -3, v243
v_mfma_f32_16x16x32_bf16 v[12:15], v[132:135], a[172:175], v[12:15]
ds_read_b64_tr_b16 v[124:125], v163 offset:35840
v_cmp_le_u32 vcc, 13, v243
s_cbranch_vccnz L_slow9
L_back9:
v_mfma_f32_16x16x32_bf16 v[12:15], v[128:131], a[164:167], v[12:15]
v_mfma_f32_16x16x32_bf16 v[12:15], v[32:35], v[100:103], v[12:15]
ds_read_b64_tr_b16 v[126:127], v163 offset:44032
s_waitcnt lgkmcnt(8)
v_mfma_f32_16x16x32_bf16 v[16:19], v[144:147], a[160:163], v[16:19]
ds_read_b64_tr_b16 v[128:129], v160 offset:49152
ds_read_b64_tr_b16 v[130:131], v160 offset:57344
v_mfma_f32_16x16x32_bf16 v[16:19], v[148:151], a[168:171], v[16:19]
buffer_load_dwordx4 v[64:67], v251, s[40:43], s13 offen offset:0 sc1
v_mfma_f32_16x16x32_bf16 v[16:19], v[152:155], a[176:179], v[16:19]
ds_read_b64_tr_b16 v[132:133], v160 offset:50176
ds_read_b64_tr_b16 v[134:135], v160 offset:58368
v_mfma_f32_16x16x32_bf16 v[16:19], v[156:159], a[184:187], v[16:19]
v_mfma_f32_16x16x32_bf16 v[16:19], v[34:37], v[104:107], v[16:19]
buffer_load_dwordx4 v[68:71], v251, s[40:43], s13 offen offset:128 sc1
v_mfma_f32_16x16x32_bf16 v[20:23], v[156:159], a[188:191], v[20:23]
ds_read_b64_tr_b16 v[136:137], v160 offset:51200
ds_read_b64_tr_b16 v[138:139], v160 offset:59392
v_mfma_f32_16x16x32_bf16 v[20:23], v[152:155], a[180:183], v[20:23]
buffer_load_dwordx4 v[72:75], v247, s[40:43], s13 offen offset:0 sc1
v_mfma_f32_16x16x32_bf16 v[20:23], v[148:151], a[172:175], v[20:23]
ds_read_b64_tr_b16 v[140:141], v160 offset:52224
v_mfma_f32_16x16x32_bf16 v[20:23], v[144:147], a[164:167], v[20:23]
v_mfma_f32_16x16x32_bf16 v[20:23], v[34:37], v[108:111], v[20:23]
ds_read_b64_tr_b16 v[142:143], v160 offset:60416
s_waitcnt lgkmcnt(8)
v_mfma_f32_16x16x32_bf16 v[24:27], v[112:115], a[160:163], v[24:27]
ds_read_b64_tr_b16 v[144:145], v161 offset:49152
ds_read_b64_tr_b16 v[146:147], v161 offset:57344
v_mfma_f32_16x16x32_bf16 v[24:27], v[116:119], a[168:171], v[24:27]
buffer_load_dwordx4 v[76:79], v247, s[40:43], s13 offen offset:128 sc1
v_mfma_f32_16x16x32_bf16 v[24:27], v[120:123], a[176:179], v[24:27]
ds_read_b64_tr_b16 v[148:149], v161 offset:50176
v_mfma_f32_16x16x32_bf16 v[24:27], v[124:127], a[184:187], v[24:27]
v_mfma_f32_16x16x32_bf16 v[24:27], v[32:35], v[104:107], v[24:27]
ds_read_b64_tr_b16 v[150:151], v161 offset:58368
v_mfma_f32_16x16x32_bf16 v[28:31], v[124:127], a[188:191], v[28:31]
ds_read_b64_tr_b16 v[152:153], v161 offset:51200
v_mfma_f32_16x16x32_bf16 v[28:31], v[120:123], a[180:183], v[28:31]
ds_read_b64_tr_b16 v[154:155], v161 offset:59392
v_mfma_f32_16x16x32_bf16 v[28:31], v[116:119], a[172:175], v[28:31]
ds_read_b64_tr_b16 v[156:157], v161 offset:52224
v_mfma_f32_16x16x32_bf16 v[28:31], v[112:115], a[164:167], v[28:31]
v_mfma_f32_16x16x32_bf16 v[28:31], v[32:35], v[108:111], v[28:31]
ds_read_b64_tr_b16 v[158:159], v161 offset:60416
s_waitcnt lgkmcnt(8)
v_mfma_f32_16x16x32_bf16 v[0:3], v[128:131], a[192:195], v[0:3]
ds_read_b64_tr_b16 v[112:113], v162 offset:49152
v_mfma_f32_16x16x32_bf16 v[0:3], v[132:135], a[200:203], v[0:3]
L_pad10:
s_cbranch_execz L_warm2
ds_read_b64_tr_b16 v[114:115], v162 offset:57344
v_mfma_f32_16x16x32_bf16 v[0:3], v[136:139], a[208:211], v[0:3]
ds_read_b64_tr_b16 v[116:117], v162 offset:50176
v_mfma_f32_16x16x32_bf16 v[0:3], v[140:143], a[216:219], v[0:3]
s_waitcnt vmcnt(3)
v_mfma_f32_16x16x32_bf16 v[0:3], v[34:37], v[64:67], v[0:3]
ds_read_b64_tr_b16 v[118:119], v162 offset:58368
v_mfma_f32_16x16x32_bf16 v[4:7], v[140:143], a[220:223], v[4:7]
ds_read_b64_tr_b16 v[120:121], v162 offset:51200
v_mfma_f32_16x16x32_bf16 v[4:7], v[136:139], a[212:215], v[4:7]
ds_read_b64_tr_b16 v[122:123], v162 offset:59392
v_mfma_f32_16x16x32_bf16 v[4:7], v[132:135], a[204:207], v[4:7]
ds_read_b64_tr_b16 v[124:125], v162 offset:52224
v_mfma_f32_16x16x32_bf16 v[4:7], v[128:131], a[196:199], v[4:7]
s_waitcnt vmcnt(2)
v_mfma_f32_16x16x32_bf16 v[4:7], v[34:37], v[68:71], v[4:7]
ds_read_b64_tr_b16 v[126:127], v162 offset:60416
s_waitcnt lgkmcnt(8)
v_mfma_f32_16x16x32_bf16 v[8:11], v[144:147], a[192:195], v[8:11]
ds_read_b64_tr_b16 v[128:129], v163 offset:49152
v_mfma_f32_16x16x32_bf16 v[8:11], v[148:151], a[200:203], v[8:11]
ds_read_b64_tr_b16 v[130:131], v163 offset:57344
v_mfma_f32_16x16x32_bf16 v[8:11], v[152:155], a[208:211], v[8:11]
ds_read_b64_tr_b16 v[132:133], v163 offset:50176
v_cvt_pk_bf16_f32 v204, v0, v1
v_mfma_f32_16x16x32_bf16 v[8:11], v[156:159], a[216:219], v[8:11]
v_mfma_f32_16x16x32_bf16 v[8:11], v[32:35], v[64:67], v[8:11]
ds_read_b64_tr_b16 v[134:135], v163 offset:58368
v_cvt_pk_bf16_f32 v205, v2, v3
v_mfma_f32_16x16x32_bf16 v[12:15], v[156:159], a[220:223], v[12:15]
ds_read_b64_tr_b16 v[136:137], v163 offset:51200
ds_write_b64 v234, v[204:205] offset:0
v_mfma_f32_16x16x32_bf16 v[12:15], v[152:155], a[212:215], v[12:15]
ds_read_b64_tr_b16 v[138:139], v163 offset:59392
v_cvt_pk_bf16_f32 v208, v4, v5
v_mfma_f32_16x16x32_bf16 v[12:15], v[148:151], a[204:207], v[12:15]
ds_read_b64_tr_b16 v[140:141], v163 offset:52224
v_cvt_pk_bf16_f32 v209, v6, v7
v_mfma_f32_16x16x32_bf16 v[12:15], v[144:147], a[196:199], v[12:15]
v_mfma_f32_16x16x32_bf16 v[12:15], v[32:35], v[68:71], v[12:15]
ds_read_b64_tr_b16 v[142:143], v163 offset:60416
s_waitcnt lgkmcnt(9)
v_mfma_f32_16x16x32_bf16 v[16:19], v[112:115], a[192:195], v[16:19]
ds_write_b64 v234, v[208:209] offset:2048
v_mfma_f32_16x16x32_bf16 v[16:19], v[116:119], a[200:203], v[16:19]
v_mfma_f32_16x16x32_bf16 v[16:19], v[120:123], a[208:211], v[16:19]
v_cvt_pk_bf16_f32 v206, v8, v9
v_cvt_pk_bf16_f32 v207, v10, v11
v_mfma_f32_16x16x32_bf16 v[16:19], v[124:127], a[216:219], v[16:19]
s_waitcnt vmcnt(1)
v_mfma_f32_16x16x32_bf16 v[16:19], v[34:37], v[72:75], v[16:19]
v_xor_b32 v234, 32, v234
ds_write_b64 v234, v[206:207] offset:0
v_mfma_f32_16x16x32_bf16 v[20:23], v[124:127], a[220:223], v[20:23]
v_cvt_pk_bf16_f32 v210, v12, v13
v_cvt_pk_bf16_f32 v211, v14, v15
v_mfma_f32_16x16x32_bf16 v[20:23], v[120:123], a[212:215], v[20:23]
ds_write_b64 v234, v[210:211] offset:2048
v_mfma_f32_16x16x32_bf16 v[20:23], v[116:119], a[204:207], v[20:23]
v_mfma_f32_16x16x32_bf16 v[20:23], v[112:115], a[196:199], v[20:23]
s_waitcnt vmcnt(0)
v_mfma_f32_16x16x32_bf16 v[20:23], v[34:37], v[76:79], v[20:23]
s_waitcnt lgkmcnt(3)
v_mfma_f32_16x16x32_bf16 v[24:27], v[128:131], a[192:195], v[24:27]
v_mfma_f32_16x16x32_bf16 v[24:27], v[132:135], a[200:203], v[24:27]
v_mfma_f32_16x16x32_bf16 v[24:27], v[136:139], a[208:211], v[24:27]
v_cvt_pk_bf16_f32 v212, v16, v17
v_cvt_pk_bf16_f32 v213, v18, v19
v_mfma_f32_16x16x32_bf16 v[24:27], v[140:143], a[216:219], v[24:27]
v_mfma_f32_16x16x32_bf16 v[24:27], v[32:35], v[72:75], v[24:27]
v_xor_b32 v234, 96, v234
ds_write_b64 v234, v[212:213] offset:0
v_mfma_f32_16x16x32_bf16 v[28:31], v[140:143], a[220:223], v[28:31]
v_cvt_pk_bf16_f32 v216, v20, v21
v_cvt_pk_bf16_f32 v217, v22, v23
v_mfma_f32_16x16x32_bf16 v[28:31], v[136:139], a[212:215], v[28:31]
ds_write_b64 v234, v[216:217] offset:2048
v_mfma_f32_16x16x32_bf16 v[28:31], v[132:135], a[204:207], v[28:31]
v_mfma_f32_16x16x32_bf16 v[28:31], v[128:131], a[196:199], v[28:31]
v_mfma_f32_16x16x32_bf16 v[28:31], v[32:35], v[76:79], v[28:31]
v_cvt_pk_bf16_f32 v214, v24, v25
v_cvt_pk_bf16_f32 v215, v26, v27
v_xor_b32 v234, 32, v234
ds_write_b64 v234, v[214:215] offset:0
ds_read_b128 v[172:175], v235 offset:0
ds_read_b128 v[176:179], v235 offset:1024
s_nop 1
v_cvt_pk_bf16_f32 v218, v28, v29
v_cvt_pk_bf16_f32 v219, v30, v31
ds_write_b64 v234, v[218:219] offset:2048
ds_read_b128 v[180:183], v235 offset:2048
ds_read_b128 v[184:187], v235 offset:3072
s_waitcnt lgkmcnt(4)
buffer_store_dwordx4 v[172:175], v246, s[20:23], 0 offen nt
s_waitcnt lgkmcnt(3)
buffer_store_dwordx4 v[176:179], v246, s[20:23], s88 offen nt
s_waitcnt lgkmcnt(1)
buffer_store_dwordx4 v[180:183], v246, s[20:23], s84 offen nt
s_waitcnt lgkmcnt(0)
buffer_store_dwordx4 v[184:187], v246, s[20:23], s87 offen nt
s_or_b32 s82, s2, s3
s_cmp_lg_u32 s82, 0
s_cbranch_scc1 L_noe
s_mov_b64 exec, 1
buffer_store_dword v242, v239, s[40:43], 0 offen sc1
s_mov_b64 exec, -1
L_noe:
L_end:
s_endpgm
L_slow0:
s_mov_b32 s85, 0
L_spin0:
buffer_load_dwordx4 v[172:175], v239, s[40:43], s87 offen offset:0 sc1
buffer_load_dwordx4 v[176:179], v239, s[40:43], s87 offen offset:1024 sc1
buffer_load_dwordx4 v[180:183], v239, s[40:43], s87 offen offset:2048 sc1
buffer_load_dwordx4 v[184:187], v239, s[40:43], s87 offen offset:3072 sc1
s_waitcnt vmcnt(0)
v_xor_b32 v173, v173, v242
v_bitop3_b32 v173, v173, v175, v242 bitop3:0xf6
v_bitop3_b32 v173, v173, v177, v242 bitop3:0xf6
v_bitop3_b32 v173, v173, v179, v242 bitop3:0xf6
v_bitop3_b32 v173, v173, v181, v242 bitop3:0xf6
v_bitop3_b32 v173, v173, v183, v242 bitop3:0xf6
v_bitop3_b32 v173, v173, v185, v242 bitop3:0xf6
v_bitop3_b32 v173, v173, v187, v242 bitop3:0xf6
v_cmp_ne_u32 vcc, 0, v173
s_cbranch_vccz L_back0
s_add_u32 s85, s85, 1
s_cmp_lt_u32 s85, 1048576
s_cbranch_scc1 L_spin0
s_branch L_back0
L_slow1:
s_mov_b32 s85, 0
L_spin1:
buffer_load_dwordx4 v[188:191], v239, s[40:43], s86 offen sc1
s_waitcnt vmcnt(0)
v_xor_b32 v189, v189, v242
v_bitop3_b32 v189, v189, v191, v242 bitop3:0xf6
v_cmp_ne_u32 vcc, 0, v189
s_cbranch_vccz L_back1
s_add_u32 s85, s85, 1
s_cmp_lt_u32 s85, 1048576
s_cbranch_scc1 L_spin1
s_branch L_back1
L_slow2:
s_mov_b32 s85, 0
L_spin2:
buffer_load_dwordx4 v[188:191], v239, s[40:43], s17 offen offset:0 sc1
buffer_load_dwordx4 v[192:195], v239, s[40:43], s17 offen offset:1024 sc1
buffer_load_dwordx4 v[196:199], v239, s[40:43], s17 offen offset:2048 sc1
buffer_load_dwordx4 v[200:203], v239, s[40:43], s17 offen offset:3072 sc1
s_waitcnt vmcnt(0)
v_xor_b32 v189, v189, v242
v_bitop3_b32 v189, v189, v191, v242 bitop3:0xf6
v_bitop3_b32 v189, v189, v193, v242 bitop3:0xf6
v_bitop3_b32 v189, v189, v195, v242 bitop3:0xf6
v_bitop3_b32 v189, v189, v197, v242 bitop3:0xf6
v_bitop3_b32 v189, v189, v199, v242 bitop3:0xf6
v_bitop3_b32 v189, v189, v201, v242 bitop3:0xf6
v_bitop3_b32 v189, v189, v203, v242 bitop3:0xf6
v_cmp_ne_u32 vcc, 0, v189
s_cbranch_vccz L_back2
s_add_u32 s85, s85, 1
s_cmp_lt_u32 s85, 1048576
s_cbranch_scc1 L_spin2
s_branch L_back2
L_slow3:
s_mov_b32 s85, 0
L_spin3:
buffer_load_dword v243, v241, s[40:43], s86 offen offset:1024 sc1
s_waitcnt vmcnt(0)
v_sub_u32 v243, v243, v242
v_add_u32 v243, -1, v243
v_cmp_le_u32 vcc, 15, v243
s_cbranch_vccz L_back3
s_add_u32 s85, s85, 1
s_cmp_lt_u32 s85, 1048576
s_cbranch_scc1 L_spin3
s_branch L_back3
L_slow4:
s_mov_b32 s85, 0
L_spin4:
buffer_load_dword v243, v241, s[40:43], s86 offen offset:1024 sc1
s_waitcnt vmcnt(0)
v_sub_u32 v243, v243, v242
v_add_u32 v243, -2, v243
v_cmp_le_u32 vcc, 14, v243
s_cbranch_vccz L_back4
s_add_u32 s85, s85, 1
s_cmp_lt_u32 s85, 1048576
s_cbranch_scc1 L_spin4
s_branch L_back4
L_slow5:
s_mov_b32 s85, 0
L_spin5:
buffer_load_dword v243, v241, s[40:43], s86 offen offset:1024 sc1
s_waitcnt vmcnt(0)
v_sub_u32 v243, v243, v242
v_add_u32 v243, -3, v243
v_cmp_le_u32 vcc, 13, v243
s_cbranch_vccz L_back5
s_add_u32 s85, s85, 1
s_cmp_lt_u32 s85, 1048576
s_cbranch_scc1 L_spin5
s_branch L_back5
L_slow6:
s_mov_b32 s85, 0
L_spin6:
buffer_load_dword v243, v241, s[40:43], s86 offen offset:1024 sc1
s_waitcnt vmcnt(0)
v_sub_u32 v243, v243, v242
v_add_u32 v243, -4, v243
v_cmp_le_u32 vcc, 12, v243
s_cbranch_vccz L_back6
s_add_u32 s85, s85, 1
s_cmp_lt_u32 s85, 1048576
s_cbranch_scc1 L_spin6
s_branch L_back6
L_slow7:
s_mov_b32 s85, 0
L_spin7:
buffer_load_dword v243, v245, s[40:43], s86 offen offset:1536 sc1
s_waitcnt vmcnt(0)
v_sub_u32 v243, v243, v242
v_add_u32 v243, -1, v243
v_cmp_le_u32 vcc, 15, v243
s_cbranch_vccz L_back7
s_add_u32 s85, s85, 1
s_cmp_lt_u32 s85, 1048576
s_cbranch_scc1 L_spin7
s_branch L_back7
L_slow8:
s_mov_b32 s85, 0
L_spin8:
buffer_load_dword v243, v245, s[40:43], s86 offen offset:1536 sc1
s_waitcnt vmcnt(0)
v_sub_u32 v243, v243, v242
v_add_u32 v243, -2, v243
v_cmp_le_u32 vcc, 14, v243
s_cbranch_vccz L_back8
s_add_u32 s85, s85, 1
s_cmp_lt_u32 s85, 1048576
s_cbranch_scc1 L_spin8
s_branch L_back8
L_slow9:
s_mov_b32 s85, 0
L_spin9:
buffer_load_dword v243, v245, s[40:43], s86 offen offset:1536 sc1
s_waitcnt vmcnt(0)
v_sub_u32 v243, v243, v242
v_add_u32 v243, -3, v243
v_cmp_le_u32 vcc, 13, v243
s_cbranch_vccz L_back9
s_add_u32 s85, s85, 1
s_cmp_lt_u32 s85, 1048576
s_cbranch_scc1 L_spin9
s_branch L_back9
.section .rodata,"a"
.p2align 6
.amdhsa_kernel standalone__mixer_channel_mlp__prompt_kernel
  .amdhsa_next_free_vgpr 512
  .amdhsa_next_free_sgpr 102
  .amdhsa_accum_offset 256
  .amdhsa_group_segment_fixed_size 0
  .amdhsa_kernarg_size 64
  .amdhsa_user_sgpr_count 2
  .amdhsa_user_sgpr_kernarg_segment_ptr 1
  .amdhsa_system_sgpr_workgroup_id_x 1
  .amdhsa_float_denorm_mode_32 3
.end_amdhsa_kernel
```
